```python
import torch

def _softmax(x, axis=-1):
    return torch.softmax(x, dim=axis)
def _gelu(x):
    return torch.nn.functional.gelu(x, approximate="tanh")
def _silu(x):
    return torch.nn.functional.silu(x)
def _sigmoid(x):
    return torch.sigmoid(x)
def _layernorm(x, axis=-1, eps=1e-5):
    m = x.mean(dim=axis, keepdim=True)
    v = x.var(dim=axis, keepdim=True, unbiased=False)
    return (x - m) / torch.sqrt(v + eps)
def _scatter_add(tgt, idx, src, axis=0):
    return tgt.clone().index_add_(axis, idx, src)
def _segment_sum(src, seg, n):
    out = torch.zeros((n,) + src.shape[1:], dtype=src.dtype)
    return out.index_add_(0, seg, src)
def _pad(x, pw):
    flat = tuple(v for pair in reversed(pw) for v in pair)
    return torch.nn.functional.pad(x, flat)

kernel_name = 'parallel_sum__spectral_gfnet__glu_gated_geglu__prompt'

def setup_inputs():

    _w = (lambda a: (lambda t: t.to(torch.bfloat16) if t.is_floating_point() else t)(torch.as_tensor(a)))
    def _A_setup():
        B, S, D = 1, 2048, 576
        Df = D // 2 + 1
        return {
            "x": _w((lambda *s: torch.randn(*s, dtype=torch.bfloat16) * 0.05)(B, S, D)),
            "w_r": _w((lambda *s: torch.randn(*s, dtype=torch.bfloat16) * 0.8)(S, Df) * 0.02),
            "w_i": _w((lambda *s: torch.randn(*s, dtype=torch.bfloat16) * 0.8)(S, Df) * 0.02),
        }
    _A_in = _A_setup()

    def _B_setup():
        B, S, Dm, Df = 1, 2048, 576, 4608
        return {
            "x": _w((lambda *s: torch.randn(*s, dtype=torch.bfloat16) * 0.05)(B, S, Dm)),
            "w_gate": _w((lambda *s: torch.randn(*s, dtype=torch.bfloat16) * 0.4)(Dm, Df) * (Dm ** -0.5)),
            "w_up": _w((lambda *s: torch.randn(*s, dtype=torch.bfloat16) * 0.4)(Dm, Df) * (Dm ** -0.5)),
            "w_down": _w((lambda *s: torch.randn(*s, dtype=torch.bfloat16) * 0.4)(Df, Dm) * (Df ** -0.5)),
        }
    _B_in = _B_setup()

    return {
        "A_x": _A_in["x"],
        "A_w_r": _A_in["w_r"],
        "A_w_i": _A_in["w_i"],
        "B_x": _B_in["x"],
        "B_w_gate": _B_in["w_gate"],
        "B_w_up": _B_in["w_up"],
        "B_w_down": _B_in["w_down"],
    }

def reference(A_x, A_w_r, A_w_i, B_x, B_w_gate, B_w_up, B_w_down):
    def _A_ref(x, w_r, w_i):
        B, S, D = x.shape
        X = (lambda x, axes=(-2,-1): torch.fft.rfft2(x.float(), dim=axes))(x, axes=(-2, -1))
        W = w_r + 1j * w_i
        X = X * W
        y = (lambda x, s, axes=(-2,-1): torch.fft.irfft2(x, s=s, dim=axes).to(torch.bfloat16))(X, (S, D), axes=(-2, -1))
        return y

    def _B_ref(x, w_gate, w_up, w_down):
        g = torch.einsum("bsd,df->bsf", x, w_gate)
        u = torch.einsum("bsd,df->bsf", x, w_up)
        h = _gelu(g) * u
        return torch.einsum("bsf,fd->bsd", h, w_down)

    x = A_x
    xn = _layernorm(x, axis=-1)
    return x + _A_ref(xn, A_w_r, A_w_i) + _B_ref(xn, B_w_gate, B_w_up, B_w_down)
```

```asm
; @launch kernel=prep_kernel grid=(256,1,1) block=(384,1,1) lds=40960
; @launch kernel=ffn1_kernel grid=(256,1,1) block=(512,1,1) lds=74752
; @launch kernel=g2_kernel grid=(329,1,1) block=(256,1,1) lds=73728
; @launch kernel=fin_kernel grid=(192,1,1) block=(384,1,1) lds=98304
.amdgcn_target "amdgcn-amd-amdhsa--gfx950"
.text
.globl prep_kernel
.p2align 8
.type prep_kernel,@function
prep_kernel:
    s_cmp_ge_u32 s2, 256
    s_cbranch_scc1 Lprep_end
    s_load_dwordx2 s[4:5], s[0:1], 0
    s_load_dwordx4 s[8:11], s[0:1], 8
    s_load_dwordx2 s[6:7], s[0:1], 72
    s_load_dwordx4 s[60:63], s[0:1], 32
    s_load_dwordx2 s[64:65], s[0:1], 48
    v_lshrrev_b32 v1, 6, v0
    v_and_b32 v0, 63, v0
    s_nop 0
    v_readfirstlane_b32 s20, v1
    v_lshrrev_b32 v2, 5, v0
    v_and_b32 v3, 31, v0
    s_mov_b32 s43, s2
    s_cmp_ge_u32 s2, 244
    s_cbranch_scc1 Lprep_C
    s_cmp_ge_u32 s2, 192
    s_cbranch_scc1 Lprep_B
    s_mul_i32 s21, s2, 43691
    s_lshr_b32 s21, s21, 17
    s_mul_i32 s22, s21, 3
    s_sub_u32 s22, s2, s22
    s_mul_i32 s23, s22, 6
    s_add_u32 s23, s23, s20
    v_lshlrev_b32 v4, 6, v3
    v_add_u32 v4, s21, v4
    v_mul_u32_u24 v4, 1152, v4
    v_mul_u32_u24 v5, 576, v2
    v_add_u32 v4, v4, v5
    s_mul_i32 s24, s20, 96
    s_waitcnt lgkmcnt(0)
    s_mov_b32 s12, s4
    s_mov_b32 s13, s5
    s_mov_b32 s14, 2359296
    s_mov_b32 s15, 0x00020000
    buffer_load_dwordx4 v[8:11], v4, s[12:15], s24 offen offset:0
    buffer_load_dwordx4 v[12:15], v4, s[12:15], s24 offen offset:16
    buffer_load_dwordx4 v[16:19], v4, s[12:15], s24 offen offset:32
    buffer_load_dwordx4 v[20:23], v4, s[12:15], s24 offen offset:48
    buffer_load_dwordx4 v[24:27], v4, s[12:15], s24 offen offset:64
    buffer_load_dwordx4 v[28:31], v4, s[12:15], s24 offen offset:80
    v_and_b32 v5, 15, v0
    s_lshl_b32 s24, s23, 4
    v_add_u32 v5, s24, v5
    v_bfe_u32 v6, v0, 4, 1
    v_cvt_f32_u32 v7, v6
    v_mul_f32 v7, 0x3e800000, v7
    v_cmp_eq_u32 vcc, 0, v5
    v_cmp_eq_u32 s[26:27], 1, v6
    s_nop 1
    s_and_b64 vcc, vcc, s[26:27]
    v_mov_b32 v6, 288
    s_nop 1
    v_cndmask_b32 v5, v5, v6, vcc
    v_mov_b32 v6, 0
    v_cndmask_b32 v7, v7, v6, vcc
    s_mov_b32 s24, 0x3ae38e39
    v_cvt_f32_u32 v6, v5
    v_mul_f32 v6, s24, v6
    v_cos_f32 v6, v6
    s_nop 0
    v_add_f32 v6, v6, v6
    v_mul_u32_u24 v1, 288, v2
    v_add_u32 v240, 0, v1
    v_mul_u32_u24 v240, v240, v5
    v_cvt_f32_u32 v240, v240
    v_mul_f32 v240, s24, v240
    v_fract_f32 v240, v240
    v_add_f32 v240, v240, v7
    v_cos_f32 v240, v240
    v_add_u32 v241, 1, v1
    v_mul_u32_u24 v241, v241, v5
    v_cvt_f32_u32 v241, v241
    v_mul_f32 v241, s24, v241
    v_fract_f32 v241, v241
    v_add_f32 v241, v241, v7
    v_cos_f32 v241, v241
    s_nop 0
    v_cvt_pk_bf16_f32 v80, v240, v241
    v_fma_f32 v242, v6, v241, -v240
    v_fma_f32 v243, v6, v242, -v241
    v_cvt_pk_bf16_f32 v81, v242, v243
    v_fma_f32 v240, v6, v243, -v242
    v_fma_f32 v241, v6, v240, -v243
    v_cvt_pk_bf16_f32 v82, v240, v241
    v_fma_f32 v242, v6, v241, -v240
    v_fma_f32 v243, v6, v242, -v241
    v_cvt_pk_bf16_f32 v83, v242, v243
    v_fma_f32 v240, v6, v243, -v242
    v_fma_f32 v241, v6, v240, -v243
    v_cvt_pk_bf16_f32 v84, v240, v241
    v_fma_f32 v242, v6, v241, -v240
    v_fma_f32 v243, v6, v242, -v241
    v_cvt_pk_bf16_f32 v85, v242, v243
    v_fma_f32 v240, v6, v243, -v242
    v_fma_f32 v241, v6, v240, -v243
    v_cvt_pk_bf16_f32 v86, v240, v241
    v_fma_f32 v242, v6, v241, -v240
    v_fma_f32 v243, v6, v242, -v241
    v_cvt_pk_bf16_f32 v87, v242, v243
    v_fma_f32 v240, v6, v243, -v242
    v_fma_f32 v241, v6, v240, -v243
    v_cvt_pk_bf16_f32 v88, v240, v241
    v_fma_f32 v242, v6, v241, -v240
    v_fma_f32 v243, v6, v242, -v241
    v_cvt_pk_bf16_f32 v89, v242, v243
    v_fma_f32 v240, v6, v243, -v242
    v_fma_f32 v241, v6, v240, -v243
    v_cvt_pk_bf16_f32 v90, v240, v241
    v_fma_f32 v242, v6, v241, -v240
    v_fma_f32 v243, v6, v242, -v241
    v_cvt_pk_bf16_f32 v91, v242, v243
    v_fma_f32 v240, v6, v243, -v242
    v_fma_f32 v241, v6, v240, -v243
    v_cvt_pk_bf16_f32 v92, v240, v241
    v_fma_f32 v242, v6, v241, -v240
    v_fma_f32 v243, v6, v242, -v241
    v_cvt_pk_bf16_f32 v93, v242, v243
    v_fma_f32 v240, v6, v243, -v242
    v_fma_f32 v241, v6, v240, -v243
    v_cvt_pk_bf16_f32 v94, v240, v241
    v_fma_f32 v242, v6, v241, -v240
    v_fma_f32 v243, v6, v242, -v241
    v_cvt_pk_bf16_f32 v95, v242, v243
    v_add_u32 v240, 32, v1
    v_mul_u32_u24 v240, v240, v5
    v_cvt_f32_u32 v240, v240
    v_mul_f32 v240, s24, v240
    v_fract_f32 v240, v240
    v_add_f32 v240, v240, v7
    v_cos_f32 v240, v240
    v_add_u32 v241, 33, v1
    v_mul_u32_u24 v241, v241, v5
    v_cvt_f32_u32 v241, v241
    v_mul_f32 v241, s24, v241
    v_fract_f32 v241, v241
    v_add_f32 v241, v241, v7
    v_cos_f32 v241, v241
    s_nop 0
    v_cvt_pk_bf16_f32 v96, v240, v241
    v_fma_f32 v242, v6, v241, -v240
    v_fma_f32 v243, v6, v242, -v241
    v_cvt_pk_bf16_f32 v97, v242, v243
    v_fma_f32 v240, v6, v243, -v242
    v_fma_f32 v241, v6, v240, -v243
    v_cvt_pk_bf16_f32 v98, v240, v241
    v_fma_f32 v242, v6, v241, -v240
    v_fma_f32 v243, v6, v242, -v241
    v_cvt_pk_bf16_f32 v99, v242, v243
    v_fma_f32 v240, v6, v243, -v242
    v_fma_f32 v241, v6, v240, -v243
    v_cvt_pk_bf16_f32 v100, v240, v241
    v_fma_f32 v242, v6, v241, -v240
    v_fma_f32 v243, v6, v242, -v241
    v_cvt_pk_bf16_f32 v101, v242, v243
    v_fma_f32 v240, v6, v243, -v242
    v_fma_f32 v241, v6, v240, -v243
    v_cvt_pk_bf16_f32 v102, v240, v241
    v_fma_f32 v242, v6, v241, -v240
    v_fma_f32 v243, v6, v242, -v241
    v_cvt_pk_bf16_f32 v103, v242, v243
    v_fma_f32 v240, v6, v243, -v242
    v_fma_f32 v241, v6, v240, -v243
    v_cvt_pk_bf16_f32 v104, v240, v241
    v_fma_f32 v242, v6, v241, -v240
    v_fma_f32 v243, v6, v242, -v241
    v_cvt_pk_bf16_f32 v105, v242, v243
    v_fma_f32 v240, v6, v243, -v242
    v_fma_f32 v241, v6, v240, -v243
    v_cvt_pk_bf16_f32 v106, v240, v241
    v_fma_f32 v242, v6, v241, -v240
    v_fma_f32 v243, v6, v242, -v241
    v_cvt_pk_bf16_f32 v107, v242, v243
    v_fma_f32 v240, v6, v243, -v242
    v_fma_f32 v241, v6, v240, -v243
    v_cvt_pk_bf16_f32 v108, v240, v241
    v_fma_f32 v242, v6, v241, -v240
    v_fma_f32 v243, v6, v242, -v241
    v_cvt_pk_bf16_f32 v109, v242, v243
    v_fma_f32 v240, v6, v243, -v242
    v_fma_f32 v241, v6, v240, -v243
    v_cvt_pk_bf16_f32 v110, v240, v241
    v_fma_f32 v242, v6, v241, -v240
    v_fma_f32 v243, v6, v242, -v241
    v_cvt_pk_bf16_f32 v111, v242, v243
    v_add_u32 v240, 64, v1
    v_mul_u32_u24 v240, v240, v5
    v_cvt_f32_u32 v240, v240
    v_mul_f32 v240, s24, v240
    v_fract_f32 v240, v240
    v_add_f32 v240, v240, v7
    v_cos_f32 v240, v240
    v_add_u32 v241, 65, v1
    v_mul_u32_u24 v241, v241, v5
    v_cvt_f32_u32 v241, v241
    v_mul_f32 v241, s24, v241
    v_fract_f32 v241, v241
    v_add_f32 v241, v241, v7
    v_cos_f32 v241, v241
    s_nop 0
    v_cvt_pk_bf16_f32 v112, v240, v241
    v_fma_f32 v242, v6, v241, -v240
    v_fma_f32 v243, v6, v242, -v241
    v_cvt_pk_bf16_f32 v113, v242, v243
    v_fma_f32 v240, v6, v243, -v242
    v_fma_f32 v241, v6, v240, -v243
    v_cvt_pk_bf16_f32 v114, v240, v241
    v_fma_f32 v242, v6, v241, -v240
    v_fma_f32 v243, v6, v242, -v241
    v_cvt_pk_bf16_f32 v115, v242, v243
    v_fma_f32 v240, v6, v243, -v242
    v_fma_f32 v241, v6, v240, -v243
    v_cvt_pk_bf16_f32 v116, v240, v241
    v_fma_f32 v242, v6, v241, -v240
    v_fma_f32 v243, v6, v242, -v241
    v_cvt_pk_bf16_f32 v117, v242, v243
    v_fma_f32 v240, v6, v243, -v242
    v_fma_f32 v241, v6, v240, -v243
    v_cvt_pk_bf16_f32 v118, v240, v241
    v_fma_f32 v242, v6, v241, -v240
    v_fma_f32 v243, v6, v242, -v241
    v_cvt_pk_bf16_f32 v119, v242, v243
    v_fma_f32 v240, v6, v243, -v242
    v_fma_f32 v241, v6, v240, -v243
    v_cvt_pk_bf16_f32 v120, v240, v241
    v_fma_f32 v242, v6, v241, -v240
    v_fma_f32 v243, v6, v242, -v241
    v_cvt_pk_bf16_f32 v121, v242, v243
    v_fma_f32 v240, v6, v243, -v242
    v_fma_f32 v241, v6, v240, -v243
    v_cvt_pk_bf16_f32 v122, v240, v241
    v_fma_f32 v242, v6, v241, -v240
    v_fma_f32 v243, v6, v242, -v241
    v_cvt_pk_bf16_f32 v123, v242, v243
    v_fma_f32 v240, v6, v243, -v242
    v_fma_f32 v241, v6, v240, -v243
    v_cvt_pk_bf16_f32 v124, v240, v241
    v_fma_f32 v242, v6, v241, -v240
    v_fma_f32 v243, v6, v242, -v241
    v_cvt_pk_bf16_f32 v125, v242, v243
    v_fma_f32 v240, v6, v243, -v242
    v_fma_f32 v241, v6, v240, -v243
    v_cvt_pk_bf16_f32 v126, v240, v241
    v_fma_f32 v242, v6, v241, -v240
    v_fma_f32 v243, v6, v242, -v241
    v_cvt_pk_bf16_f32 v127, v242, v243
    v_add_u32 v240, 96, v1
    v_mul_u32_u24 v240, v240, v5
    v_cvt_f32_u32 v240, v240
    v_mul_f32 v240, s24, v240
    v_fract_f32 v240, v240
    v_add_f32 v240, v240, v7
    v_cos_f32 v240, v240
    v_add_u32 v241, 97, v1
    v_mul_u32_u24 v241, v241, v5
    v_cvt_f32_u32 v241, v241
    v_mul_f32 v241, s24, v241
    v_fract_f32 v241, v241
    v_add_f32 v241, v241, v7
    v_cos_f32 v241, v241
    s_nop 0
    v_cvt_pk_bf16_f32 v128, v240, v241
    v_fma_f32 v242, v6, v241, -v240
    v_fma_f32 v243, v6, v242, -v241
    v_cvt_pk_bf16_f32 v129, v242, v243
    v_fma_f32 v240, v6, v243, -v242
    v_fma_f32 v241, v6, v240, -v243
    v_cvt_pk_bf16_f32 v130, v240, v241
    v_fma_f32 v242, v6, v241, -v240
    v_fma_f32 v243, v6, v242, -v241
    v_cvt_pk_bf16_f32 v131, v242, v243
    v_fma_f32 v240, v6, v243, -v242
    v_fma_f32 v241, v6, v240, -v243
    v_cvt_pk_bf16_f32 v132, v240, v241
    v_fma_f32 v242, v6, v241, -v240
    v_fma_f32 v243, v6, v242, -v241
    v_cvt_pk_bf16_f32 v133, v242, v243
    v_fma_f32 v240, v6, v243, -v242
    v_fma_f32 v241, v6, v240, -v243
    v_cvt_pk_bf16_f32 v134, v240, v241
    v_fma_f32 v242, v6, v241, -v240
    v_fma_f32 v243, v6, v242, -v241
    v_cvt_pk_bf16_f32 v135, v242, v243
    v_fma_f32 v240, v6, v243, -v242
    v_fma_f32 v241, v6, v240, -v243
    v_cvt_pk_bf16_f32 v136, v240, v241
    v_fma_f32 v242, v6, v241, -v240
    v_fma_f32 v243, v6, v242, -v241
    v_cvt_pk_bf16_f32 v137, v242, v243
    v_fma_f32 v240, v6, v243, -v242
    v_fma_f32 v241, v6, v240, -v243
    v_cvt_pk_bf16_f32 v138, v240, v241
    v_fma_f32 v242, v6, v241, -v240
    v_fma_f32 v243, v6, v242, -v241
    v_cvt_pk_bf16_f32 v139, v242, v243
    v_fma_f32 v240, v6, v243, -v242
    v_fma_f32 v241, v6, v240, -v243
    v_cvt_pk_bf16_f32 v140, v240, v241
    v_fma_f32 v242, v6, v241, -v240
    v_fma_f32 v243, v6, v242, -v241
    v_cvt_pk_bf16_f32 v141, v242, v243
    v_fma_f32 v240, v6, v243, -v242
    v_fma_f32 v241, v6, v240, -v243
    v_cvt_pk_bf16_f32 v142, v240, v241
    v_fma_f32 v242, v6, v241, -v240
    v_fma_f32 v243, v6, v242, -v241
    v_cvt_pk_bf16_f32 v143, v242, v243
    v_add_u32 v240, 128, v1
    v_mul_u32_u24 v240, v240, v5
    v_cvt_f32_u32 v240, v240
    v_mul_f32 v240, s24, v240
    v_fract_f32 v240, v240
    v_add_f32 v240, v240, v7
    v_cos_f32 v240, v240
    v_add_u32 v241, 129, v1
    v_mul_u32_u24 v241, v241, v5
    v_cvt_f32_u32 v241, v241
    v_mul_f32 v241, s24, v241
    v_fract_f32 v241, v241
    v_add_f32 v241, v241, v7
    v_cos_f32 v241, v241
    s_nop 0
    v_cvt_pk_bf16_f32 v144, v240, v241
    v_fma_f32 v242, v6, v241, -v240
    v_fma_f32 v243, v6, v242, -v241
    v_cvt_pk_bf16_f32 v145, v242, v243
    v_fma_f32 v240, v6, v243, -v242
    v_fma_f32 v241, v6, v240, -v243
    v_cvt_pk_bf16_f32 v146, v240, v241
    v_fma_f32 v242, v6, v241, -v240
    v_fma_f32 v243, v6, v242, -v241
    v_cvt_pk_bf16_f32 v147, v242, v243
    v_fma_f32 v240, v6, v243, -v242
    v_fma_f32 v241, v6, v240, -v243
    v_cvt_pk_bf16_f32 v148, v240, v241
    v_fma_f32 v242, v6, v241, -v240
    v_fma_f32 v243, v6, v242, -v241
    v_cvt_pk_bf16_f32 v149, v242, v243
    v_fma_f32 v240, v6, v243, -v242
    v_fma_f32 v241, v6, v240, -v243
    v_cvt_pk_bf16_f32 v150, v240, v241
    v_fma_f32 v242, v6, v241, -v240
    v_fma_f32 v243, v6, v242, -v241
    v_cvt_pk_bf16_f32 v151, v242, v243
    v_fma_f32 v240, v6, v243, -v242
    v_fma_f32 v241, v6, v240, -v243
    v_cvt_pk_bf16_f32 v152, v240, v241
    v_fma_f32 v242, v6, v241, -v240
    v_fma_f32 v243, v6, v242, -v241
    v_cvt_pk_bf16_f32 v153, v242, v243
    v_fma_f32 v240, v6, v243, -v242
    v_fma_f32 v241, v6, v240, -v243
    v_cvt_pk_bf16_f32 v154, v240, v241
    v_fma_f32 v242, v6, v241, -v240
    v_fma_f32 v243, v6, v242, -v241
    v_cvt_pk_bf16_f32 v155, v242, v243
    v_fma_f32 v240, v6, v243, -v242
    v_fma_f32 v241, v6, v240, -v243
    v_cvt_pk_bf16_f32 v156, v240, v241
    v_fma_f32 v242, v6, v241, -v240
    v_fma_f32 v243, v6, v242, -v241
    v_cvt_pk_bf16_f32 v157, v242, v243
    v_fma_f32 v240, v6, v243, -v242
    v_fma_f32 v241, v6, v240, -v243
    v_cvt_pk_bf16_f32 v158, v240, v241
    v_fma_f32 v242, v6, v241, -v240
    v_fma_f32 v243, v6, v242, -v241
    v_cvt_pk_bf16_f32 v159, v242, v243
    v_add_u32 v240, 160, v1
    v_mul_u32_u24 v240, v240, v5
    v_cvt_f32_u32 v240, v240
    v_mul_f32 v240, s24, v240
    v_fract_f32 v240, v240
    v_add_f32 v240, v240, v7
    v_cos_f32 v240, v240
    v_add_u32 v241, 161, v1
    v_mul_u32_u24 v241, v241, v5
    v_cvt_f32_u32 v241, v241
    v_mul_f32 v241, s24, v241
    v_fract_f32 v241, v241
    v_add_f32 v241, v241, v7
    v_cos_f32 v241, v241
    s_nop 0
    v_cvt_pk_bf16_f32 v160, v240, v241
    v_fma_f32 v242, v6, v241, -v240
    v_fma_f32 v243, v6, v242, -v241
    v_cvt_pk_bf16_f32 v161, v242, v243
    v_fma_f32 v240, v6, v243, -v242
    v_fma_f32 v241, v6, v240, -v243
    v_cvt_pk_bf16_f32 v162, v240, v241
    v_fma_f32 v242, v6, v241, -v240
    v_fma_f32 v243, v6, v242, -v241
    v_cvt_pk_bf16_f32 v163, v242, v243
    v_fma_f32 v240, v6, v243, -v242
    v_fma_f32 v241, v6, v240, -v243
    v_cvt_pk_bf16_f32 v164, v240, v241
    v_fma_f32 v242, v6, v241, -v240
    v_fma_f32 v243, v6, v242, -v241
    v_cvt_pk_bf16_f32 v165, v242, v243
    v_fma_f32 v240, v6, v243, -v242
    v_fma_f32 v241, v6, v240, -v243
    v_cvt_pk_bf16_f32 v166, v240, v241
    v_fma_f32 v242, v6, v241, -v240
    v_fma_f32 v243, v6, v242, -v241
    v_cvt_pk_bf16_f32 v167, v242, v243
    v_fma_f32 v240, v6, v243, -v242
    v_fma_f32 v241, v6, v240, -v243
    v_cvt_pk_bf16_f32 v168, v240, v241
    v_fma_f32 v242, v6, v241, -v240
    v_fma_f32 v243, v6, v242, -v241
    v_cvt_pk_bf16_f32 v169, v242, v243
    v_fma_f32 v240, v6, v243, -v242
    v_fma_f32 v241, v6, v240, -v243
    v_cvt_pk_bf16_f32 v170, v240, v241
    v_fma_f32 v242, v6, v241, -v240
    v_fma_f32 v243, v6, v242, -v241
    v_cvt_pk_bf16_f32 v171, v242, v243
    v_fma_f32 v240, v6, v243, -v242
    v_fma_f32 v241, v6, v240, -v243
    v_cvt_pk_bf16_f32 v172, v240, v241
    v_fma_f32 v242, v6, v241, -v240
    v_fma_f32 v243, v6, v242, -v241
    v_cvt_pk_bf16_f32 v173, v242, v243
    v_fma_f32 v240, v6, v243, -v242
    v_fma_f32 v241, v6, v240, -v243
    v_cvt_pk_bf16_f32 v174, v240, v241
    v_fma_f32 v242, v6, v241, -v240
    v_fma_f32 v243, v6, v242, -v241
    v_cvt_pk_bf16_f32 v175, v242, v243
    v_add_u32 v240, 192, v1
    v_mul_u32_u24 v240, v240, v5
    v_cvt_f32_u32 v240, v240
    v_mul_f32 v240, s24, v240
    v_fract_f32 v240, v240
    v_add_f32 v240, v240, v7
    v_cos_f32 v240, v240
    v_add_u32 v241, 193, v1
    v_mul_u32_u24 v241, v241, v5
    v_cvt_f32_u32 v241, v241
    v_mul_f32 v241, s24, v241
    v_fract_f32 v241, v241
    v_add_f32 v241, v241, v7
    v_cos_f32 v241, v241
    s_nop 0
    v_cvt_pk_bf16_f32 v176, v240, v241
    v_fma_f32 v242, v6, v241, -v240
    v_fma_f32 v243, v6, v242, -v241
    v_cvt_pk_bf16_f32 v177, v242, v243
    v_fma_f32 v240, v6, v243, -v242
    v_fma_f32 v241, v6, v240, -v243
    v_cvt_pk_bf16_f32 v178, v240, v241
    v_fma_f32 v242, v6, v241, -v240
    v_fma_f32 v243, v6, v242, -v241
    v_cvt_pk_bf16_f32 v179, v242, v243
    v_fma_f32 v240, v6, v243, -v242
    v_fma_f32 v241, v6, v240, -v243
    v_cvt_pk_bf16_f32 v180, v240, v241
    v_fma_f32 v242, v6, v241, -v240
    v_fma_f32 v243, v6, v242, -v241
    v_cvt_pk_bf16_f32 v181, v242, v243
    v_fma_f32 v240, v6, v243, -v242
    v_fma_f32 v241, v6, v240, -v243
    v_cvt_pk_bf16_f32 v182, v240, v241
    v_fma_f32 v242, v6, v241, -v240
    v_fma_f32 v243, v6, v242, -v241
    v_cvt_pk_bf16_f32 v183, v242, v243
    v_fma_f32 v240, v6, v243, -v242
    v_fma_f32 v241, v6, v240, -v243
    v_cvt_pk_bf16_f32 v184, v240, v241
    v_fma_f32 v242, v6, v241, -v240
    v_fma_f32 v243, v6, v242, -v241
    v_cvt_pk_bf16_f32 v185, v242, v243
    v_fma_f32 v240, v6, v243, -v242
    v_fma_f32 v241, v6, v240, -v243
    v_cvt_pk_bf16_f32 v186, v240, v241
    v_fma_f32 v242, v6, v241, -v240
    v_fma_f32 v243, v6, v242, -v241
    v_cvt_pk_bf16_f32 v187, v242, v243
    v_fma_f32 v240, v6, v243, -v242
    v_fma_f32 v241, v6, v240, -v243
    v_cvt_pk_bf16_f32 v188, v240, v241
    v_fma_f32 v242, v6, v241, -v240
    v_fma_f32 v243, v6, v242, -v241
    v_cvt_pk_bf16_f32 v189, v242, v243
    v_fma_f32 v240, v6, v243, -v242
    v_fma_f32 v241, v6, v240, -v243
    v_cvt_pk_bf16_f32 v190, v240, v241
    v_fma_f32 v242, v6, v241, -v240
    v_fma_f32 v243, v6, v242, -v241
    v_cvt_pk_bf16_f32 v191, v242, v243
    v_add_u32 v240, 224, v1
    v_mul_u32_u24 v240, v240, v5
    v_cvt_f32_u32 v240, v240
    v_mul_f32 v240, s24, v240
    v_fract_f32 v240, v240
    v_add_f32 v240, v240, v7
    v_cos_f32 v240, v240
    v_add_u32 v241, 225, v1
    v_mul_u32_u24 v241, v241, v5
    v_cvt_f32_u32 v241, v241
    v_mul_f32 v241, s24, v241
    v_fract_f32 v241, v241
    v_add_f32 v241, v241, v7
    v_cos_f32 v241, v241
    s_nop 0
    v_cvt_pk_bf16_f32 v192, v240, v241
    v_fma_f32 v242, v6, v241, -v240
    v_fma_f32 v243, v6, v242, -v241
    v_cvt_pk_bf16_f32 v193, v242, v243
    v_fma_f32 v240, v6, v243, -v242
    v_fma_f32 v241, v6, v240, -v243
    v_cvt_pk_bf16_f32 v194, v240, v241
    v_fma_f32 v242, v6, v241, -v240
    v_fma_f32 v243, v6, v242, -v241
    v_cvt_pk_bf16_f32 v195, v242, v243
    v_fma_f32 v240, v6, v243, -v242
    v_fma_f32 v241, v6, v240, -v243
    v_cvt_pk_bf16_f32 v196, v240, v241
    v_fma_f32 v242, v6, v241, -v240
    v_fma_f32 v243, v6, v242, -v241
    v_cvt_pk_bf16_f32 v197, v242, v243
    v_fma_f32 v240, v6, v243, -v242
    v_fma_f32 v241, v6, v240, -v243
    v_cvt_pk_bf16_f32 v198, v240, v241
    v_fma_f32 v242, v6, v241, -v240
    v_fma_f32 v243, v6, v242, -v241
    v_cvt_pk_bf16_f32 v199, v242, v243
    v_fma_f32 v240, v6, v243, -v242
    v_fma_f32 v241, v6, v240, -v243
    v_cvt_pk_bf16_f32 v200, v240, v241
    v_fma_f32 v242, v6, v241, -v240
    v_fma_f32 v243, v6, v242, -v241
    v_cvt_pk_bf16_f32 v201, v242, v243
    v_fma_f32 v240, v6, v243, -v242
    v_fma_f32 v241, v6, v240, -v243
    v_cvt_pk_bf16_f32 v202, v240, v241
    v_fma_f32 v242, v6, v241, -v240
    v_fma_f32 v243, v6, v242, -v241
    v_cvt_pk_bf16_f32 v203, v242, v243
    v_fma_f32 v240, v6, v243, -v242
    v_fma_f32 v241, v6, v240, -v243
    v_cvt_pk_bf16_f32 v204, v240, v241
    v_fma_f32 v242, v6, v241, -v240
    v_fma_f32 v243, v6, v242, -v241
    v_cvt_pk_bf16_f32 v205, v242, v243
    v_fma_f32 v240, v6, v243, -v242
    v_fma_f32 v241, v6, v240, -v243
    v_cvt_pk_bf16_f32 v206, v240, v241
    v_fma_f32 v242, v6, v241, -v240
    v_fma_f32 v243, v6, v242, -v241
    v_cvt_pk_bf16_f32 v207, v242, v243
    v_add_u32 v240, 256, v1
    v_mul_u32_u24 v240, v240, v5
    v_cvt_f32_u32 v240, v240
    v_mul_f32 v240, s24, v240
    v_fract_f32 v240, v240
    v_add_f32 v240, v240, v7
    v_cos_f32 v240, v240
    v_add_u32 v241, 257, v1
    v_mul_u32_u24 v241, v241, v5
    v_cvt_f32_u32 v241, v241
    v_mul_f32 v241, s24, v241
    v_fract_f32 v241, v241
    v_add_f32 v241, v241, v7
    v_cos_f32 v241, v241
    s_nop 0
    v_cvt_pk_bf16_f32 v208, v240, v241
    v_fma_f32 v242, v6, v241, -v240
    v_fma_f32 v243, v6, v242, -v241
    v_cvt_pk_bf16_f32 v209, v242, v243
    v_fma_f32 v240, v6, v243, -v242
    v_fma_f32 v241, v6, v240, -v243
    v_cvt_pk_bf16_f32 v210, v240, v241
    v_fma_f32 v242, v6, v241, -v240
    v_fma_f32 v243, v6, v242, -v241
    v_cvt_pk_bf16_f32 v211, v242, v243
    v_fma_f32 v240, v6, v243, -v242
    v_fma_f32 v241, v6, v240, -v243
    v_cvt_pk_bf16_f32 v212, v240, v241
    v_fma_f32 v242, v6, v241, -v240
    v_fma_f32 v243, v6, v242, -v241
    v_cvt_pk_bf16_f32 v213, v242, v243
    v_fma_f32 v240, v6, v243, -v242
    v_fma_f32 v241, v6, v240, -v243
    v_cvt_pk_bf16_f32 v214, v240, v241
    v_fma_f32 v242, v6, v241, -v240
    v_fma_f32 v243, v6, v242, -v241
    v_cvt_pk_bf16_f32 v215, v242, v243
    v_fma_f32 v240, v6, v243, -v242
    v_fma_f32 v241, v6, v240, -v243
    v_cvt_pk_bf16_f32 v216, v240, v241
    v_fma_f32 v242, v6, v241, -v240
    v_fma_f32 v243, v6, v242, -v241
    v_cvt_pk_bf16_f32 v217, v242, v243
    v_fma_f32 v240, v6, v243, -v242
    v_fma_f32 v241, v6, v240, -v243
    v_cvt_pk_bf16_f32 v218, v240, v241
    v_fma_f32 v242, v6, v241, -v240
    v_fma_f32 v243, v6, v242, -v241
    v_cvt_pk_bf16_f32 v219, v242, v243
    v_fma_f32 v240, v6, v243, -v242
    v_fma_f32 v241, v6, v240, -v243
    v_cvt_pk_bf16_f32 v220, v240, v241
    v_fma_f32 v242, v6, v241, -v240
    v_fma_f32 v243, v6, v242, -v241
    v_cvt_pk_bf16_f32 v221, v242, v243
    v_fma_f32 v240, v6, v243, -v242
    v_fma_f32 v241, v6, v240, -v243
    v_cvt_pk_bf16_f32 v222, v240, v241
    v_fma_f32 v242, v6, v241, -v240
    v_fma_f32 v243, v6, v242, -v241
    v_cvt_pk_bf16_f32 v223, v242, v243
    s_waitcnt vmcnt(0)
    v_mul_u32_u24 v1, 48, v3
    v_lshlrev_b32 v4, 2, v2
    s_lshl_b32 s24, s20, 3
    v_add3_u32 v4, v1, v4, s24
    v_mov_b32 v248, 0x3f803f80
    v_dot2_f32_bf16 v240, v8, v248, 0
    v_dot2_f32_bf16 v241, v9, v248, 0
    v_dot2_f32_bf16 v242, v10, v248, 0
    v_dot2_f32_bf16 v243, v11, v248, 0
    v_dot2_f32_bf16 v240, v12, v248, v240
    v_dot2_f32_bf16 v241, v13, v248, v241
    v_dot2_f32_bf16 v242, v14, v248, v242
    v_dot2_f32_bf16 v243, v15, v248, v243
    v_dot2_f32_bf16 v240, v16, v248, v240
    v_dot2_f32_bf16 v241, v17, v248, v241
    v_dot2_f32_bf16 v242, v18, v248, v242
    v_dot2_f32_bf16 v243, v19, v248, v243
    v_dot2_f32_bf16 v240, v20, v248, v240
    v_dot2_f32_bf16 v241, v21, v248, v241
    v_dot2_f32_bf16 v242, v22, v248, v242
    v_dot2_f32_bf16 v243, v23, v248, v243
    v_dot2_f32_bf16 v240, v24, v248, v240
    v_dot2_f32_bf16 v241, v25, v248, v241
    v_dot2_f32_bf16 v242, v26, v248, v242
    v_dot2_f32_bf16 v243, v27, v248, v243
    v_dot2_f32_bf16 v240, v28, v248, v240
    v_dot2_f32_bf16 v241, v29, v248, v241
    v_dot2_f32_bf16 v242, v30, v248, v242
    v_dot2_f32_bf16 v243, v31, v248, v243
    s_nop 4
    v_add_f32 v240, v240, v241
    v_add_f32 v242, v242, v243
    v_add_f32 v240, v240, v242
    ds_write_b32 v4, v240
    v_lshlrev_b32 v32, 16, v8
    v_and_b32 v33, 0xffff0000, v8
    v_lshlrev_b32 v34, 16, v9
    v_and_b32 v35, 0xffff0000, v9
    v_lshlrev_b32 v36, 16, v10
    v_and_b32 v37, 0xffff0000, v10
    v_lshlrev_b32 v38, 16, v11
    v_and_b32 v39, 0xffff0000, v11
    v_lshlrev_b32 v40, 16, v12
    v_and_b32 v41, 0xffff0000, v12
    v_lshlrev_b32 v42, 16, v13
    v_and_b32 v43, 0xffff0000, v13
    v_lshlrev_b32 v44, 16, v14
    v_and_b32 v45, 0xffff0000, v14
    v_lshlrev_b32 v46, 16, v15
    v_and_b32 v47, 0xffff0000, v15
    v_lshlrev_b32 v48, 16, v16
    v_and_b32 v49, 0xffff0000, v16
    v_lshlrev_b32 v50, 16, v17
    v_and_b32 v51, 0xffff0000, v17
    v_lshlrev_b32 v52, 16, v18
    v_and_b32 v53, 0xffff0000, v18
    v_lshlrev_b32 v54, 16, v19
    v_and_b32 v55, 0xffff0000, v19
    v_lshlrev_b32 v56, 16, v20
    v_and_b32 v57, 0xffff0000, v20
    v_lshlrev_b32 v58, 16, v21
    v_and_b32 v59, 0xffff0000, v21
    v_lshlrev_b32 v60, 16, v22
    v_and_b32 v61, 0xffff0000, v22
    v_lshlrev_b32 v62, 16, v23
    v_and_b32 v63, 0xffff0000, v23
    v_lshlrev_b32 v64, 16, v24
    v_and_b32 v65, 0xffff0000, v24
    v_lshlrev_b32 v66, 16, v25
    v_and_b32 v67, 0xffff0000, v25
    v_lshlrev_b32 v68, 16, v26
    v_and_b32 v69, 0xffff0000, v26
    v_lshlrev_b32 v70, 16, v27
    v_and_b32 v71, 0xffff0000, v27
    v_lshlrev_b32 v72, 16, v28
    v_and_b32 v73, 0xffff0000, v28
    v_lshlrev_b32 v74, 16, v29
    v_and_b32 v75, 0xffff0000, v29
    v_lshlrev_b32 v76, 16, v30
    v_and_b32 v77, 0xffff0000, v30
    v_lshlrev_b32 v78, 16, v31
    v_and_b32 v79, 0xffff0000, v31
    s_waitcnt lgkmcnt(0)
    s_barrier
    ds_read_b128 v[8:11], v1 offset:0
    ds_read_b128 v[12:15], v1 offset:16
    ds_read_b128 v[16:19], v1 offset:32
    s_waitcnt lgkmcnt(0)
    v_add_f32 v8, v8, v12
    v_add_f32 v9, v9, v13
    v_add_f32 v10, v10, v14
    v_add_f32 v11, v11, v15
    v_add_f32 v8, v8, v16
    v_add_f32 v9, v9, v17
    v_add_f32 v10, v10, v18
    v_add_f32 v11, v11, v19
    v_add_f32 v8, v8, v9
    v_add_f32 v10, v10, v11
    v_add_f32 v244, v8, v10
    v_mul_f32 v244, 0x3ae38e39, v244
    v_mov_b32 v240, 0
    v_mov_b32 v241, 0
    v_mov_b32 v242, 0
    v_mov_b32 v243, 0
    v_pk_add_f32 v[248:249], v[32:33], v[244:245] op_sel:[0,0] op_sel_hi:[1,0] neg_lo:[0,1] neg_hi:[0,1]
    v_pk_add_f32 v[250:251], v[34:35], v[244:245] op_sel:[0,0] op_sel_hi:[1,0] neg_lo:[0,1] neg_hi:[0,1]
    v_pk_fma_f32 v[240:241], v[248:249], v[248:249], v[240:241]
    v_pk_add_f32 v[252:253], v[36:37], v[244:245] op_sel:[0,0] op_sel_hi:[1,0] neg_lo:[0,1] neg_hi:[0,1]
    v_pk_fma_f32 v[242:243], v[250:251], v[250:251], v[242:243]
    v_pk_add_f32 v[254:255], v[38:39], v[244:245] op_sel:[0,0] op_sel_hi:[1,0] neg_lo:[0,1] neg_hi:[0,1]
    v_pk_fma_f32 v[240:241], v[252:253], v[252:253], v[240:241]
    v_pk_add_f32 v[248:249], v[40:41], v[244:245] op_sel:[0,0] op_sel_hi:[1,0] neg_lo:[0,1] neg_hi:[0,1]
    v_pk_fma_f32 v[242:243], v[254:255], v[254:255], v[242:243]
    v_pk_add_f32 v[250:251], v[42:43], v[244:245] op_sel:[0,0] op_sel_hi:[1,0] neg_lo:[0,1] neg_hi:[0,1]
    v_pk_fma_f32 v[240:241], v[248:249], v[248:249], v[240:241]
    v_pk_add_f32 v[252:253], v[44:45], v[244:245] op_sel:[0,0] op_sel_hi:[1,0] neg_lo:[0,1] neg_hi:[0,1]
    v_pk_fma_f32 v[242:243], v[250:251], v[250:251], v[242:243]
    v_pk_add_f32 v[254:255], v[46:47], v[244:245] op_sel:[0,0] op_sel_hi:[1,0] neg_lo:[0,1] neg_hi:[0,1]
    v_pk_fma_f32 v[240:241], v[252:253], v[252:253], v[240:241]
    v_pk_add_f32 v[248:249], v[48:49], v[244:245] op_sel:[0,0] op_sel_hi:[1,0] neg_lo:[0,1] neg_hi:[0,1]
    v_pk_fma_f32 v[242:243], v[254:255], v[254:255], v[242:243]
    v_pk_add_f32 v[250:251], v[50:51], v[244:245] op_sel:[0,0] op_sel_hi:[1,0] neg_lo:[0,1] neg_hi:[0,1]
    v_pk_fma_f32 v[240:241], v[248:249], v[248:249], v[240:241]
    v_pk_add_f32 v[252:253], v[52:53], v[244:245] op_sel:[0,0] op_sel_hi:[1,0] neg_lo:[0,1] neg_hi:[0,1]
    v_pk_fma_f32 v[242:243], v[250:251], v[250:251], v[242:243]
    v_pk_add_f32 v[254:255], v[54:55], v[244:245] op_sel:[0,0] op_sel_hi:[1,0] neg_lo:[0,1] neg_hi:[0,1]
    v_pk_fma_f32 v[240:241], v[252:253], v[252:253], v[240:241]
    v_pk_add_f32 v[248:249], v[56:57], v[244:245] op_sel:[0,0] op_sel_hi:[1,0] neg_lo:[0,1] neg_hi:[0,1]
    v_pk_fma_f32 v[242:243], v[254:255], v[254:255], v[242:243]
    v_pk_add_f32 v[250:251], v[58:59], v[244:245] op_sel:[0,0] op_sel_hi:[1,0] neg_lo:[0,1] neg_hi:[0,1]
    v_pk_fma_f32 v[240:241], v[248:249], v[248:249], v[240:241]
    v_pk_add_f32 v[252:253], v[60:61], v[244:245] op_sel:[0,0] op_sel_hi:[1,0] neg_lo:[0,1] neg_hi:[0,1]
    v_pk_fma_f32 v[242:243], v[250:251], v[250:251], v[242:243]
    v_pk_add_f32 v[254:255], v[62:63], v[244:245] op_sel:[0,0] op_sel_hi:[1,0] neg_lo:[0,1] neg_hi:[0,1]
    v_pk_fma_f32 v[240:241], v[252:253], v[252:253], v[240:241]
    v_pk_add_f32 v[248:249], v[64:65], v[244:245] op_sel:[0,0] op_sel_hi:[1,0] neg_lo:[0,1] neg_hi:[0,1]
    v_pk_fma_f32 v[242:243], v[254:255], v[254:255], v[242:243]
    v_pk_add_f32 v[250:251], v[66:67], v[244:245] op_sel:[0,0] op_sel_hi:[1,0] neg_lo:[0,1] neg_hi:[0,1]
    v_pk_fma_f32 v[240:241], v[248:249], v[248:249], v[240:241]
    v_pk_add_f32 v[252:253], v[68:69], v[244:245] op_sel:[0,0] op_sel_hi:[1,0] neg_lo:[0,1] neg_hi:[0,1]
    v_pk_fma_f32 v[242:243], v[250:251], v[250:251], v[242:243]
    v_pk_add_f32 v[254:255], v[70:71], v[244:245] op_sel:[0,0] op_sel_hi:[1,0] neg_lo:[0,1] neg_hi:[0,1]
    v_pk_fma_f32 v[240:241], v[252:253], v[252:253], v[240:241]
    v_pk_add_f32 v[248:249], v[72:73], v[244:245] op_sel:[0,0] op_sel_hi:[1,0] neg_lo:[0,1] neg_hi:[0,1]
    v_pk_fma_f32 v[242:243], v[254:255], v[254:255], v[242:243]
    v_pk_add_f32 v[250:251], v[74:75], v[244:245] op_sel:[0,0] op_sel_hi:[1,0] neg_lo:[0,1] neg_hi:[0,1]
    v_pk_fma_f32 v[240:241], v[248:249], v[248:249], v[240:241]
    v_pk_add_f32 v[252:253], v[76:77], v[244:245] op_sel:[0,0] op_sel_hi:[1,0] neg_lo:[0,1] neg_hi:[0,1]
    v_pk_fma_f32 v[242:243], v[250:251], v[250:251], v[242:243]
    v_pk_add_f32 v[254:255], v[78:79], v[244:245] op_sel:[0,0] op_sel_hi:[1,0] neg_lo:[0,1] neg_hi:[0,1]
    v_pk_fma_f32 v[240:241], v[252:253], v[252:253], v[240:241]
    v_pk_fma_f32 v[242:243], v[254:255], v[254:255], v[242:243]
    v_add_f32 v240, v240, v241
    v_add_f32 v242, v242, v243
    v_add_f32 v240, v240, v242
    ds_write_b32 v4, v240 offset:2048
    s_waitcnt lgkmcnt(0)
    s_barrier
    ds_read_b128 v[8:11], v1 offset:2048
    ds_read_b128 v[12:15], v1 offset:2064
    ds_read_b128 v[16:19], v1 offset:2080
    s_waitcnt lgkmcnt(0)
    v_add_f32 v8, v8, v12
    v_add_f32 v9, v9, v13
    v_add_f32 v10, v10, v14
    v_add_f32 v11, v11, v15
    v_add_f32 v8, v8, v16
    v_add_f32 v9, v9, v17
    v_add_f32 v10, v10, v18
    v_add_f32 v11, v11, v19
    v_add_f32 v8, v8, v9
    v_add_f32 v10, v10, v11
    v_add_f32 v245, v8, v10
    v_mul_f32 v245, 0x3ae38e39, v245
    v_cvt_pk_bf16_f32 v246, v244, v245
    v_lshlrev_b32 v244, 16, v246
    v_and_b32 v245, 0xffff0000, v246
    v_add_f32 v245, 0x3727c5ac, v245
    v_cvt_pk_bf16_f32 v245, v245, v245
    v_lshlrev_b32 v245, 16, v245
    v_sqrt_f32 v245, v245
    s_nop 0
    v_cvt_pk_bf16_f32 v245, v245, v245
    v_lshlrev_b32 v245, 16, v245
    v_rcp_f32 v246, v245
    s_nop 0
    v_pk_add_f32 v[32:33], v[32:33], v[244:245] op_sel:[0,0] op_sel_hi:[1,0] neg_lo:[0,1] neg_hi:[0,1]
    v_cvt_pk_bf16_f32 v33, v32, v33
    v_lshlrev_b32 v32, 16, v33
    v_and_b32 v33, 0xffff0000, v33
    v_pk_mul_f32 v[32:33], v[32:33], v[246:247] op_sel:[0,0] op_sel_hi:[1,0]
    v_cvt_pk_bf16_f32 v8, v32, v33
    v_pk_add_f32 v[34:35], v[34:35], v[244:245] op_sel:[0,0] op_sel_hi:[1,0] neg_lo:[0,1] neg_hi:[0,1]
    v_cvt_pk_bf16_f32 v35, v34, v35
    v_lshlrev_b32 v34, 16, v35
    v_and_b32 v35, 0xffff0000, v35
    v_pk_mul_f32 v[34:35], v[34:35], v[246:247] op_sel:[0,0] op_sel_hi:[1,0]
    v_cvt_pk_bf16_f32 v9, v34, v35
    v_pk_add_f32 v[36:37], v[36:37], v[244:245] op_sel:[0,0] op_sel_hi:[1,0] neg_lo:[0,1] neg_hi:[0,1]
    v_cvt_pk_bf16_f32 v37, v36, v37
    v_lshlrev_b32 v36, 16, v37
    v_and_b32 v37, 0xffff0000, v37
    v_pk_mul_f32 v[36:37], v[36:37], v[246:247] op_sel:[0,0] op_sel_hi:[1,0]
    v_cvt_pk_bf16_f32 v10, v36, v37
    v_pk_add_f32 v[38:39], v[38:39], v[244:245] op_sel:[0,0] op_sel_hi:[1,0] neg_lo:[0,1] neg_hi:[0,1]
    v_cvt_pk_bf16_f32 v39, v38, v39
    v_lshlrev_b32 v38, 16, v39
    v_and_b32 v39, 0xffff0000, v39
    v_pk_mul_f32 v[38:39], v[38:39], v[246:247] op_sel:[0,0] op_sel_hi:[1,0]
    v_cvt_pk_bf16_f32 v11, v38, v39
    v_pk_add_f32 v[40:41], v[40:41], v[244:245] op_sel:[0,0] op_sel_hi:[1,0] neg_lo:[0,1] neg_hi:[0,1]
    v_cvt_pk_bf16_f32 v41, v40, v41
    v_lshlrev_b32 v40, 16, v41
    v_and_b32 v41, 0xffff0000, v41
    v_pk_mul_f32 v[40:41], v[40:41], v[246:247] op_sel:[0,0] op_sel_hi:[1,0]
    v_cvt_pk_bf16_f32 v12, v40, v41
    v_pk_add_f32 v[42:43], v[42:43], v[244:245] op_sel:[0,0] op_sel_hi:[1,0] neg_lo:[0,1] neg_hi:[0,1]
    v_cvt_pk_bf16_f32 v43, v42, v43
    v_lshlrev_b32 v42, 16, v43
    v_and_b32 v43, 0xffff0000, v43
    v_pk_mul_f32 v[42:43], v[42:43], v[246:247] op_sel:[0,0] op_sel_hi:[1,0]
    v_cvt_pk_bf16_f32 v13, v42, v43
    v_pk_add_f32 v[44:45], v[44:45], v[244:245] op_sel:[0,0] op_sel_hi:[1,0] neg_lo:[0,1] neg_hi:[0,1]
    v_cvt_pk_bf16_f32 v45, v44, v45
    v_lshlrev_b32 v44, 16, v45
    v_and_b32 v45, 0xffff0000, v45
    v_pk_mul_f32 v[44:45], v[44:45], v[246:247] op_sel:[0,0] op_sel_hi:[1,0]
    v_cvt_pk_bf16_f32 v14, v44, v45
    v_pk_add_f32 v[46:47], v[46:47], v[244:245] op_sel:[0,0] op_sel_hi:[1,0] neg_lo:[0,1] neg_hi:[0,1]
    v_cvt_pk_bf16_f32 v47, v46, v47
    v_lshlrev_b32 v46, 16, v47
    v_and_b32 v47, 0xffff0000, v47
    v_pk_mul_f32 v[46:47], v[46:47], v[246:247] op_sel:[0,0] op_sel_hi:[1,0]
    v_cvt_pk_bf16_f32 v15, v46, v47
    v_pk_add_f32 v[48:49], v[48:49], v[244:245] op_sel:[0,0] op_sel_hi:[1,0] neg_lo:[0,1] neg_hi:[0,1]
    v_cvt_pk_bf16_f32 v49, v48, v49
    v_lshlrev_b32 v48, 16, v49
    v_and_b32 v49, 0xffff0000, v49
    v_pk_mul_f32 v[48:49], v[48:49], v[246:247] op_sel:[0,0] op_sel_hi:[1,0]
    v_cvt_pk_bf16_f32 v16, v48, v49
    v_pk_add_f32 v[50:51], v[50:51], v[244:245] op_sel:[0,0] op_sel_hi:[1,0] neg_lo:[0,1] neg_hi:[0,1]
    v_cvt_pk_bf16_f32 v51, v50, v51
    v_lshlrev_b32 v50, 16, v51
    v_and_b32 v51, 0xffff0000, v51
    v_pk_mul_f32 v[50:51], v[50:51], v[246:247] op_sel:[0,0] op_sel_hi:[1,0]
    v_cvt_pk_bf16_f32 v17, v50, v51
    v_pk_add_f32 v[52:53], v[52:53], v[244:245] op_sel:[0,0] op_sel_hi:[1,0] neg_lo:[0,1] neg_hi:[0,1]
    v_cvt_pk_bf16_f32 v53, v52, v53
    v_lshlrev_b32 v52, 16, v53
    v_and_b32 v53, 0xffff0000, v53
    v_pk_mul_f32 v[52:53], v[52:53], v[246:247] op_sel:[0,0] op_sel_hi:[1,0]
    v_cvt_pk_bf16_f32 v18, v52, v53
    v_pk_add_f32 v[54:55], v[54:55], v[244:245] op_sel:[0,0] op_sel_hi:[1,0] neg_lo:[0,1] neg_hi:[0,1]
    v_cvt_pk_bf16_f32 v55, v54, v55
    v_lshlrev_b32 v54, 16, v55
    v_and_b32 v55, 0xffff0000, v55
    v_pk_mul_f32 v[54:55], v[54:55], v[246:247] op_sel:[0,0] op_sel_hi:[1,0]
    v_cvt_pk_bf16_f32 v19, v54, v55
    v_pk_add_f32 v[56:57], v[56:57], v[244:245] op_sel:[0,0] op_sel_hi:[1,0] neg_lo:[0,1] neg_hi:[0,1]
    v_cvt_pk_bf16_f32 v57, v56, v57
    v_lshlrev_b32 v56, 16, v57
    v_and_b32 v57, 0xffff0000, v57
    v_pk_mul_f32 v[56:57], v[56:57], v[246:247] op_sel:[0,0] op_sel_hi:[1,0]
    v_cvt_pk_bf16_f32 v20, v56, v57
    v_pk_add_f32 v[58:59], v[58:59], v[244:245] op_sel:[0,0] op_sel_hi:[1,0] neg_lo:[0,1] neg_hi:[0,1]
    v_cvt_pk_bf16_f32 v59, v58, v59
    v_lshlrev_b32 v58, 16, v59
    v_and_b32 v59, 0xffff0000, v59
    v_pk_mul_f32 v[58:59], v[58:59], v[246:247] op_sel:[0,0] op_sel_hi:[1,0]
    v_cvt_pk_bf16_f32 v21, v58, v59
    v_pk_add_f32 v[60:61], v[60:61], v[244:245] op_sel:[0,0] op_sel_hi:[1,0] neg_lo:[0,1] neg_hi:[0,1]
    v_cvt_pk_bf16_f32 v61, v60, v61
    v_lshlrev_b32 v60, 16, v61
    v_and_b32 v61, 0xffff0000, v61
    v_pk_mul_f32 v[60:61], v[60:61], v[246:247] op_sel:[0,0] op_sel_hi:[1,0]
    v_cvt_pk_bf16_f32 v22, v60, v61
    v_pk_add_f32 v[62:63], v[62:63], v[244:245] op_sel:[0,0] op_sel_hi:[1,0] neg_lo:[0,1] neg_hi:[0,1]
    v_cvt_pk_bf16_f32 v63, v62, v63
    v_lshlrev_b32 v62, 16, v63
    v_and_b32 v63, 0xffff0000, v63
    v_pk_mul_f32 v[62:63], v[62:63], v[246:247] op_sel:[0,0] op_sel_hi:[1,0]
    v_cvt_pk_bf16_f32 v23, v62, v63
    v_pk_add_f32 v[64:65], v[64:65], v[244:245] op_sel:[0,0] op_sel_hi:[1,0] neg_lo:[0,1] neg_hi:[0,1]
    v_cvt_pk_bf16_f32 v65, v64, v65
    v_lshlrev_b32 v64, 16, v65
    v_and_b32 v65, 0xffff0000, v65
    v_pk_mul_f32 v[64:65], v[64:65], v[246:247] op_sel:[0,0] op_sel_hi:[1,0]
    v_cvt_pk_bf16_f32 v24, v64, v65
    v_pk_add_f32 v[66:67], v[66:67], v[244:245] op_sel:[0,0] op_sel_hi:[1,0] neg_lo:[0,1] neg_hi:[0,1]
    v_cvt_pk_bf16_f32 v67, v66, v67
    v_lshlrev_b32 v66, 16, v67
    v_and_b32 v67, 0xffff0000, v67
    v_pk_mul_f32 v[66:67], v[66:67], v[246:247] op_sel:[0,0] op_sel_hi:[1,0]
    v_cvt_pk_bf16_f32 v25, v66, v67
    v_pk_add_f32 v[68:69], v[68:69], v[244:245] op_sel:[0,0] op_sel_hi:[1,0] neg_lo:[0,1] neg_hi:[0,1]
    v_cvt_pk_bf16_f32 v69, v68, v69
    v_lshlrev_b32 v68, 16, v69
    v_and_b32 v69, 0xffff0000, v69
    v_pk_mul_f32 v[68:69], v[68:69], v[246:247] op_sel:[0,0] op_sel_hi:[1,0]
    v_cvt_pk_bf16_f32 v26, v68, v69
    v_pk_add_f32 v[70:71], v[70:71], v[244:245] op_sel:[0,0] op_sel_hi:[1,0] neg_lo:[0,1] neg_hi:[0,1]
    v_cvt_pk_bf16_f32 v71, v70, v71
    v_lshlrev_b32 v70, 16, v71
    v_and_b32 v71, 0xffff0000, v71
    v_pk_mul_f32 v[70:71], v[70:71], v[246:247] op_sel:[0,0] op_sel_hi:[1,0]
    v_cvt_pk_bf16_f32 v27, v70, v71
    v_pk_add_f32 v[72:73], v[72:73], v[244:245] op_sel:[0,0] op_sel_hi:[1,0] neg_lo:[0,1] neg_hi:[0,1]
    v_cvt_pk_bf16_f32 v73, v72, v73
    v_lshlrev_b32 v72, 16, v73
    v_and_b32 v73, 0xffff0000, v73
    v_pk_mul_f32 v[72:73], v[72:73], v[246:247] op_sel:[0,0] op_sel_hi:[1,0]
    v_cvt_pk_bf16_f32 v28, v72, v73
    v_pk_add_f32 v[74:75], v[74:75], v[244:245] op_sel:[0,0] op_sel_hi:[1,0] neg_lo:[0,1] neg_hi:[0,1]
    v_cvt_pk_bf16_f32 v75, v74, v75
    v_lshlrev_b32 v74, 16, v75
    v_and_b32 v75, 0xffff0000, v75
    v_pk_mul_f32 v[74:75], v[74:75], v[246:247] op_sel:[0,0] op_sel_hi:[1,0]
    v_cvt_pk_bf16_f32 v29, v74, v75
    v_pk_add_f32 v[76:77], v[76:77], v[244:245] op_sel:[0,0] op_sel_hi:[1,0] neg_lo:[0,1] neg_hi:[0,1]
    v_cvt_pk_bf16_f32 v77, v76, v77
    v_lshlrev_b32 v76, 16, v77
    v_and_b32 v77, 0xffff0000, v77
    v_pk_mul_f32 v[76:77], v[76:77], v[246:247] op_sel:[0,0] op_sel_hi:[1,0]
    v_cvt_pk_bf16_f32 v30, v76, v77
    v_pk_add_f32 v[78:79], v[78:79], v[244:245] op_sel:[0,0] op_sel_hi:[1,0] neg_lo:[0,1] neg_hi:[0,1]
    v_cvt_pk_bf16_f32 v79, v78, v79
    v_lshlrev_b32 v78, 16, v79
    v_and_b32 v79, 0xffff0000, v79
    v_pk_mul_f32 v[78:79], v[78:79], v[246:247] op_sel:[0,0] op_sel_hi:[1,0]
    v_cvt_pk_bf16_f32 v31, v78, v79
    v_lshlrev_b32 v4, 4, v0
    s_mul_i32 s24, s20, 6144
    s_add_u32 s25, s24, 4096
    v_add_u32 v1, s25, v4
    ds_write_b128 v1, v[8:11] offset:0
    ds_write_b128 v1, v[12:15] offset:1024
    ds_write_b128 v1, v[16:19] offset:2048
    ds_write_b128 v1, v[20:23] offset:3072
    ds_write_b128 v1, v[24:27] offset:4096
    ds_write_b128 v1, v[28:31] offset:5120
    s_cmp_lg_u32 s22, 0
    s_cbranch_scc1 Lprep_A2
    s_mov_b32 s12, s6
    s_mov_b32 s13, s7
    s_mov_b32 s14, 2359296
    s_mov_b32 s15, 0x00020000
    s_mul_i32 s25, s21, 36864
    s_add_u32 s25, s25, s24
    s_add_u32 s24, s25, 0
    buffer_store_dwordx4 v[8:11], v4, s[12:15], s24 offen nt
    s_add_u32 s24, s25, 1024
    buffer_store_dwordx4 v[12:15], v4, s[12:15], s24 offen nt
    s_add_u32 s24, s25, 2048
    buffer_store_dwordx4 v[16:19], v4, s[12:15], s24 offen nt
    s_add_u32 s24, s25, 3072
    buffer_store_dwordx4 v[20:23], v4, s[12:15], s24 offen nt
    s_add_u32 s24, s25, 4096
    buffer_store_dwordx4 v[24:27], v4, s[12:15], s24 offen nt
    s_add_u32 s24, s25, 5120
    buffer_store_dwordx4 v[28:31], v4, s[12:15], s24 offen nt
Lprep_A2:
    v_mov_b32 v224, 0
    v_mov_b32 v225, 0
    v_mov_b32 v226, 0
    v_mov_b32 v227, 0
    v_mov_b32 v228, 0
    v_mov_b32 v229, 0
    v_mov_b32 v230, 0
    v_mov_b32 v231, 0
    v_mov_b32 v232, 0
    v_mov_b32 v233, 0
    v_mov_b32 v234, 0
    v_mov_b32 v235, 0
    v_mov_b32 v236, 0
    v_mov_b32 v237, 0
    v_mov_b32 v238, 0
    v_mov_b32 v239, 0
    s_waitcnt lgkmcnt(0)
    s_barrier
    v_add_u32 v1, 4096, v4
    ds_read_b128 v[32:35], v1 offset:0
    ds_read_b128 v[36:39], v1 offset:1024
    ds_read_b128 v[40:43], v1 offset:2048
    ds_read_b128 v[44:47], v1 offset:3072
    ds_read_b128 v[48:51], v1 offset:4096
    ds_read_b128 v[52:55], v1 offset:5120
    ds_read_b128 v[56:59], v1 offset:6144
    ds_read_b128 v[60:63], v1 offset:7168
    ds_read_b128 v[64:67], v1 offset:8192
    ds_read_b128 v[68:71], v1 offset:9216
    ds_read_b128 v[72:75], v1 offset:10240
    ds_read_b128 v[76:79], v1 offset:11264
    s_waitcnt lgkmcnt(11)
    v_mfma_f32_32x32x16_bf16 v[224:239], v[32:35], v[80:83], v[224:239]
    s_waitcnt lgkmcnt(10)
    v_mfma_f32_32x32x16_bf16 v[224:239], v[36:39], v[84:87], v[224:239]
    ds_read_b128 v[32:35], v1 offset:12288
    s_waitcnt lgkmcnt(10)
    v_mfma_f32_32x32x16_bf16 v[224:239], v[40:43], v[88:91], v[224:239]
    ds_read_b128 v[36:39], v1 offset:13312
    s_waitcnt lgkmcnt(10)
    v_mfma_f32_32x32x16_bf16 v[224:239], v[44:47], v[92:95], v[224:239]
    ds_read_b128 v[40:43], v1 offset:14336
    s_waitcnt lgkmcnt(10)
    v_mfma_f32_32x32x16_bf16 v[224:239], v[48:51], v[96:99], v[224:239]
    ds_read_b128 v[44:47], v1 offset:15360
    s_waitcnt lgkmcnt(10)
    v_mfma_f32_32x32x16_bf16 v[224:239], v[52:55], v[100:103], v[224:239]
    ds_read_b128 v[48:51], v1 offset:16384
    s_waitcnt lgkmcnt(10)
    v_mfma_f32_32x32x16_bf16 v[224:239], v[56:59], v[104:107], v[224:239]
    ds_read_b128 v[52:55], v1 offset:17408
    s_waitcnt lgkmcnt(10)
    v_mfma_f32_32x32x16_bf16 v[224:239], v[60:63], v[108:111], v[224:239]
    ds_read_b128 v[56:59], v1 offset:18432
    s_waitcnt lgkmcnt(10)
    v_mfma_f32_32x32x16_bf16 v[224:239], v[64:67], v[112:115], v[224:239]
    ds_read_b128 v[60:63], v1 offset:19456
    s_waitcnt lgkmcnt(10)
    v_mfma_f32_32x32x16_bf16 v[224:239], v[68:71], v[116:119], v[224:239]
    ds_read_b128 v[64:67], v1 offset:20480
    s_waitcnt lgkmcnt(10)
    v_mfma_f32_32x32x16_bf16 v[224:239], v[72:75], v[120:123], v[224:239]
    ds_read_b128 v[68:71], v1 offset:21504
    s_waitcnt lgkmcnt(10)
    v_mfma_f32_32x32x16_bf16 v[224:239], v[76:79], v[124:127], v[224:239]
    ds_read_b128 v[72:75], v1 offset:22528
    s_waitcnt lgkmcnt(10)
    v_mfma_f32_32x32x16_bf16 v[224:239], v[32:35], v[128:131], v[224:239]
    ds_read_b128 v[76:79], v1 offset:23552
    s_waitcnt lgkmcnt(10)
    v_mfma_f32_32x32x16_bf16 v[224:239], v[36:39], v[132:135], v[224:239]
    ds_read_b128 v[32:35], v1 offset:24576
    s_waitcnt lgkmcnt(10)
    v_mfma_f32_32x32x16_bf16 v[224:239], v[40:43], v[136:139], v[224:239]
    ds_read_b128 v[36:39], v1 offset:25600
    s_waitcnt lgkmcnt(10)
    v_mfma_f32_32x32x16_bf16 v[224:239], v[44:47], v[140:143], v[224:239]
    ds_read_b128 v[40:43], v1 offset:26624
    s_waitcnt lgkmcnt(10)
    v_mfma_f32_32x32x16_bf16 v[224:239], v[48:51], v[144:147], v[224:239]
    ds_read_b128 v[44:47], v1 offset:27648
    s_waitcnt lgkmcnt(10)
    v_mfma_f32_32x32x16_bf16 v[224:239], v[52:55], v[148:151], v[224:239]
    ds_read_b128 v[48:51], v1 offset:28672
    s_waitcnt lgkmcnt(10)
    v_mfma_f32_32x32x16_bf16 v[224:239], v[56:59], v[152:155], v[224:239]
    ds_read_b128 v[52:55], v1 offset:29696
    s_waitcnt lgkmcnt(10)
    v_mfma_f32_32x32x16_bf16 v[224:239], v[60:63], v[156:159], v[224:239]
    ds_read_b128 v[56:59], v1 offset:30720
    s_waitcnt lgkmcnt(10)
    v_mfma_f32_32x32x16_bf16 v[224:239], v[64:67], v[160:163], v[224:239]
    ds_read_b128 v[60:63], v1 offset:31744
    s_waitcnt lgkmcnt(10)
    v_mfma_f32_32x32x16_bf16 v[224:239], v[68:71], v[164:167], v[224:239]
    ds_read_b128 v[64:67], v1 offset:32768
    s_waitcnt lgkmcnt(10)
    v_mfma_f32_32x32x16_bf16 v[224:239], v[72:75], v[168:171], v[224:239]
    ds_read_b128 v[68:71], v1 offset:33792
    s_waitcnt lgkmcnt(10)
    v_mfma_f32_32x32x16_bf16 v[224:239], v[76:79], v[172:175], v[224:239]
    ds_read_b128 v[72:75], v1 offset:34816
    s_waitcnt lgkmcnt(10)
    v_mfma_f32_32x32x16_bf16 v[224:239], v[32:35], v[176:179], v[224:239]
    ds_read_b128 v[76:79], v1 offset:35840
    s_waitcnt lgkmcnt(10)
    v_mfma_f32_32x32x16_bf16 v[224:239], v[36:39], v[180:183], v[224:239]
    s_waitcnt lgkmcnt(9)
    v_mfma_f32_32x32x16_bf16 v[224:239], v[40:43], v[184:187], v[224:239]
    s_waitcnt lgkmcnt(8)
    v_mfma_f32_32x32x16_bf16 v[224:239], v[44:47], v[188:191], v[224:239]
    s_waitcnt lgkmcnt(7)
    v_mfma_f32_32x32x16_bf16 v[224:239], v[48:51], v[192:195], v[224:239]
    s_waitcnt lgkmcnt(6)
    v_mfma_f32_32x32x16_bf16 v[224:239], v[52:55], v[196:199], v[224:239]
    s_waitcnt lgkmcnt(5)
    v_mfma_f32_32x32x16_bf16 v[224:239], v[56:59], v[200:203], v[224:239]
    s_waitcnt lgkmcnt(4)
    v_mfma_f32_32x32x16_bf16 v[224:239], v[60:63], v[204:207], v[224:239]
    s_waitcnt lgkmcnt(3)
    v_mfma_f32_32x32x16_bf16 v[224:239], v[64:67], v[208:211], v[224:239]
    s_waitcnt lgkmcnt(2)
    v_mfma_f32_32x32x16_bf16 v[224:239], v[68:71], v[212:215], v[224:239]
    s_waitcnt lgkmcnt(1)
    v_mfma_f32_32x32x16_bf16 v[224:239], v[72:75], v[216:219], v[224:239]
    s_waitcnt lgkmcnt(0)
    v_mfma_f32_32x32x16_bf16 v[224:239], v[76:79], v[220:223], v[224:239]
    s_nop 7
    s_nop 7
    v_cvt_pk_bf16_f32 v8, v224, v225
    v_cvt_pk_bf16_f32 v9, v226, v227
    v_cvt_pk_bf16_f32 v12, v228, v229
    v_cvt_pk_bf16_f32 v13, v230, v231
    v_cvt_pk_bf16_f32 v10, v232, v233
    v_cvt_pk_bf16_f32 v11, v234, v235
    v_cvt_pk_bf16_f32 v14, v236, v237
    v_cvt_pk_bf16_f32 v15, v238, v239
    s_nop 1
    v_permlane32_swap_b32 v8, v10
    v_permlane32_swap_b32 v9, v11
    v_permlane32_swap_b32 v12, v14
    v_permlane32_swap_b32 v13, v15
    s_add_u32 s12, s6, 2359296
    s_addc_u32 s13, s7, 0
    s_mov_b32 s14, 2359296
    s_mov_b32 s15, 0x00020000
    v_and_b32 v5, 15, v0
    s_lshl_b32 s24, s23, 4
    v_add_u32 v5, s24, v5
    v_bfe_u32 v6, v0, 4, 1
    v_lshl_add_u32 v5, v5, 1, v6
    v_lshlrev_b32 v5, 12, v5
    v_lshl_add_u32 v5, v2, 5, v5
    s_lshl_b32 s24, s21, 6
    buffer_store_dwordx4 v[8:11], v5, s[12:15], s24 offen offset:0
    buffer_store_dwordx4 v[12:15], v5, s[12:15], s24 offen offset:16
    s_waitcnt vmcnt(0)
    s_waitcnt vmcnt(0)
    s_endpgm
Lprep_B:
    s_sub_u32 s21, s2, 192
    s_mul_i32 s21, s21, 6
    s_add_u32 s40, s21, s20
    s_add_u32 s41, s40, 312
    s_waitcnt lgkmcnt(0)
    s_mov_b32 s12, s8
    s_mov_b32 s13, s9
    s_mov_b32 s14, 1183744
    s_mov_b32 s15, 0x00020000
    s_mov_b32 s16, s10
    s_mov_b32 s17, s11
    s_mov_b32 s18, 1183744
    s_mov_b32 s19, 0x00020000
    s_add_u32 s28, s6, 7741440
    s_addc_u32 s29, s7, 0
    s_mov_b32 s30, 2367488
    s_mov_b32 s31, 0x00020000
    v_lshlrev_b32 v4, 1, v0
    v_cmp_lt_u32 vcc, 32, v0
    v_mov_b32 v7, 0x40000000
    v_mov_b32 v6, 0
    v_cndmask_b32 v6, v6, v7, vcc
    v_add_u32 v6, v6, v4
    s_and_b32 s22, s40, 31
    s_lshr_b32 s23, s40, 5
    s_lshl_b32 s24, s23, 7
    s_add_u32 s24, s24, s22
    s_mul_i32 s24, s24, 578
    buffer_load_ushort v8, v4, s[12:15], s24 offen offset:0
    buffer_load_ushort v28, v4, s[16:19], s24 offen offset:0
    buffer_load_ushort v12, v4, s[12:15], s24 offen offset:128
    buffer_load_ushort v32, v4, s[16:19], s24 offen offset:128
    buffer_load_ushort v16, v4, s[12:15], s24 offen offset:256
    buffer_load_ushort v36, v4, s[16:19], s24 offen offset:256
    buffer_load_ushort v20, v4, s[12:15], s24 offen offset:384
    buffer_load_ushort v40, v4, s[16:19], s24 offen offset:384
    buffer_load_ushort v24, v6, s[12:15], s24 offen offset:512
    buffer_load_ushort v44, v6, s[16:19], s24 offen offset:512
    s_add_u32 s24, s24, 18496
    buffer_load_ushort v9, v4, s[12:15], s24 offen offset:0
    buffer_load_ushort v29, v4, s[16:19], s24 offen offset:0
    buffer_load_ushort v13, v4, s[12:15], s24 offen offset:128
    buffer_load_ushort v33, v4, s[16:19], s24 offen offset:128
    buffer_load_ushort v17, v4, s[12:15], s24 offen offset:256
    buffer_load_ushort v37, v4, s[16:19], s24 offen offset:256
    buffer_load_ushort v21, v4, s[12:15], s24 offen offset:384
    buffer_load_ushort v41, v4, s[16:19], s24 offen offset:384
    buffer_load_ushort v25, v6, s[12:15], s24 offen offset:512
    buffer_load_ushort v45, v6, s[16:19], s24 offen offset:512
    s_add_u32 s24, s24, 18496
    buffer_load_ushort v10, v4, s[12:15], s24 offen offset:0
    buffer_load_ushort v30, v4, s[16:19], s24 offen offset:0
    buffer_load_ushort v14, v4, s[12:15], s24 offen offset:128
    buffer_load_ushort v34, v4, s[16:19], s24 offen offset:128
    buffer_load_ushort v18, v4, s[12:15], s24 offen offset:256
    buffer_load_ushort v38, v4, s[16:19], s24 offen offset:256
    buffer_load_ushort v22, v4, s[12:15], s24 offen offset:384
    buffer_load_ushort v42, v4, s[16:19], s24 offen offset:384
    buffer_load_ushort v26, v6, s[12:15], s24 offen offset:512
    buffer_load_ushort v46, v6, s[16:19], s24 offen offset:512
    s_add_u32 s24, s24, 18496
    buffer_load_ushort v11, v4, s[12:15], s24 offen offset:0
    buffer_load_ushort v31, v4, s[16:19], s24 offen offset:0
    buffer_load_ushort v15, v4, s[12:15], s24 offen offset:128
    buffer_load_ushort v35, v4, s[16:19], s24 offen offset:128
    buffer_load_ushort v19, v4, s[12:15], s24 offen offset:256
    buffer_load_ushort v39, v4, s[16:19], s24 offen offset:256
    buffer_load_ushort v23, v4, s[12:15], s24 offen offset:384
    buffer_load_ushort v43, v4, s[16:19], s24 offen offset:384
    buffer_load_ushort v27, v6, s[12:15], s24 offen offset:512
    buffer_load_ushort v47, v6, s[16:19], s24 offen offset:512
    s_cmp_ge_u32 s41, 512
    s_cbranch_scc1 Lprep_B2
    s_and_b32 s22, s41, 31
    s_lshr_b32 s23, s41, 5
    s_lshl_b32 s24, s23, 7
    s_add_u32 s24, s24, s22
    s_mul_i32 s24, s24, 578
    buffer_load_ushort v48, v4, s[12:15], s24 offen offset:0
    buffer_load_ushort v68, v4, s[16:19], s24 offen offset:0
    buffer_load_ushort v52, v4, s[12:15], s24 offen offset:128
    buffer_load_ushort v72, v4, s[16:19], s24 offen offset:128
    buffer_load_ushort v56, v4, s[12:15], s24 offen offset:256
    buffer_load_ushort v76, v4, s[16:19], s24 offen offset:256
    buffer_load_ushort v60, v4, s[12:15], s24 offen offset:384
    buffer_load_ushort v80, v4, s[16:19], s24 offen offset:384
    buffer_load_ushort v64, v6, s[12:15], s24 offen offset:512
    buffer_load_ushort v84, v6, s[16:19], s24 offen offset:512
    s_add_u32 s24, s24, 18496
    buffer_load_ushort v49, v4, s[12:15], s24 offen offset:0
    buffer_load_ushort v69, v4, s[16:19], s24 offen offset:0
    buffer_load_ushort v53, v4, s[12:15], s24 offen offset:128
    buffer_load_ushort v73, v4, s[16:19], s24 offen offset:128
    buffer_load_ushort v57, v4, s[12:15], s24 offen offset:256
    buffer_load_ushort v77, v4, s[16:19], s24 offen offset:256
    buffer_load_ushort v61, v4, s[12:15], s24 offen offset:384
    buffer_load_ushort v81, v4, s[16:19], s24 offen offset:384
    buffer_load_ushort v65, v6, s[12:15], s24 offen offset:512
    buffer_load_ushort v85, v6, s[16:19], s24 offen offset:512
    s_add_u32 s24, s24, 18496
    buffer_load_ushort v50, v4, s[12:15], s24 offen offset:0
    buffer_load_ushort v70, v4, s[16:19], s24 offen offset:0
    buffer_load_ushort v54, v4, s[12:15], s24 offen offset:128
    buffer_load_ushort v74, v4, s[16:19], s24 offen offset:128
    buffer_load_ushort v58, v4, s[12:15], s24 offen offset:256
    buffer_load_ushort v78, v4, s[16:19], s24 offen offset:256
    buffer_load_ushort v62, v4, s[12:15], s24 offen offset:384
    buffer_load_ushort v82, v4, s[16:19], s24 offen offset:384
    buffer_load_ushort v66, v6, s[12:15], s24 offen offset:512
    buffer_load_ushort v86, v6, s[16:19], s24 offen offset:512
    s_add_u32 s24, s24, 18496
    buffer_load_ushort v51, v4, s[12:15], s24 offen offset:0
    buffer_load_ushort v71, v4, s[16:19], s24 offen offset:0
    buffer_load_ushort v55, v4, s[12:15], s24 offen offset:128
    buffer_load_ushort v75, v4, s[16:19], s24 offen offset:128
    buffer_load_ushort v59, v4, s[12:15], s24 offen offset:256
    buffer_load_ushort v79, v4, s[16:19], s24 offen offset:256
    buffer_load_ushort v63, v4, s[12:15], s24 offen offset:384
    buffer_load_ushort v83, v4, s[16:19], s24 offen offset:384
    buffer_load_ushort v67, v6, s[12:15], s24 offen offset:512
    buffer_load_ushort v87, v6, s[16:19], s24 offen offset:512
Lprep_B2:
    s_and_b32 s22, s40, 31
    s_lshr_b32 s23, s40, 5
    s_lshr_b32 s24, s23, 1
    s_lshl_b32 s24, s24, 10
    s_and_b32 s25, s23, 1
    s_lshl_b32 s25, s25, 5
    s_add_u32 s25, s25, s22
    s_lshl_b32 s25, s25, 4
    s_add_u32 s24, s24, s25
    v_lshlrev_b32 v5, 13, v0
    s_waitcnt vmcnt(0)
    v_lshl_or_b32 v8, v28, 16, v8
    v_lshl_or_b32 v9, v29, 16, v9
    v_lshl_or_b32 v10, v30, 16, v10
    v_lshl_or_b32 v11, v31, 16, v11
    buffer_store_dwordx4 v[8:11], v5, s[28:31], s24 offen
    v_add_u32 v5, 524288, v5
    v_lshl_or_b32 v12, v32, 16, v12
    v_lshl_or_b32 v13, v33, 16, v13
    v_lshl_or_b32 v14, v34, 16, v14
    v_lshl_or_b32 v15, v35, 16, v15
    buffer_store_dwordx4 v[12:15], v5, s[28:31], s24 offen
    v_add_u32 v5, 524288, v5
    v_lshl_or_b32 v16, v36, 16, v16
    v_lshl_or_b32 v17, v37, 16, v17
    v_lshl_or_b32 v18, v38, 16, v18
    v_lshl_or_b32 v19, v39, 16, v19
    buffer_store_dwordx4 v[16:19], v5, s[28:31], s24 offen
    v_add_u32 v5, 524288, v5
    v_lshl_or_b32 v20, v40, 16, v20
    v_lshl_or_b32 v21, v41, 16, v21
    v_lshl_or_b32 v22, v42, 16, v22
    v_lshl_or_b32 v23, v43, 16, v23
    buffer_store_dwordx4 v[20:23], v5, s[28:31], s24 offen
    v_add_u32 v5, 524288, v5
    v_lshl_or_b32 v24, v44, 16, v24
    v_lshl_or_b32 v25, v45, 16, v25
    v_lshl_or_b32 v26, v46, 16, v26
    v_lshl_or_b32 v27, v47, 16, v27
    buffer_store_dwordx4 v[24:27], v5, s[28:31], s24 offen
    s_cmp_ge_u32 s41, 512
    s_cbranch_scc1 Lprep_Bend
    s_and_b32 s22, s41, 31
    s_lshr_b32 s23, s41, 5
    s_lshr_b32 s24, s23, 1
    s_lshl_b32 s24, s24, 10
    s_and_b32 s25, s23, 1
    s_lshl_b32 s25, s25, 5
    s_add_u32 s25, s25, s22
    s_lshl_b32 s25, s25, 4
    s_add_u32 s24, s24, s25
    v_lshlrev_b32 v5, 13, v0
    s_waitcnt vmcnt(0)
    v_lshl_or_b32 v48, v68, 16, v48
    v_lshl_or_b32 v49, v69, 16, v49
    v_lshl_or_b32 v50, v70, 16, v50
    v_lshl_or_b32 v51, v71, 16, v51
    buffer_store_dwordx4 v[48:51], v5, s[28:31], s24 offen
    v_add_u32 v5, 524288, v5
    v_lshl_or_b32 v52, v72, 16, v52
    v_lshl_or_b32 v53, v73, 16, v53
    v_lshl_or_b32 v54, v74, 16, v54
    v_lshl_or_b32 v55, v75, 16, v55
    buffer_store_dwordx4 v[52:55], v5, s[28:31], s24 offen
    v_add_u32 v5, 524288, v5
    v_lshl_or_b32 v56, v76, 16, v56
    v_lshl_or_b32 v57, v77, 16, v57
    v_lshl_or_b32 v58, v78, 16, v58
    v_lshl_or_b32 v59, v79, 16, v59
    buffer_store_dwordx4 v[56:59], v5, s[28:31], s24 offen
    v_add_u32 v5, 524288, v5
    v_lshl_or_b32 v60, v80, 16, v60
    v_lshl_or_b32 v61, v81, 16, v61
    v_lshl_or_b32 v62, v82, 16, v62
    v_lshl_or_b32 v63, v83, 16, v63
    buffer_store_dwordx4 v[60:63], v5, s[28:31], s24 offen
    v_add_u32 v5, 524288, v5
    v_lshl_or_b32 v64, v84, 16, v64
    v_lshl_or_b32 v65, v85, 16, v65
    v_lshl_or_b32 v66, v86, 16, v66
    v_lshl_or_b32 v67, v87, 16, v67
    buffer_store_dwordx4 v[64:67], v5, s[28:31], s24 offen
Lprep_Bend:
    s_endpgm
Lprep_C:
    s_sub_u32 s21, s2, 244
    s_mul_i32 s21, s21, 6
    s_add_u32 s21, s21, s20
    s_cmp_ge_u32 s21, 692
    s_cbranch_scc1 Lprep_Cnext
    s_waitcnt lgkmcnt(0)
    v_lshlrev_b32 v4, 4, v0
    s_cmp_ge_u32 s21, 648
    s_cbranch_scc1 Lprep_D
    s_add_u32 s12, s6, 7077888
    s_addc_u32 s13, s7, 0
    s_mov_b32 s14, 663552
    s_mov_b32 s15, 0x00020000
    s_mul_i32 s22, s21, 1821
    s_lshr_b32 s22, s22, 16
    s_mul_i32 s23, s22, 36
    s_sub_u32 s23, s21, s23
    s_lshl_b32 s22, s22, 5
    v_add_u32 v5, s22, v3
    s_lshl_b32 s23, s23, 3
    v_lshl_add_u32 v6, v2, 2, s23
    s_mov_b32 s24, 0x3ae38e39
    v_mov_b32 v7, 0x3b638e39
    v_mov_b32 v18, 0x3ae38e39
    v_cmp_eq_u32 vcc, 0, v6
    s_nop 1
    v_cndmask_b32 v18, v7, v18, vcc
    v_mov_b32 v19, 288
    v_cndmask_b32 v19, v6, v19, vcc
    v_mov_b32 v20, 0x3e800000
    v_mov_b32 v21, 0
    v_cndmask_b32 v20, v20, v21, vcc
    v_add_u32 v8, 0, v6
    v_mul_u32_u24 v8, v8, v5
    v_cvt_f32_u32 v8, v8
    v_mul_f32 v8, s24, v8
    v_fract_f32 v8, v8
    v_cos_f32 v8, v8
    s_nop 0
    v_mul_f32 v8, v18, v8
    v_mul_u32_u24 v9, v19, v5
    v_cvt_f32_u32 v9, v9
    v_mul_f32 v9, s24, v9
    v_fract_f32 v9, v9
    v_add_f32 v9, v20, v9
    v_cos_f32 v9, v9
    s_nop 0
    v_mul_f32 v9, v18, v9
    v_add_u32 v10, 1, v6
    v_mul_u32_u24 v10, v10, v5
    v_cvt_f32_u32 v10, v10
    v_mul_f32 v10, s24, v10
    v_fract_f32 v10, v10
    v_cos_f32 v10, v10
    s_nop 0
    v_mul_f32 v10, v7, v10
    v_add_u32 v11, 1, v6
    v_mul_u32_u24 v11, v11, v5
    v_cvt_f32_u32 v11, v11
    v_mul_f32 v11, s24, v11
    v_fract_f32 v11, v11
    v_add_f32 v11, 0x3e800000, v11
    v_cos_f32 v11, v11
    s_nop 0
    v_mul_f32 v11, v7, v11
    v_add_u32 v12, 2, v6
    v_mul_u32_u24 v12, v12, v5
    v_cvt_f32_u32 v12, v12
    v_mul_f32 v12, s24, v12
    v_fract_f32 v12, v12
    v_cos_f32 v12, v12
    s_nop 0
    v_mul_f32 v12, v7, v12
    v_add_u32 v13, 2, v6
    v_mul_u32_u24 v13, v13, v5
    v_cvt_f32_u32 v13, v13
    v_mul_f32 v13, s24, v13
    v_fract_f32 v13, v13
    v_add_f32 v13, 0x3e800000, v13
    v_cos_f32 v13, v13
    s_nop 0
    v_mul_f32 v13, v7, v13
    v_add_u32 v14, 3, v6
    v_mul_u32_u24 v14, v14, v5
    v_cvt_f32_u32 v14, v14
    v_mul_f32 v14, s24, v14
    v_fract_f32 v14, v14
    v_cos_f32 v14, v14
    s_nop 0
    v_mul_f32 v14, v7, v14
    v_add_u32 v15, 3, v6
    v_mul_u32_u24 v15, v15, v5
    v_cvt_f32_u32 v15, v15
    v_mul_f32 v15, s24, v15
    v_fract_f32 v15, v15
    v_add_f32 v15, 0x3e800000, v15
    v_cos_f32 v15, v15
    s_nop 0
    v_mul_f32 v15, v7, v15
    v_cvt_pk_bf16_f32 v24, v8, v9
    v_cvt_pk_bf16_f32 v25, v10, v11
    v_cvt_pk_bf16_f32 v26, v12, v13
    v_cvt_pk_bf16_f32 v27, v14, v15
    s_lshl_b32 s21, s21, 10
    buffer_store_dwordx4 v[24:27], v4, s[12:15], s21 offen
    s_branch Lprep_Cnext
Lprep_D:
    s_add_u32 s12, s6, 10108928
    s_addc_u32 s13, s7, 0
    s_mov_b32 s14, 45056
    s_mov_b32 s15, 0x00020000
    s_sub_u32 s21, s21, 648
    s_cmp_ge_u32 s21, 28
    s_cbranch_scc1 Lprep_TW
    s_cmp_ge_u32 s21, 12
    s_cbranch_scc1 Lprep_D64
    s_mov_b32 s22, 0
    s_and_b32 s23, s21, 1
    s_lshl_b32 s23, s23, 4
    s_mov_b32 s24, 0x3d000000
    s_lshr_b32 s28, s21, 1
    s_mov_b32 s25, 0
    s_cmp_eq_u32 s28, 1
    s_cselect_b32 s25, 0x3f400000, s25
    s_cmp_eq_u32 s28, 2
    s_cselect_b32 s25, 0x3e800000, s25
    s_cmp_eq_u32 s28, 4
    s_cselect_b32 s25, 0x3f400000, s25
    s_cmp_ge_u32 s28, 3
    s_cselect_b32 s26, 0x3a000000, 1.0
    s_cselect_b32 s27, 1, 0
    s_branch Lprep_Dgo
Lprep_D64:
    s_sub_u32 s28, s21, 12
    s_bfe_u32 s22, s28, 65538
    s_lshl_b32 s22, s22, 5
    s_and_b32 s23, s28, 3
    s_lshl_b32 s23, s23, 4
    s_mov_b32 s24, 0x3c800000
    s_cmp_ge_u32 s28, 8
    s_cselect_b32 s25, 0x3f400000, 0
    s_mov_b32 s26, 1.0
    s_mov_b32 s27, 1
Lprep_Dgo:
    v_add_u32 v5, s22, v3
    s_cmp_eq_u32 s27, 1
    s_cselect_b32 s29, 2, 3
    s_cselect_b32 s30, 4, 0
    v_lshlrev_b32 v6, s29, v2
    v_add_u32 v6, s23, v6
    v_add_u32 v8, 0, v6
    v_mul_u32_u24 v8, v8, v5
    v_cvt_f32_u32 v8, v8
    v_mul_f32 v8, s24, v8
    v_fract_f32 v8, v8
    v_add_f32 v8, s25, v8
    v_cos_f32 v8, v8
    s_nop 0
    v_mul_f32 v8, s26, v8
    v_add_u32 v9, 1, v6
    v_mul_u32_u24 v9, v9, v5
    v_cvt_f32_u32 v9, v9
    v_mul_f32 v9, s24, v9
    v_fract_f32 v9, v9
    v_add_f32 v9, s25, v9
    v_cos_f32 v9, v9
    s_nop 0
    v_mul_f32 v9, s26, v9
    v_add_u32 v10, 2, v6
    v_mul_u32_u24 v10, v10, v5
    v_cvt_f32_u32 v10, v10
    v_mul_f32 v10, s24, v10
    v_fract_f32 v10, v10
    v_add_f32 v10, s25, v10
    v_cos_f32 v10, v10
    s_nop 0
    v_mul_f32 v10, s26, v10
    v_add_u32 v11, 3, v6
    v_mul_u32_u24 v11, v11, v5
    v_cvt_f32_u32 v11, v11
    v_mul_f32 v11, s24, v11
    v_fract_f32 v11, v11
    v_add_f32 v11, s25, v11
    v_cos_f32 v11, v11
    s_nop 0
    v_mul_f32 v11, s26, v11
    v_add_u32 v12, 4, v6
    v_add_u32 v12, s30, v12
    v_mul_u32_u24 v12, v12, v5
    v_cvt_f32_u32 v12, v12
    v_mul_f32 v12, s24, v12
    v_fract_f32 v12, v12
    v_add_f32 v12, s25, v12
    v_cos_f32 v12, v12
    s_nop 0
    v_mul_f32 v12, s26, v12
    v_add_u32 v13, 5, v6
    v_add_u32 v13, s30, v13
    v_mul_u32_u24 v13, v13, v5
    v_cvt_f32_u32 v13, v13
    v_mul_f32 v13, s24, v13
    v_fract_f32 v13, v13
    v_add_f32 v13, s25, v13
    v_cos_f32 v13, v13
    s_nop 0
    v_mul_f32 v13, s26, v13
    v_add_u32 v14, 6, v6
    v_add_u32 v14, s30, v14
    v_mul_u32_u24 v14, v14, v5
    v_cvt_f32_u32 v14, v14
    v_mul_f32 v14, s24, v14
    v_fract_f32 v14, v14
    v_add_f32 v14, s25, v14
    v_cos_f32 v14, v14
    s_nop 0
    v_mul_f32 v14, s26, v14
    v_add_u32 v15, 7, v6
    v_add_u32 v15, s30, v15
    v_mul_u32_u24 v15, v15, v5
    v_cvt_f32_u32 v15, v15
    v_mul_f32 v15, s24, v15
    v_fract_f32 v15, v15
    v_add_f32 v15, s25, v15
    v_cos_f32 v15, v15
    s_nop 0
    v_mul_f32 v15, s26, v15
    v_cvt_pk_bf16_f32 v24, v8, v9
    v_cvt_pk_bf16_f32 v25, v10, v11
    v_cvt_pk_bf16_f32 v26, v12, v13
    v_cvt_pk_bf16_f32 v27, v14, v15
    s_lshl_b32 s21, s21, 10
    buffer_store_dwordx4 v[24:27], v4, s[12:15], s21 offen
    s_branch Lprep_Cnext
Lprep_TW:
    s_sub_u32 s28, s21, 28
    s_and_b32 s29, s28, 3
    s_lshl_b32 s29, s29, 3
    s_bfe_u32 s30, s28, 65538
    s_lshl_b32 s30, s30, 5
    s_cmp_ge_u32 s28, 8
    s_cselect_b32 s31, 0, s30
    s_cselect_b32 s30, s30, 0
    s_add_u32 s29, s29, s31
    v_lshl_add_u32 v6, v2, 2, s29
    v_add_u32 v5, s30, v3
    v_add_u32 v8, 0, v6
    v_mul_u32_u24 v8, v8, v5
    v_cvt_f32_u32 v8, v8
    v_mul_f32 v8, 0x3a000000, v8
    v_sin_f32 v9, v8
    v_cos_f32 v8, v8
    s_nop 0
    v_cvt_pk_bf16_f32 v24, v8, v9
    v_add_u32 v10, 1, v6
    v_mul_u32_u24 v10, v10, v5
    v_cvt_f32_u32 v10, v10
    v_mul_f32 v10, 0x3a000000, v10
    v_sin_f32 v11, v10
    v_cos_f32 v10, v10
    s_nop 0
    v_cvt_pk_bf16_f32 v25, v10, v11
    v_add_u32 v12, 2, v6
    v_mul_u32_u24 v12, v12, v5
    v_cvt_f32_u32 v12, v12
    v_mul_f32 v12, 0x3a000000, v12
    v_sin_f32 v13, v12
    v_cos_f32 v12, v12
    s_nop 0
    v_cvt_pk_bf16_f32 v26, v12, v13
    v_add_u32 v14, 3, v6
    v_mul_u32_u24 v14, v14, v5
    v_cvt_f32_u32 v14, v14
    v_mul_f32 v14, 0x3a000000, v14
    v_sin_f32 v15, v14
    v_cos_f32 v14, v14
    s_nop 0
    v_cvt_pk_bf16_f32 v27, v14, v15
    s_lshl_b32 s21, s21, 10
    buffer_store_dwordx4 v[24:27], v4, s[12:15], s21 offen
Lprep_Cnext:
    s_add_u32 s2, s2, 12
    s_cmp_lt_u32 s2, 360
    s_cbranch_scc1 Lprep_C
Lprep_end:
    s_endpgm
.globl ffn1_kernel
.p2align 8
.type ffn1_kernel,@function
ffn1_kernel:
    s_cmp_ge_u32 s2, 256
    s_cbranch_scc1 Lf1_end
    s_load_dwordx2 s[4:5], s[0:1], 32
    s_load_dwordx2 s[6:7], s[0:1], 40
    s_load_dwordx2 s[8:9], s[0:1], 72
    v_lshrrev_b32 v208, 6, v0
    v_and_b32 v0, 63, v0
    s_nop 0
    v_readfirstlane_b32 s35, v208
    s_and_b32 s38, s2, 7
    s_lshr_b32 s39, s2, 3
    s_lshr_b32 s40, s39, 3
    s_lshl_b32 s38, s38, 2
    s_add_u32 s38, s38, s40
    s_and_b32 s39, s39, 7
    s_lshl_b32 s39, s39, 3
    s_add_u32 s39, s39, s35
    s_mul_i32 s36, s38, 288
    s_mul_i32 s37, s39, 36864
    s_mul_i32 s40, s39, 288
    s_mul_i32 s38, s38, 9
    s_add_u32 s40, s40, s38
    s_lshl_b32 s3, s40, 10
    s_add_u32 s38, s35, 0
    s_cmp_ge_u32 s38, 9
    s_cselect_b32 s39, 9, 0
    s_cselect_b32 s40, 9344, 0
    s_sub_u32 s39, s38, s39
    s_lshl_b32 s32, s39, 10
    s_add_u32 s32, s32, s40
    s_lshl_b32 s39, s39, 6
    v_add_u32 v208, s39, v0
    s_mov_b32 s39, 58255
    v_mul_u32_u24 v209, s39, v208
    v_lshrrev_b32 v209, 20, v209
    v_mul_u32_u24 v210, 18, v209
    v_sub_u32 v208, v208, v210
    v_lshlrev_b32 v208, 4, v208
    v_lshrrev_b32 v210, 4, v209
    v_and_b32 v209, 15, v209
    v_mul_u32_u24 v210, 288, v210
    v_add_u32 v209, v209, v210
    s_mov_b32 s39, 9216
    v_mul_lo_u32 v209, s39, v209
    v_add_u32 v204, v208, v209
    s_add_u32 s38, s35, 8
    s_cmp_ge_u32 s38, 9
    s_cselect_b32 s39, 9, 0
    s_cselect_b32 s40, 9344, 0
    s_sub_u32 s39, s38, s39
    s_lshl_b32 s33, s39, 10
    s_add_u32 s33, s33, s40
    s_lshl_b32 s39, s39, 6
    v_add_u32 v208, s39, v0
    s_mov_b32 s39, 58255
    v_mul_u32_u24 v209, s39, v208
    v_lshrrev_b32 v209, 20, v209
    v_mul_u32_u24 v210, 18, v209
    v_sub_u32 v208, v208, v210
    v_lshlrev_b32 v208, 4, v208
    v_lshrrev_b32 v210, 4, v209
    v_and_b32 v209, 15, v209
    v_mul_u32_u24 v210, 288, v210
    v_add_u32 v209, v209, v210
    s_mov_b32 s39, 9216
    v_mul_lo_u32 v209, s39, v209
    v_add_u32 v205, v208, v209
    s_add_u32 s38, s35, 16
    s_cmp_ge_u32 s38, 9
    s_cselect_b32 s39, 9, 0
    s_cselect_b32 s40, 9344, 0
    s_sub_u32 s39, s38, s39
    s_lshl_b32 s34, s39, 10
    s_add_u32 s34, s34, s40
    s_lshl_b32 s39, s39, 6
    v_add_u32 v208, s39, v0
    s_mov_b32 s39, 58255
    v_mul_u32_u24 v209, s39, v208
    v_lshrrev_b32 v209, 20, v209
    v_mul_u32_u24 v210, 18, v209
    v_sub_u32 v208, v208, v210
    v_lshlrev_b32 v208, 4, v208
    v_lshrrev_b32 v210, 4, v209
    v_and_b32 v209, 15, v209
    v_mul_u32_u24 v210, 288, v210
    v_add_u32 v209, v209, v210
    s_mov_b32 s39, 9216
    v_mul_lo_u32 v209, s39, v209
    v_add_u32 v206, v208, v209
    s_cmp_ge_u32 s38, 18
    s_cselect_b32 s39, 0x40000000, 0
    s_cselect_b32 s34, 74752, s34
    v_add_u32 v206, s39, v206
    v_lshlrev_b32 v207, 4, v0
    v_lshrrev_b32 v208, 5, v0
    v_bfe_u32 v209, v0, 4, 1
    v_bfe_u32 v210, v0, 2, 2
    v_and_b32 v211, 3, v0
    v_lshlrev_b32 v211, 3, v211
    v_mul_u32_u24 v208, 16, v208
    v_add_u32 v208, v208, v210
    v_mul_u32_u24 v208, 288, v208
    v_mul_u32_u24 v209, 9344, v209
    v_add3_u32 v200, v208, v209, v211
    v_add_u32 v201, 18688, v200
    v_add_u32 v202, 37376, v200
    v_add_u32 v203, 56064, v200
    s_waitcnt lgkmcnt(0)
    s_add_u32 s38, s35, 0
    s_cmp_ge_u32 s38, 9
    s_cselect_b32 s20, s6, s4
    s_cselect_b32 s21, s7, s5
    s_mov_b32 s22, 5308416
    s_mov_b32 s23, 0x00020000
    s_add_u32 s38, s35, 8
    s_cmp_ge_u32 s38, 9
    s_cselect_b32 s24, s6, s4
    s_cselect_b32 s25, s7, s5
    s_mov_b32 s26, 5308416
    s_mov_b32 s27, 0x00020000
    s_add_u32 s38, s35, 16
    s_cmp_ge_u32 s38, 9
    s_cselect_b32 s28, s6, s4
    s_cselect_b32 s29, s7, s5
    s_mov_b32 s30, 5308416
    s_mov_b32 s31, 0x00020000
    s_mov_b32 s12, s8
    s_mov_b32 s13, s9
    s_mov_b32 s14, 2359296
    s_mov_b32 s15, 0x00020000
    s_add_u32 s16, s8, 10153984
    s_addc_u32 s17, s9, 0
    s_mov_b32 s18, 18874368
    s_mov_b32 s19, 0x00020000
    s_add_u32 s38, s36, 0
    s_add_u32 m0, s32, 0
    s_nop 0
    buffer_load_dwordx4 v204, s[20:23], s38 offen lds
    s_add_u32 m0, s33, 0
    s_nop 0
    buffer_load_dwordx4 v205, s[24:27], s38 offen lds
    s_add_u32 m0, s34, 0
    s_nop 0
    buffer_load_dwordx4 v206, s[28:31], s38 offen lds
    s_add_u32 s39, s37, 0
    buffer_load_dwordx4 v[168:171], v207, s[12:15], s39 offen offset:0
    buffer_load_dwordx4 v[172:175], v207, s[12:15], s39 offen offset:1024
    s_add_u32 s38, s36, 147456
    s_add_u32 m0, s32, 18688
    s_nop 0
    buffer_load_dwordx4 v204, s[20:23], s38 offen lds
    s_add_u32 m0, s33, 18688
    s_nop 0
    buffer_load_dwordx4 v205, s[24:27], s38 offen lds
    s_add_u32 m0, s34, 18688
    s_nop 0
    buffer_load_dwordx4 v206, s[28:31], s38 offen lds
    s_add_u32 s39, s37, 2048
    buffer_load_dwordx4 v[176:179], v207, s[12:15], s39 offen offset:0
    buffer_load_dwordx4 v[180:183], v207, s[12:15], s39 offen offset:1024
    v_mov_b32 v0, 0
    v_mov_b32 v1, 0
    v_mov_b32 v2, 0
    v_mov_b32 v3, 0
    v_mov_b32 v4, 0
    v_mov_b32 v5, 0
    v_mov_b32 v6, 0
    v_mov_b32 v7, 0
    v_mov_b32 v8, 0
    v_mov_b32 v9, 0
    v_mov_b32 v10, 0
    v_mov_b32 v11, 0
    v_mov_b32 v12, 0
    v_mov_b32 v13, 0
    v_mov_b32 v14, 0
    v_mov_b32 v15, 0
    v_mov_b32 v16, 0
    v_mov_b32 v17, 0
    v_mov_b32 v18, 0
    v_mov_b32 v19, 0
    v_mov_b32 v20, 0
    v_mov_b32 v21, 0
    v_mov_b32 v22, 0
    v_mov_b32 v23, 0
    v_mov_b32 v24, 0
    v_mov_b32 v25, 0
    v_mov_b32 v26, 0
    v_mov_b32 v27, 0
    v_mov_b32 v28, 0
    v_mov_b32 v29, 0
    v_mov_b32 v30, 0
    v_mov_b32 v31, 0
    v_mov_b32 v32, 0
    v_mov_b32 v33, 0
    v_mov_b32 v34, 0
    v_mov_b32 v35, 0
    v_mov_b32 v36, 0
    v_mov_b32 v37, 0
    v_mov_b32 v38, 0
    v_mov_b32 v39, 0
    v_mov_b32 v40, 0
    v_mov_b32 v41, 0
    v_mov_b32 v42, 0
    v_mov_b32 v43, 0
    v_mov_b32 v44, 0
    v_mov_b32 v45, 0
    v_mov_b32 v46, 0
    v_mov_b32 v47, 0
    v_mov_b32 v48, 0
    v_mov_b32 v49, 0
    v_mov_b32 v50, 0
    v_mov_b32 v51, 0
    v_mov_b32 v52, 0
    v_mov_b32 v53, 0
    v_mov_b32 v54, 0
    v_mov_b32 v55, 0
    v_mov_b32 v56, 0
    v_mov_b32 v57, 0
    v_mov_b32 v58, 0
    v_mov_b32 v59, 0
    v_mov_b32 v60, 0
    v_mov_b32 v61, 0
    v_mov_b32 v62, 0
    v_mov_b32 v63, 0
    v_mov_b32 v64, 0
    v_mov_b32 v65, 0
    v_mov_b32 v66, 0
    v_mov_b32 v67, 0
    v_mov_b32 v68, 0
    v_mov_b32 v69, 0
    v_mov_b32 v70, 0
    v_mov_b32 v71, 0
    v_mov_b32 v72, 0
    v_mov_b32 v73, 0
    v_mov_b32 v74, 0
    v_mov_b32 v75, 0
    v_mov_b32 v76, 0
    v_mov_b32 v77, 0
    v_mov_b32 v78, 0
    v_mov_b32 v79, 0
    v_mov_b32 v80, 0
    v_mov_b32 v81, 0
    v_mov_b32 v82, 0
    v_mov_b32 v83, 0
    v_mov_b32 v84, 0
    v_mov_b32 v85, 0
    v_mov_b32 v86, 0
    v_mov_b32 v87, 0
    v_mov_b32 v88, 0
    v_mov_b32 v89, 0
    v_mov_b32 v90, 0
    v_mov_b32 v91, 0
    v_mov_b32 v92, 0
    v_mov_b32 v93, 0
    v_mov_b32 v94, 0
    v_mov_b32 v95, 0
    v_mov_b32 v96, 0
    v_mov_b32 v97, 0
    v_mov_b32 v98, 0
    v_mov_b32 v99, 0
    v_mov_b32 v100, 0
    v_mov_b32 v101, 0
    v_mov_b32 v102, 0
    v_mov_b32 v103, 0
    v_mov_b32 v104, 0
    v_mov_b32 v105, 0
    v_mov_b32 v106, 0
    v_mov_b32 v107, 0
    v_mov_b32 v108, 0
    v_mov_b32 v109, 0
    v_mov_b32 v110, 0
    v_mov_b32 v111, 0
    v_mov_b32 v112, 0
    v_mov_b32 v113, 0
    v_mov_b32 v114, 0
    v_mov_b32 v115, 0
    v_mov_b32 v116, 0
    v_mov_b32 v117, 0
    v_mov_b32 v118, 0
    v_mov_b32 v119, 0
    v_mov_b32 v120, 0
    v_mov_b32 v121, 0
    v_mov_b32 v122, 0
    v_mov_b32 v123, 0
    v_mov_b32 v124, 0
    v_mov_b32 v125, 0
    v_mov_b32 v126, 0
    v_mov_b32 v127, 0
    v_mov_b32 v128, 0
    v_mov_b32 v129, 0
    v_mov_b32 v130, 0
    v_mov_b32 v131, 0
    v_mov_b32 v132, 0
    v_mov_b32 v133, 0
    v_mov_b32 v134, 0
    v_mov_b32 v135, 0
    v_mov_b32 v136, 0
    v_mov_b32 v137, 0
    v_mov_b32 v138, 0
    v_mov_b32 v139, 0
    v_mov_b32 v140, 0
    v_mov_b32 v141, 0
    v_mov_b32 v142, 0
    v_mov_b32 v143, 0
    s_waitcnt vmcnt(5)
    s_barrier
    s_add_u32 s38, s36, 294912
    s_add_u32 m0, s32, 37376
    s_nop 0
    buffer_load_dwordx4 v204, s[20:23], s38 offen lds
    s_add_u32 m0, s33, 37376
    s_nop 0
    buffer_load_dwordx4 v205, s[24:27], s38 offen lds
    s_add_u32 m0, s34, 37376
    s_nop 0
    buffer_load_dwordx4 v206, s[28:31], s38 offen lds
    ds_read_b64_tr_b16 v[144:145], v200 offset:0
    ds_read_b64_tr_b16 v[146:147], v200 offset:1152
    ds_read_b64_tr_b16 v[148:149], v200 offset:32
    ds_read_b64_tr_b16 v[150:151], v200 offset:1184
    ds_read_b64_tr_b16 v[152:153], v200 offset:64
    ds_read_b64_tr_b16 v[154:155], v200 offset:1216
    ds_read_b64_tr_b16 v[156:157], v200 offset:96
    ds_read_b64_tr_b16 v[158:159], v200 offset:1248
    ds_read_b64_tr_b16 v[160:161], v200 offset:128
    ds_read_b64_tr_b16 v[162:163], v200 offset:1280
    s_waitcnt lgkmcnt(8)
    v_mfma_f32_32x32x16_bf16 v[0:15], v[144:147], v[168:171], v[0:15]
    s_add_u32 s39, s37, 4096
    buffer_load_dwordx4 v[184:187], v207, s[12:15], s39 offen offset:0
    buffer_load_dwordx4 v[188:191], v207, s[12:15], s39 offen offset:1024
    s_add_u32 s39, s37, 6144
    buffer_load_dwordx4 v[192:195], v207, s[12:15], s39 offen offset:0
    buffer_load_dwordx4 v[196:199], v207, s[12:15], s39 offen offset:1024
    ds_read_b64_tr_b16 v[164:165], v200 offset:160
    ds_read_b64_tr_b16 v[166:167], v200 offset:1312
    s_waitcnt lgkmcnt(8)
    v_mfma_f32_32x32x16_bf16 v[16:31], v[148:151], v[168:171], v[16:31]
    ds_read_b64_tr_b16 v[144:145], v200 offset:192
    ds_read_b64_tr_b16 v[146:147], v200 offset:1344
    s_waitcnt lgkmcnt(8)
    v_mfma_f32_32x32x16_bf16 v[32:47], v[152:155], v[168:171], v[32:47]
    ds_read_b64_tr_b16 v[148:149], v200 offset:224
    ds_read_b64_tr_b16 v[150:151], v200 offset:1376
    s_waitcnt lgkmcnt(8)
    v_mfma_f32_32x32x16_bf16 v[48:63], v[156:159], v[168:171], v[48:63]
    ds_read_b64_tr_b16 v[152:153], v200 offset:256
    ds_read_b64_tr_b16 v[154:155], v200 offset:1408
    s_waitcnt lgkmcnt(8)
    v_mfma_f32_32x32x16_bf16 v[64:79], v[160:163], v[168:171], v[64:79]
    ds_read_b64_tr_b16 v[156:157], v200 offset:2304
    ds_read_b64_tr_b16 v[158:159], v200 offset:3456
    s_waitcnt lgkmcnt(8)
    v_mfma_f32_32x32x16_bf16 v[80:95], v[164:167], v[168:171], v[80:95]
    ds_read_b64_tr_b16 v[160:161], v200 offset:2336
    ds_read_b64_tr_b16 v[162:163], v200 offset:3488
    s_waitcnt lgkmcnt(8)
    v_mfma_f32_32x32x16_bf16 v[96:111], v[144:147], v[168:171], v[96:111]
    ds_read_b64_tr_b16 v[164:165], v200 offset:2368
    ds_read_b64_tr_b16 v[166:167], v200 offset:3520
    s_waitcnt lgkmcnt(8)
    v_mfma_f32_32x32x16_bf16 v[112:127], v[148:151], v[168:171], v[112:127]
    ds_read_b64_tr_b16 v[144:145], v200 offset:2400
    ds_read_b64_tr_b16 v[146:147], v200 offset:3552
    s_waitcnt lgkmcnt(8)
    v_mfma_f32_32x32x16_bf16 v[128:143], v[152:155], v[168:171], v[128:143]
    ds_read_b64_tr_b16 v[148:149], v200 offset:2432
    ds_read_b64_tr_b16 v[150:151], v200 offset:3584
    s_waitcnt lgkmcnt(8)
    v_mfma_f32_32x32x16_bf16 v[0:15], v[156:159], v[172:175], v[0:15]
    ds_read_b64_tr_b16 v[152:153], v200 offset:2464
    ds_read_b64_tr_b16 v[154:155], v200 offset:3616
    s_waitcnt lgkmcnt(8)
    v_mfma_f32_32x32x16_bf16 v[16:31], v[160:163], v[172:175], v[16:31]
    ds_read_b64_tr_b16 v[156:157], v200 offset:2496
    ds_read_b64_tr_b16 v[158:159], v200 offset:3648
    s_waitcnt lgkmcnt(8)
    v_mfma_f32_32x32x16_bf16 v[32:47], v[164:167], v[172:175], v[32:47]
    ds_read_b64_tr_b16 v[160:161], v200 offset:2528
    ds_read_b64_tr_b16 v[162:163], v200 offset:3680
    s_waitcnt lgkmcnt(8)
    v_mfma_f32_32x32x16_bf16 v[48:63], v[144:147], v[172:175], v[48:63]
    ds_read_b64_tr_b16 v[164:165], v200 offset:2560
    ds_read_b64_tr_b16 v[166:167], v200 offset:3712
    s_waitcnt lgkmcnt(8)
    v_mfma_f32_32x32x16_bf16 v[64:79], v[148:151], v[172:175], v[64:79]
    s_waitcnt vmcnt(7)
    s_barrier
    s_add_u32 s38, s36, 442368
    s_add_u32 m0, s32, 56064
    s_nop 0
    buffer_load_dwordx4 v204, s[20:23], s38 offen lds
    s_add_u32 m0, s33, 56064
    s_nop 0
    buffer_load_dwordx4 v205, s[24:27], s38 offen lds
    s_add_u32 m0, s34, 56064
    s_nop 0
    buffer_load_dwordx4 v206, s[28:31], s38 offen lds
    ds_read_b64_tr_b16 v[144:145], v201 offset:0
    ds_read_b64_tr_b16 v[146:147], v201 offset:1152
    s_waitcnt lgkmcnt(8)
    v_mfma_f32_32x32x16_bf16 v[80:95], v[152:155], v[172:175], v[80:95]
    ds_read_b64_tr_b16 v[148:149], v201 offset:32
    ds_read_b64_tr_b16 v[150:151], v201 offset:1184
    s_waitcnt lgkmcnt(8)
    v_mfma_f32_32x32x16_bf16 v[96:111], v[156:159], v[172:175], v[96:111]
    ds_read_b64_tr_b16 v[152:153], v201 offset:64
    ds_read_b64_tr_b16 v[154:155], v201 offset:1216
    s_waitcnt lgkmcnt(8)
    v_mfma_f32_32x32x16_bf16 v[112:127], v[160:163], v[172:175], v[112:127]
    ds_read_b64_tr_b16 v[156:157], v201 offset:96
    ds_read_b64_tr_b16 v[158:159], v201 offset:1248
    s_waitcnt lgkmcnt(8)
    v_mfma_f32_32x32x16_bf16 v[128:143], v[164:167], v[172:175], v[128:143]
    ds_read_b64_tr_b16 v[160:161], v201 offset:128
    ds_read_b64_tr_b16 v[162:163], v201 offset:1280
    s_waitcnt lgkmcnt(8)
    v_mfma_f32_32x32x16_bf16 v[0:15], v[144:147], v[176:179], v[0:15]
    s_add_u32 s39, s37, 8192
    buffer_load_dwordx4 v[168:171], v207, s[12:15], s39 offen offset:0
    buffer_load_dwordx4 v[172:175], v207, s[12:15], s39 offen offset:1024
    ds_read_b64_tr_b16 v[164:165], v201 offset:160
    ds_read_b64_tr_b16 v[166:167], v201 offset:1312
    s_waitcnt lgkmcnt(8)
    v_mfma_f32_32x32x16_bf16 v[16:31], v[148:151], v[176:179], v[16:31]
    ds_read_b64_tr_b16 v[144:145], v201 offset:192
    ds_read_b64_tr_b16 v[146:147], v201 offset:1344
    s_waitcnt lgkmcnt(8)
    v_mfma_f32_32x32x16_bf16 v[32:47], v[152:155], v[176:179], v[32:47]
    ds_read_b64_tr_b16 v[148:149], v201 offset:224
    ds_read_b64_tr_b16 v[150:151], v201 offset:1376
    s_waitcnt lgkmcnt(8)
    v_mfma_f32_32x32x16_bf16 v[48:63], v[156:159], v[176:179], v[48:63]
    ds_read_b64_tr_b16 v[152:153], v201 offset:256
    ds_read_b64_tr_b16 v[154:155], v201 offset:1408
    s_waitcnt lgkmcnt(8)
    v_mfma_f32_32x32x16_bf16 v[64:79], v[160:163], v[176:179], v[64:79]
    ds_read_b64_tr_b16 v[156:157], v201 offset:2304
    ds_read_b64_tr_b16 v[158:159], v201 offset:3456
    s_waitcnt lgkmcnt(8)
    v_mfma_f32_32x32x16_bf16 v[80:95], v[164:167], v[176:179], v[80:95]
    ds_read_b64_tr_b16 v[160:161], v201 offset:2336
    ds_read_b64_tr_b16 v[162:163], v201 offset:3488
    s_waitcnt lgkmcnt(8)
    v_mfma_f32_32x32x16_bf16 v[96:111], v[144:147], v[176:179], v[96:111]
    ds_read_b64_tr_b16 v[164:165], v201 offset:2368
    ds_read_b64_tr_b16 v[166:167], v201 offset:3520
    s_waitcnt lgkmcnt(8)
    v_mfma_f32_32x32x16_bf16 v[112:127], v[148:151], v[176:179], v[112:127]
    ds_read_b64_tr_b16 v[144:145], v201 offset:2400
    ds_read_b64_tr_b16 v[146:147], v201 offset:3552
    s_waitcnt lgkmcnt(8)
    v_mfma_f32_32x32x16_bf16 v[128:143], v[152:155], v[176:179], v[128:143]
    ds_read_b64_tr_b16 v[148:149], v201 offset:2432
    ds_read_b64_tr_b16 v[150:151], v201 offset:3584
    s_waitcnt lgkmcnt(8)
    v_mfma_f32_32x32x16_bf16 v[0:15], v[156:159], v[180:183], v[0:15]
    ds_read_b64_tr_b16 v[152:153], v201 offset:2464
    ds_read_b64_tr_b16 v[154:155], v201 offset:3616
    s_waitcnt lgkmcnt(8)
    v_mfma_f32_32x32x16_bf16 v[16:31], v[160:163], v[180:183], v[16:31]
    ds_read_b64_tr_b16 v[156:157], v201 offset:2496
    ds_read_b64_tr_b16 v[158:159], v201 offset:3648
    s_waitcnt lgkmcnt(8)
    v_mfma_f32_32x32x16_bf16 v[32:47], v[164:167], v[180:183], v[32:47]
    ds_read_b64_tr_b16 v[160:161], v201 offset:2528
    ds_read_b64_tr_b16 v[162:163], v201 offset:3680
    s_waitcnt lgkmcnt(8)
    v_mfma_f32_32x32x16_bf16 v[48:63], v[144:147], v[180:183], v[48:63]
    ds_read_b64_tr_b16 v[164:165], v201 offset:2560
    ds_read_b64_tr_b16 v[166:167], v201 offset:3712
    s_waitcnt lgkmcnt(8)
    v_mfma_f32_32x32x16_bf16 v[64:79], v[148:151], v[180:183], v[64:79]
    s_waitcnt vmcnt(7)
    s_barrier
    s_add_u32 s38, s36, 589824
    s_add_u32 m0, s32, 0
    s_nop 0
    buffer_load_dwordx4 v204, s[20:23], s38 offen lds
    s_add_u32 m0, s33, 0
    s_nop 0
    buffer_load_dwordx4 v205, s[24:27], s38 offen lds
    s_add_u32 m0, s34, 0
    s_nop 0
    buffer_load_dwordx4 v206, s[28:31], s38 offen lds
    ds_read_b64_tr_b16 v[144:145], v202 offset:0
    ds_read_b64_tr_b16 v[146:147], v202 offset:1152
    s_waitcnt lgkmcnt(8)
    v_mfma_f32_32x32x16_bf16 v[80:95], v[152:155], v[180:183], v[80:95]
    ds_read_b64_tr_b16 v[148:149], v202 offset:32
    ds_read_b64_tr_b16 v[150:151], v202 offset:1184
    s_waitcnt lgkmcnt(8)
    v_mfma_f32_32x32x16_bf16 v[96:111], v[156:159], v[180:183], v[96:111]
    ds_read_b64_tr_b16 v[152:153], v202 offset:64
    ds_read_b64_tr_b16 v[154:155], v202 offset:1216
    s_waitcnt lgkmcnt(8)
    v_mfma_f32_32x32x16_bf16 v[112:127], v[160:163], v[180:183], v[112:127]
    ds_read_b64_tr_b16 v[156:157], v202 offset:96
    ds_read_b64_tr_b16 v[158:159], v202 offset:1248
    s_waitcnt lgkmcnt(8)
    v_mfma_f32_32x32x16_bf16 v[128:143], v[164:167], v[180:183], v[128:143]
    ds_read_b64_tr_b16 v[160:161], v202 offset:128
    ds_read_b64_tr_b16 v[162:163], v202 offset:1280
    s_waitcnt lgkmcnt(8)
    v_mfma_f32_32x32x16_bf16 v[0:15], v[144:147], v[184:187], v[0:15]
    s_add_u32 s39, s37, 10240
    buffer_load_dwordx4 v[176:179], v207, s[12:15], s39 offen offset:0
    buffer_load_dwordx4 v[180:183], v207, s[12:15], s39 offen offset:1024
    ds_read_b64_tr_b16 v[164:165], v202 offset:160
    ds_read_b64_tr_b16 v[166:167], v202 offset:1312
    s_waitcnt lgkmcnt(8)
    v_mfma_f32_32x32x16_bf16 v[16:31], v[148:151], v[184:187], v[16:31]
    ds_read_b64_tr_b16 v[144:145], v202 offset:192
    ds_read_b64_tr_b16 v[146:147], v202 offset:1344
    s_waitcnt lgkmcnt(8)
    v_mfma_f32_32x32x16_bf16 v[32:47], v[152:155], v[184:187], v[32:47]
    ds_read_b64_tr_b16 v[148:149], v202 offset:224
    ds_read_b64_tr_b16 v[150:151], v202 offset:1376
    s_waitcnt lgkmcnt(8)
    v_mfma_f32_32x32x16_bf16 v[48:63], v[156:159], v[184:187], v[48:63]
    ds_read_b64_tr_b16 v[152:153], v202 offset:256
    ds_read_b64_tr_b16 v[154:155], v202 offset:1408
    s_waitcnt lgkmcnt(8)
    v_mfma_f32_32x32x16_bf16 v[64:79], v[160:163], v[184:187], v[64:79]
    ds_read_b64_tr_b16 v[156:157], v202 offset:2304
    ds_read_b64_tr_b16 v[158:159], v202 offset:3456
    s_waitcnt lgkmcnt(8)
    v_mfma_f32_32x32x16_bf16 v[80:95], v[164:167], v[184:187], v[80:95]
    ds_read_b64_tr_b16 v[160:161], v202 offset:2336
    ds_read_b64_tr_b16 v[162:163], v202 offset:3488
    s_waitcnt lgkmcnt(8)
    v_mfma_f32_32x32x16_bf16 v[96:111], v[144:147], v[184:187], v[96:111]
    ds_read_b64_tr_b16 v[164:165], v202 offset:2368
    ds_read_b64_tr_b16 v[166:167], v202 offset:3520
    s_waitcnt lgkmcnt(8)
    v_mfma_f32_32x32x16_bf16 v[112:127], v[148:151], v[184:187], v[112:127]
    ds_read_b64_tr_b16 v[144:145], v202 offset:2400
    ds_read_b64_tr_b16 v[146:147], v202 offset:3552
    s_waitcnt lgkmcnt(8)
    v_mfma_f32_32x32x16_bf16 v[128:143], v[152:155], v[184:187], v[128:143]
    ds_read_b64_tr_b16 v[148:149], v202 offset:2432
    ds_read_b64_tr_b16 v[150:151], v202 offset:3584
    s_waitcnt lgkmcnt(8)
    v_mfma_f32_32x32x16_bf16 v[0:15], v[156:159], v[188:191], v[0:15]
    ds_read_b64_tr_b16 v[152:153], v202 offset:2464
    ds_read_b64_tr_b16 v[154:155], v202 offset:3616
    s_waitcnt lgkmcnt(8)
    v_mfma_f32_32x32x16_bf16 v[16:31], v[160:163], v[188:191], v[16:31]
    ds_read_b64_tr_b16 v[156:157], v202 offset:2496
    ds_read_b64_tr_b16 v[158:159], v202 offset:3648
    s_waitcnt lgkmcnt(8)
    v_mfma_f32_32x32x16_bf16 v[32:47], v[164:167], v[188:191], v[32:47]
    ds_read_b64_tr_b16 v[160:161], v202 offset:2528
    ds_read_b64_tr_b16 v[162:163], v202 offset:3680
    s_waitcnt lgkmcnt(8)
    v_mfma_f32_32x32x16_bf16 v[48:63], v[144:147], v[188:191], v[48:63]
    ds_read_b64_tr_b16 v[164:165], v202 offset:2560
    ds_read_b64_tr_b16 v[166:167], v202 offset:3712
    s_waitcnt lgkmcnt(8)
    v_mfma_f32_32x32x16_bf16 v[64:79], v[148:151], v[188:191], v[64:79]
    s_waitcnt vmcnt(7)
    s_barrier
    s_add_u32 s38, s36, 737280
    s_add_u32 m0, s32, 18688
    s_nop 0
    buffer_load_dwordx4 v204, s[20:23], s38 offen lds
    s_add_u32 m0, s33, 18688
    s_nop 0
    buffer_load_dwordx4 v205, s[24:27], s38 offen lds
    s_add_u32 m0, s34, 18688
    s_nop 0
    buffer_load_dwordx4 v206, s[28:31], s38 offen lds
    ds_read_b64_tr_b16 v[144:145], v203 offset:0
    ds_read_b64_tr_b16 v[146:147], v203 offset:1152
    s_waitcnt lgkmcnt(8)
    v_mfma_f32_32x32x16_bf16 v[80:95], v[152:155], v[188:191], v[80:95]
    ds_read_b64_tr_b16 v[148:149], v203 offset:32
    ds_read_b64_tr_b16 v[150:151], v203 offset:1184
    s_waitcnt lgkmcnt(8)
    v_mfma_f32_32x32x16_bf16 v[96:111], v[156:159], v[188:191], v[96:111]
    ds_read_b64_tr_b16 v[152:153], v203 offset:64
    ds_read_b64_tr_b16 v[154:155], v203 offset:1216
    s_waitcnt lgkmcnt(8)
    v_mfma_f32_32x32x16_bf16 v[112:127], v[160:163], v[188:191], v[112:127]
    ds_read_b64_tr_b16 v[156:157], v203 offset:96
    ds_read_b64_tr_b16 v[158:159], v203 offset:1248
    s_waitcnt lgkmcnt(8)
    v_mfma_f32_32x32x16_bf16 v[128:143], v[164:167], v[188:191], v[128:143]
    ds_read_b64_tr_b16 v[160:161], v203 offset:128
    ds_read_b64_tr_b16 v[162:163], v203 offset:1280
    s_waitcnt lgkmcnt(8)
    v_mfma_f32_32x32x16_bf16 v[0:15], v[144:147], v[192:195], v[0:15]
    s_add_u32 s39, s37, 12288
    buffer_load_dwordx4 v[184:187], v207, s[12:15], s39 offen offset:0
    buffer_load_dwordx4 v[188:191], v207, s[12:15], s39 offen offset:1024
    ds_read_b64_tr_b16 v[164:165], v203 offset:160
    ds_read_b64_tr_b16 v[166:167], v203 offset:1312
    s_waitcnt lgkmcnt(8)
    v_mfma_f32_32x32x16_bf16 v[16:31], v[148:151], v[192:195], v[16:31]
    ds_read_b64_tr_b16 v[144:145], v203 offset:192
    ds_read_b64_tr_b16 v[146:147], v203 offset:1344
    s_waitcnt lgkmcnt(8)
    v_mfma_f32_32x32x16_bf16 v[32:47], v[152:155], v[192:195], v[32:47]
    ds_read_b64_tr_b16 v[148:149], v203 offset:224
    ds_read_b64_tr_b16 v[150:151], v203 offset:1376
    s_waitcnt lgkmcnt(8)
    v_mfma_f32_32x32x16_bf16 v[48:63], v[156:159], v[192:195], v[48:63]
    ds_read_b64_tr_b16 v[152:153], v203 offset:256
    ds_read_b64_tr_b16 v[154:155], v203 offset:1408
    s_waitcnt lgkmcnt(8)
    v_mfma_f32_32x32x16_bf16 v[64:79], v[160:163], v[192:195], v[64:79]
    ds_read_b64_tr_b16 v[156:157], v203 offset:2304
    ds_read_b64_tr_b16 v[158:159], v203 offset:3456
    s_waitcnt lgkmcnt(8)
    v_mfma_f32_32x32x16_bf16 v[80:95], v[164:167], v[192:195], v[80:95]
    ds_read_b64_tr_b16 v[160:161], v203 offset:2336
    ds_read_b64_tr_b16 v[162:163], v203 offset:3488
    s_waitcnt lgkmcnt(8)
    v_mfma_f32_32x32x16_bf16 v[96:111], v[144:147], v[192:195], v[96:111]
    ds_read_b64_tr_b16 v[164:165], v203 offset:2368
    ds_read_b64_tr_b16 v[166:167], v203 offset:3520
    s_waitcnt lgkmcnt(8)
    v_mfma_f32_32x32x16_bf16 v[112:127], v[148:151], v[192:195], v[112:127]
    ds_read_b64_tr_b16 v[144:145], v203 offset:2400
    ds_read_b64_tr_b16 v[146:147], v203 offset:3552
    s_waitcnt lgkmcnt(8)
    v_mfma_f32_32x32x16_bf16 v[128:143], v[152:155], v[192:195], v[128:143]
    ds_read_b64_tr_b16 v[148:149], v203 offset:2432
    ds_read_b64_tr_b16 v[150:151], v203 offset:3584
    s_waitcnt lgkmcnt(8)
    v_mfma_f32_32x32x16_bf16 v[0:15], v[156:159], v[196:199], v[0:15]
    ds_read_b64_tr_b16 v[152:153], v203 offset:2464
    ds_read_b64_tr_b16 v[154:155], v203 offset:3616
    s_waitcnt lgkmcnt(8)
    v_mfma_f32_32x32x16_bf16 v[16:31], v[160:163], v[196:199], v[16:31]
    ds_read_b64_tr_b16 v[156:157], v203 offset:2496
    ds_read_b64_tr_b16 v[158:159], v203 offset:3648
    s_waitcnt lgkmcnt(8)
    v_mfma_f32_32x32x16_bf16 v[32:47], v[164:167], v[196:199], v[32:47]
    ds_read_b64_tr_b16 v[160:161], v203 offset:2528
    ds_read_b64_tr_b16 v[162:163], v203 offset:3680
    s_waitcnt lgkmcnt(8)
    v_mfma_f32_32x32x16_bf16 v[48:63], v[144:147], v[196:199], v[48:63]
    ds_read_b64_tr_b16 v[164:165], v203 offset:2560
    ds_read_b64_tr_b16 v[166:167], v203 offset:3712
    s_waitcnt lgkmcnt(8)
    v_mfma_f32_32x32x16_bf16 v[64:79], v[148:151], v[196:199], v[64:79]
    s_waitcnt vmcnt(7)
    s_barrier
    s_add_u32 s38, s36, 884736
    s_add_u32 m0, s32, 37376
    s_nop 0
    buffer_load_dwordx4 v204, s[20:23], s38 offen lds
    s_add_u32 m0, s33, 37376
    s_nop 0
    buffer_load_dwordx4 v205, s[24:27], s38 offen lds
    s_add_u32 m0, s34, 37376
    s_nop 0
    buffer_load_dwordx4 v206, s[28:31], s38 offen lds
    ds_read_b64_tr_b16 v[144:145], v200 offset:0
    ds_read_b64_tr_b16 v[146:147], v200 offset:1152
    s_waitcnt lgkmcnt(8)
    v_mfma_f32_32x32x16_bf16 v[80:95], v[152:155], v[196:199], v[80:95]
    ds_read_b64_tr_b16 v[148:149], v200 offset:32
    ds_read_b64_tr_b16 v[150:151], v200 offset:1184
    s_waitcnt lgkmcnt(8)
    v_mfma_f32_32x32x16_bf16 v[96:111], v[156:159], v[196:199], v[96:111]
    ds_read_b64_tr_b16 v[152:153], v200 offset:64
    ds_read_b64_tr_b16 v[154:155], v200 offset:1216
    s_waitcnt lgkmcnt(8)
    v_mfma_f32_32x32x16_bf16 v[112:127], v[160:163], v[196:199], v[112:127]
    ds_read_b64_tr_b16 v[156:157], v200 offset:96
    ds_read_b64_tr_b16 v[158:159], v200 offset:1248
    s_waitcnt lgkmcnt(8)
    v_mfma_f32_32x32x16_bf16 v[128:143], v[164:167], v[196:199], v[128:143]
    ds_read_b64_tr_b16 v[160:161], v200 offset:128
    ds_read_b64_tr_b16 v[162:163], v200 offset:1280
    s_waitcnt lgkmcnt(8)
    v_mfma_f32_32x32x16_bf16 v[0:15], v[144:147], v[168:171], v[0:15]
    s_add_u32 s39, s37, 14336
    buffer_load_dwordx4 v[192:195], v207, s[12:15], s39 offen offset:0
    buffer_load_dwordx4 v[196:199], v207, s[12:15], s39 offen offset:1024
    ds_read_b64_tr_b16 v[164:165], v200 offset:160
    ds_read_b64_tr_b16 v[166:167], v200 offset:1312
    s_waitcnt lgkmcnt(8)
    v_mfma_f32_32x32x16_bf16 v[16:31], v[148:151], v[168:171], v[16:31]
    ds_read_b64_tr_b16 v[144:145], v200 offset:192
    ds_read_b64_tr_b16 v[146:147], v200 offset:1344
    s_waitcnt lgkmcnt(8)
    v_mfma_f32_32x32x16_bf16 v[32:47], v[152:155], v[168:171], v[32:47]
    ds_read_b64_tr_b16 v[148:149], v200 offset:224
    ds_read_b64_tr_b16 v[150:151], v200 offset:1376
    s_waitcnt lgkmcnt(8)
    v_mfma_f32_32x32x16_bf16 v[48:63], v[156:159], v[168:171], v[48:63]
    ds_read_b64_tr_b16 v[152:153], v200 offset:256
    ds_read_b64_tr_b16 v[154:155], v200 offset:1408
    s_waitcnt lgkmcnt(8)
    v_mfma_f32_32x32x16_bf16 v[64:79], v[160:163], v[168:171], v[64:79]
    ds_read_b64_tr_b16 v[156:157], v200 offset:2304
    ds_read_b64_tr_b16 v[158:159], v200 offset:3456
    s_waitcnt lgkmcnt(8)
    v_mfma_f32_32x32x16_bf16 v[80:95], v[164:167], v[168:171], v[80:95]
    ds_read_b64_tr_b16 v[160:161], v200 offset:2336
    ds_read_b64_tr_b16 v[162:163], v200 offset:3488
    s_waitcnt lgkmcnt(8)
    v_mfma_f32_32x32x16_bf16 v[96:111], v[144:147], v[168:171], v[96:111]
    ds_read_b64_tr_b16 v[164:165], v200 offset:2368
    ds_read_b64_tr_b16 v[166:167], v200 offset:3520
    s_waitcnt lgkmcnt(8)
    v_mfma_f32_32x32x16_bf16 v[112:127], v[148:151], v[168:171], v[112:127]
    ds_read_b64_tr_b16 v[144:145], v200 offset:2400
    ds_read_b64_tr_b16 v[146:147], v200 offset:3552
    s_waitcnt lgkmcnt(8)
    v_mfma_f32_32x32x16_bf16 v[128:143], v[152:155], v[168:171], v[128:143]
    ds_read_b64_tr_b16 v[148:149], v200 offset:2432
    ds_read_b64_tr_b16 v[150:151], v200 offset:3584
    s_waitcnt lgkmcnt(8)
    v_mfma_f32_32x32x16_bf16 v[0:15], v[156:159], v[172:175], v[0:15]
    ds_read_b64_tr_b16 v[152:153], v200 offset:2464
    ds_read_b64_tr_b16 v[154:155], v200 offset:3616
    s_waitcnt lgkmcnt(8)
    v_mfma_f32_32x32x16_bf16 v[16:31], v[160:163], v[172:175], v[16:31]
    ds_read_b64_tr_b16 v[156:157], v200 offset:2496
    ds_read_b64_tr_b16 v[158:159], v200 offset:3648
    s_waitcnt lgkmcnt(8)
    v_mfma_f32_32x32x16_bf16 v[32:47], v[164:167], v[172:175], v[32:47]
    ds_read_b64_tr_b16 v[160:161], v200 offset:2528
    ds_read_b64_tr_b16 v[162:163], v200 offset:3680
    s_waitcnt lgkmcnt(8)
    v_mfma_f32_32x32x16_bf16 v[48:63], v[144:147], v[172:175], v[48:63]
    ds_read_b64_tr_b16 v[164:165], v200 offset:2560
    ds_read_b64_tr_b16 v[166:167], v200 offset:3712
    s_waitcnt lgkmcnt(8)
    v_mfma_f32_32x32x16_bf16 v[64:79], v[148:151], v[172:175], v[64:79]
    s_waitcnt vmcnt(7)
    s_barrier
    s_add_u32 s38, s36, 1032192
    s_add_u32 m0, s32, 56064
    s_nop 0
    buffer_load_dwordx4 v204, s[20:23], s38 offen lds
    s_add_u32 m0, s33, 56064
    s_nop 0
    buffer_load_dwordx4 v205, s[24:27], s38 offen lds
    s_add_u32 m0, s34, 56064
    s_nop 0
    buffer_load_dwordx4 v206, s[28:31], s38 offen lds
    ds_read_b64_tr_b16 v[144:145], v201 offset:0
    ds_read_b64_tr_b16 v[146:147], v201 offset:1152
    s_waitcnt lgkmcnt(8)
    v_mfma_f32_32x32x16_bf16 v[80:95], v[152:155], v[172:175], v[80:95]
    ds_read_b64_tr_b16 v[148:149], v201 offset:32
    ds_read_b64_tr_b16 v[150:151], v201 offset:1184
    s_waitcnt lgkmcnt(8)
    v_mfma_f32_32x32x16_bf16 v[96:111], v[156:159], v[172:175], v[96:111]
    ds_read_b64_tr_b16 v[152:153], v201 offset:64
    ds_read_b64_tr_b16 v[154:155], v201 offset:1216
    s_waitcnt lgkmcnt(8)
    v_mfma_f32_32x32x16_bf16 v[112:127], v[160:163], v[172:175], v[112:127]
    ds_read_b64_tr_b16 v[156:157], v201 offset:96
    ds_read_b64_tr_b16 v[158:159], v201 offset:1248
    s_waitcnt lgkmcnt(8)
    v_mfma_f32_32x32x16_bf16 v[128:143], v[164:167], v[172:175], v[128:143]
    ds_read_b64_tr_b16 v[160:161], v201 offset:128
    ds_read_b64_tr_b16 v[162:163], v201 offset:1280
    s_waitcnt lgkmcnt(8)
    v_mfma_f32_32x32x16_bf16 v[0:15], v[144:147], v[176:179], v[0:15]
    s_add_u32 s39, s37, 16384
    buffer_load_dwordx4 v[168:171], v207, s[12:15], s39 offen offset:0
    buffer_load_dwordx4 v[172:175], v207, s[12:15], s39 offen offset:1024
    ds_read_b64_tr_b16 v[164:165], v201 offset:160
    ds_read_b64_tr_b16 v[166:167], v201 offset:1312
    s_waitcnt lgkmcnt(8)
    v_mfma_f32_32x32x16_bf16 v[16:31], v[148:151], v[176:179], v[16:31]
    ds_read_b64_tr_b16 v[144:145], v201 offset:192
    ds_read_b64_tr_b16 v[146:147], v201 offset:1344
    s_waitcnt lgkmcnt(8)
    v_mfma_f32_32x32x16_bf16 v[32:47], v[152:155], v[176:179], v[32:47]
    ds_read_b64_tr_b16 v[148:149], v201 offset:224
    ds_read_b64_tr_b16 v[150:151], v201 offset:1376
    s_waitcnt lgkmcnt(8)
    v_mfma_f32_32x32x16_bf16 v[48:63], v[156:159], v[176:179], v[48:63]
    ds_read_b64_tr_b16 v[152:153], v201 offset:256
    ds_read_b64_tr_b16 v[154:155], v201 offset:1408
    s_waitcnt lgkmcnt(8)
    v_mfma_f32_32x32x16_bf16 v[64:79], v[160:163], v[176:179], v[64:79]
    ds_read_b64_tr_b16 v[156:157], v201 offset:2304
    ds_read_b64_tr_b16 v[158:159], v201 offset:3456
    s_waitcnt lgkmcnt(8)
    v_mfma_f32_32x32x16_bf16 v[80:95], v[164:167], v[176:179], v[80:95]
    ds_read_b64_tr_b16 v[160:161], v201 offset:2336
    ds_read_b64_tr_b16 v[162:163], v201 offset:3488
    s_waitcnt lgkmcnt(8)
    v_mfma_f32_32x32x16_bf16 v[96:111], v[144:147], v[176:179], v[96:111]
    ds_read_b64_tr_b16 v[164:165], v201 offset:2368
    ds_read_b64_tr_b16 v[166:167], v201 offset:3520
    s_waitcnt lgkmcnt(8)
    v_mfma_f32_32x32x16_bf16 v[112:127], v[148:151], v[176:179], v[112:127]
    ds_read_b64_tr_b16 v[144:145], v201 offset:2400
    ds_read_b64_tr_b16 v[146:147], v201 offset:3552
    s_waitcnt lgkmcnt(8)
    v_mfma_f32_32x32x16_bf16 v[128:143], v[152:155], v[176:179], v[128:143]
    ds_read_b64_tr_b16 v[148:149], v201 offset:2432
    ds_read_b64_tr_b16 v[150:151], v201 offset:3584
    s_waitcnt lgkmcnt(8)
    v_mfma_f32_32x32x16_bf16 v[0:15], v[156:159], v[180:183], v[0:15]
    ds_read_b64_tr_b16 v[152:153], v201 offset:2464
    ds_read_b64_tr_b16 v[154:155], v201 offset:3616
    s_waitcnt lgkmcnt(8)
    v_mfma_f32_32x32x16_bf16 v[16:31], v[160:163], v[180:183], v[16:31]
    ds_read_b64_tr_b16 v[156:157], v201 offset:2496
    ds_read_b64_tr_b16 v[158:159], v201 offset:3648
    s_waitcnt lgkmcnt(8)
    v_mfma_f32_32x32x16_bf16 v[32:47], v[164:167], v[180:183], v[32:47]
    ds_read_b64_tr_b16 v[160:161], v201 offset:2528
    ds_read_b64_tr_b16 v[162:163], v201 offset:3680
    s_waitcnt lgkmcnt(8)
    v_mfma_f32_32x32x16_bf16 v[48:63], v[144:147], v[180:183], v[48:63]
    ds_read_b64_tr_b16 v[164:165], v201 offset:2560
    ds_read_b64_tr_b16 v[166:167], v201 offset:3712
    s_waitcnt lgkmcnt(8)
    v_mfma_f32_32x32x16_bf16 v[64:79], v[148:151], v[180:183], v[64:79]
    s_waitcnt vmcnt(7)
    s_barrier
    s_add_u32 s38, s36, 1179648
    s_add_u32 m0, s32, 0
    s_nop 0
    buffer_load_dwordx4 v204, s[20:23], s38 offen lds
    s_add_u32 m0, s33, 0
    s_nop 0
    buffer_load_dwordx4 v205, s[24:27], s38 offen lds
    s_add_u32 m0, s34, 0
    s_nop 0
    buffer_load_dwordx4 v206, s[28:31], s38 offen lds
    ds_read_b64_tr_b16 v[144:145], v202 offset:0
    ds_read_b64_tr_b16 v[146:147], v202 offset:1152
    s_waitcnt lgkmcnt(8)
    v_mfma_f32_32x32x16_bf16 v[80:95], v[152:155], v[180:183], v[80:95]
    ds_read_b64_tr_b16 v[148:149], v202 offset:32
    ds_read_b64_tr_b16 v[150:151], v202 offset:1184
    s_waitcnt lgkmcnt(8)
    v_mfma_f32_32x32x16_bf16 v[96:111], v[156:159], v[180:183], v[96:111]
    ds_read_b64_tr_b16 v[152:153], v202 offset:64
    ds_read_b64_tr_b16 v[154:155], v202 offset:1216
    s_waitcnt lgkmcnt(8)
    v_mfma_f32_32x32x16_bf16 v[112:127], v[160:163], v[180:183], v[112:127]
    ds_read_b64_tr_b16 v[156:157], v202 offset:96
    ds_read_b64_tr_b16 v[158:159], v202 offset:1248
    s_waitcnt lgkmcnt(8)
    v_mfma_f32_32x32x16_bf16 v[128:143], v[164:167], v[180:183], v[128:143]
    ds_read_b64_tr_b16 v[160:161], v202 offset:128
    ds_read_b64_tr_b16 v[162:163], v202 offset:1280
    s_waitcnt lgkmcnt(8)
    v_mfma_f32_32x32x16_bf16 v[0:15], v[144:147], v[184:187], v[0:15]
    s_add_u32 s39, s37, 18432
    buffer_load_dwordx4 v[176:179], v207, s[12:15], s39 offen offset:0
    buffer_load_dwordx4 v[180:183], v207, s[12:15], s39 offen offset:1024
    ds_read_b64_tr_b16 v[164:165], v202 offset:160
    ds_read_b64_tr_b16 v[166:167], v202 offset:1312
    s_waitcnt lgkmcnt(8)
    v_mfma_f32_32x32x16_bf16 v[16:31], v[148:151], v[184:187], v[16:31]
    ds_read_b64_tr_b16 v[144:145], v202 offset:192
    ds_read_b64_tr_b16 v[146:147], v202 offset:1344
    s_waitcnt lgkmcnt(8)
    v_mfma_f32_32x32x16_bf16 v[32:47], v[152:155], v[184:187], v[32:47]
    ds_read_b64_tr_b16 v[148:149], v202 offset:224
    ds_read_b64_tr_b16 v[150:151], v202 offset:1376
    s_waitcnt lgkmcnt(8)
    v_mfma_f32_32x32x16_bf16 v[48:63], v[156:159], v[184:187], v[48:63]
    ds_read_b64_tr_b16 v[152:153], v202 offset:256
    ds_read_b64_tr_b16 v[154:155], v202 offset:1408
    s_waitcnt lgkmcnt(8)
    v_mfma_f32_32x32x16_bf16 v[64:79], v[160:163], v[184:187], v[64:79]
    ds_read_b64_tr_b16 v[156:157], v202 offset:2304
    ds_read_b64_tr_b16 v[158:159], v202 offset:3456
    s_waitcnt lgkmcnt(8)
    v_mfma_f32_32x32x16_bf16 v[80:95], v[164:167], v[184:187], v[80:95]
    ds_read_b64_tr_b16 v[160:161], v202 offset:2336
    ds_read_b64_tr_b16 v[162:163], v202 offset:3488
    s_waitcnt lgkmcnt(8)
    v_mfma_f32_32x32x16_bf16 v[96:111], v[144:147], v[184:187], v[96:111]
    ds_read_b64_tr_b16 v[164:165], v202 offset:2368
    ds_read_b64_tr_b16 v[166:167], v202 offset:3520
    s_waitcnt lgkmcnt(8)
    v_mfma_f32_32x32x16_bf16 v[112:127], v[148:151], v[184:187], v[112:127]
    ds_read_b64_tr_b16 v[144:145], v202 offset:2400
    ds_read_b64_tr_b16 v[146:147], v202 offset:3552
    s_waitcnt lgkmcnt(8)
    v_mfma_f32_32x32x16_bf16 v[128:143], v[152:155], v[184:187], v[128:143]
    ds_read_b64_tr_b16 v[148:149], v202 offset:2432
    ds_read_b64_tr_b16 v[150:151], v202 offset:3584
    s_waitcnt lgkmcnt(8)
    v_mfma_f32_32x32x16_bf16 v[0:15], v[156:159], v[188:191], v[0:15]
    ds_read_b64_tr_b16 v[152:153], v202 offset:2464
    ds_read_b64_tr_b16 v[154:155], v202 offset:3616
    s_waitcnt lgkmcnt(8)
    v_mfma_f32_32x32x16_bf16 v[16:31], v[160:163], v[188:191], v[16:31]
    ds_read_b64_tr_b16 v[156:157], v202 offset:2496
    ds_read_b64_tr_b16 v[158:159], v202 offset:3648
    s_waitcnt lgkmcnt(8)
    v_mfma_f32_32x32x16_bf16 v[32:47], v[164:167], v[188:191], v[32:47]
    ds_read_b64_tr_b16 v[160:161], v202 offset:2528
    ds_read_b64_tr_b16 v[162:163], v202 offset:3680
    s_waitcnt lgkmcnt(8)
    v_mfma_f32_32x32x16_bf16 v[48:63], v[144:147], v[188:191], v[48:63]
    ds_read_b64_tr_b16 v[164:165], v202 offset:2560
    ds_read_b64_tr_b16 v[166:167], v202 offset:3712
    s_waitcnt lgkmcnt(8)
    v_mfma_f32_32x32x16_bf16 v[64:79], v[148:151], v[188:191], v[64:79]
    s_waitcnt vmcnt(7)
    s_barrier
    s_add_u32 s38, s36, 1327104
    s_add_u32 m0, s32, 18688
    s_nop 0
    buffer_load_dwordx4 v204, s[20:23], s38 offen lds
    s_add_u32 m0, s33, 18688
    s_nop 0
    buffer_load_dwordx4 v205, s[24:27], s38 offen lds
    s_add_u32 m0, s34, 18688
    s_nop 0
    buffer_load_dwordx4 v206, s[28:31], s38 offen lds
    ds_read_b64_tr_b16 v[144:145], v203 offset:0
    ds_read_b64_tr_b16 v[146:147], v203 offset:1152
    s_waitcnt lgkmcnt(8)
    v_mfma_f32_32x32x16_bf16 v[80:95], v[152:155], v[188:191], v[80:95]
    ds_read_b64_tr_b16 v[148:149], v203 offset:32
    ds_read_b64_tr_b16 v[150:151], v203 offset:1184
    s_waitcnt lgkmcnt(8)
    v_mfma_f32_32x32x16_bf16 v[96:111], v[156:159], v[188:191], v[96:111]
    ds_read_b64_tr_b16 v[152:153], v203 offset:64
    ds_read_b64_tr_b16 v[154:155], v203 offset:1216
    s_waitcnt lgkmcnt(8)
    v_mfma_f32_32x32x16_bf16 v[112:127], v[160:163], v[188:191], v[112:127]
    ds_read_b64_tr_b16 v[156:157], v203 offset:96
    ds_read_b64_tr_b16 v[158:159], v203 offset:1248
    s_waitcnt lgkmcnt(8)
    v_mfma_f32_32x32x16_bf16 v[128:143], v[164:167], v[188:191], v[128:143]
    ds_read_b64_tr_b16 v[160:161], v203 offset:128
    ds_read_b64_tr_b16 v[162:163], v203 offset:1280
    s_waitcnt lgkmcnt(8)
    v_mfma_f32_32x32x16_bf16 v[0:15], v[144:147], v[192:195], v[0:15]
    s_add_u32 s39, s37, 20480
    buffer_load_dwordx4 v[184:187], v207, s[12:15], s39 offen offset:0
    buffer_load_dwordx4 v[188:191], v207, s[12:15], s39 offen offset:1024
    ds_read_b64_tr_b16 v[164:165], v203 offset:160
    ds_read_b64_tr_b16 v[166:167], v203 offset:1312
    s_waitcnt lgkmcnt(8)
    v_mfma_f32_32x32x16_bf16 v[16:31], v[148:151], v[192:195], v[16:31]
    ds_read_b64_tr_b16 v[144:145], v203 offset:192
    ds_read_b64_tr_b16 v[146:147], v203 offset:1344
    s_waitcnt lgkmcnt(8)
    v_mfma_f32_32x32x16_bf16 v[32:47], v[152:155], v[192:195], v[32:47]
    ds_read_b64_tr_b16 v[148:149], v203 offset:224
    ds_read_b64_tr_b16 v[150:151], v203 offset:1376
    s_waitcnt lgkmcnt(8)
    v_mfma_f32_32x32x16_bf16 v[48:63], v[156:159], v[192:195], v[48:63]
    ds_read_b64_tr_b16 v[152:153], v203 offset:256
    ds_read_b64_tr_b16 v[154:155], v203 offset:1408
    s_waitcnt lgkmcnt(8)
    v_mfma_f32_32x32x16_bf16 v[64:79], v[160:163], v[192:195], v[64:79]
    ds_read_b64_tr_b16 v[156:157], v203 offset:2304
    ds_read_b64_tr_b16 v[158:159], v203 offset:3456
    s_waitcnt lgkmcnt(8)
    v_mfma_f32_32x32x16_bf16 v[80:95], v[164:167], v[192:195], v[80:95]
    ds_read_b64_tr_b16 v[160:161], v203 offset:2336
    ds_read_b64_tr_b16 v[162:163], v203 offset:3488
    s_waitcnt lgkmcnt(8)
    v_mfma_f32_32x32x16_bf16 v[96:111], v[144:147], v[192:195], v[96:111]
    ds_read_b64_tr_b16 v[164:165], v203 offset:2368
    ds_read_b64_tr_b16 v[166:167], v203 offset:3520
    s_waitcnt lgkmcnt(8)
    v_mfma_f32_32x32x16_bf16 v[112:127], v[148:151], v[192:195], v[112:127]
    ds_read_b64_tr_b16 v[144:145], v203 offset:2400
    ds_read_b64_tr_b16 v[146:147], v203 offset:3552
    s_waitcnt lgkmcnt(8)
    v_mfma_f32_32x32x16_bf16 v[128:143], v[152:155], v[192:195], v[128:143]
    ds_read_b64_tr_b16 v[148:149], v203 offset:2432
    ds_read_b64_tr_b16 v[150:151], v203 offset:3584
    s_waitcnt lgkmcnt(8)
    v_mfma_f32_32x32x16_bf16 v[0:15], v[156:159], v[196:199], v[0:15]
    ds_read_b64_tr_b16 v[152:153], v203 offset:2464
    ds_read_b64_tr_b16 v[154:155], v203 offset:3616
    s_waitcnt lgkmcnt(8)
    v_mfma_f32_32x32x16_bf16 v[16:31], v[160:163], v[196:199], v[16:31]
    ds_read_b64_tr_b16 v[156:157], v203 offset:2496
    ds_read_b64_tr_b16 v[158:159], v203 offset:3648
    s_waitcnt lgkmcnt(8)
    v_mfma_f32_32x32x16_bf16 v[32:47], v[164:167], v[196:199], v[32:47]
    ds_read_b64_tr_b16 v[160:161], v203 offset:2528
    ds_read_b64_tr_b16 v[162:163], v203 offset:3680
    s_waitcnt lgkmcnt(8)
    v_mfma_f32_32x32x16_bf16 v[48:63], v[144:147], v[196:199], v[48:63]
    ds_read_b64_tr_b16 v[164:165], v203 offset:2560
    ds_read_b64_tr_b16 v[166:167], v203 offset:3712
    s_waitcnt lgkmcnt(8)
    v_mfma_f32_32x32x16_bf16 v[64:79], v[148:151], v[196:199], v[64:79]
    s_waitcnt vmcnt(7)
    s_barrier
    s_add_u32 s38, s36, 1474560
    s_add_u32 m0, s32, 37376
    s_nop 0
    buffer_load_dwordx4 v204, s[20:23], s38 offen lds
    s_add_u32 m0, s33, 37376
    s_nop 0
    buffer_load_dwordx4 v205, s[24:27], s38 offen lds
    s_add_u32 m0, s34, 37376
    s_nop 0
    buffer_load_dwordx4 v206, s[28:31], s38 offen lds
    ds_read_b64_tr_b16 v[144:145], v200 offset:0
    ds_read_b64_tr_b16 v[146:147], v200 offset:1152
    s_waitcnt lgkmcnt(8)
    v_mfma_f32_32x32x16_bf16 v[80:95], v[152:155], v[196:199], v[80:95]
    ds_read_b64_tr_b16 v[148:149], v200 offset:32
    ds_read_b64_tr_b16 v[150:151], v200 offset:1184
    s_waitcnt lgkmcnt(8)
    v_mfma_f32_32x32x16_bf16 v[96:111], v[156:159], v[196:199], v[96:111]
    ds_read_b64_tr_b16 v[152:153], v200 offset:64
    ds_read_b64_tr_b16 v[154:155], v200 offset:1216
    s_waitcnt lgkmcnt(8)
    v_mfma_f32_32x32x16_bf16 v[112:127], v[160:163], v[196:199], v[112:127]
    ds_read_b64_tr_b16 v[156:157], v200 offset:96
    ds_read_b64_tr_b16 v[158:159], v200 offset:1248
    s_waitcnt lgkmcnt(8)
    v_mfma_f32_32x32x16_bf16 v[128:143], v[164:167], v[196:199], v[128:143]
    ds_read_b64_tr_b16 v[160:161], v200 offset:128
    ds_read_b64_tr_b16 v[162:163], v200 offset:1280
    s_waitcnt lgkmcnt(8)
    v_mfma_f32_32x32x16_bf16 v[0:15], v[144:147], v[168:171], v[0:15]
    s_add_u32 s39, s37, 22528
    buffer_load_dwordx4 v[192:195], v207, s[12:15], s39 offen offset:0
    buffer_load_dwordx4 v[196:199], v207, s[12:15], s39 offen offset:1024
    ds_read_b64_tr_b16 v[164:165], v200 offset:160
    ds_read_b64_tr_b16 v[166:167], v200 offset:1312
    s_waitcnt lgkmcnt(8)
    v_mfma_f32_32x32x16_bf16 v[16:31], v[148:151], v[168:171], v[16:31]
    ds_read_b64_tr_b16 v[144:145], v200 offset:192
    ds_read_b64_tr_b16 v[146:147], v200 offset:1344
    s_waitcnt lgkmcnt(8)
    v_mfma_f32_32x32x16_bf16 v[32:47], v[152:155], v[168:171], v[32:47]
    ds_read_b64_tr_b16 v[148:149], v200 offset:224
    ds_read_b64_tr_b16 v[150:151], v200 offset:1376
    s_waitcnt lgkmcnt(8)
    v_mfma_f32_32x32x16_bf16 v[48:63], v[156:159], v[168:171], v[48:63]
    ds_read_b64_tr_b16 v[152:153], v200 offset:256
    ds_read_b64_tr_b16 v[154:155], v200 offset:1408
    s_waitcnt lgkmcnt(8)
    v_mfma_f32_32x32x16_bf16 v[64:79], v[160:163], v[168:171], v[64:79]
    ds_read_b64_tr_b16 v[156:157], v200 offset:2304
    ds_read_b64_tr_b16 v[158:159], v200 offset:3456
    s_waitcnt lgkmcnt(8)
    v_mfma_f32_32x32x16_bf16 v[80:95], v[164:167], v[168:171], v[80:95]
    ds_read_b64_tr_b16 v[160:161], v200 offset:2336
    ds_read_b64_tr_b16 v[162:163], v200 offset:3488
    s_waitcnt lgkmcnt(8)
    v_mfma_f32_32x32x16_bf16 v[96:111], v[144:147], v[168:171], v[96:111]
    ds_read_b64_tr_b16 v[164:165], v200 offset:2368
    ds_read_b64_tr_b16 v[166:167], v200 offset:3520
    s_waitcnt lgkmcnt(8)
    v_mfma_f32_32x32x16_bf16 v[112:127], v[148:151], v[168:171], v[112:127]
    ds_read_b64_tr_b16 v[144:145], v200 offset:2400
    ds_read_b64_tr_b16 v[146:147], v200 offset:3552
    s_waitcnt lgkmcnt(8)
    v_mfma_f32_32x32x16_bf16 v[128:143], v[152:155], v[168:171], v[128:143]
    ds_read_b64_tr_b16 v[148:149], v200 offset:2432
    ds_read_b64_tr_b16 v[150:151], v200 offset:3584
    s_waitcnt lgkmcnt(8)
    v_mfma_f32_32x32x16_bf16 v[0:15], v[156:159], v[172:175], v[0:15]
    ds_read_b64_tr_b16 v[152:153], v200 offset:2464
    ds_read_b64_tr_b16 v[154:155], v200 offset:3616
    s_waitcnt lgkmcnt(8)
    v_mfma_f32_32x32x16_bf16 v[16:31], v[160:163], v[172:175], v[16:31]
    ds_read_b64_tr_b16 v[156:157], v200 offset:2496
    ds_read_b64_tr_b16 v[158:159], v200 offset:3648
    s_waitcnt lgkmcnt(8)
    v_mfma_f32_32x32x16_bf16 v[32:47], v[164:167], v[172:175], v[32:47]
    ds_read_b64_tr_b16 v[160:161], v200 offset:2528
    ds_read_b64_tr_b16 v[162:163], v200 offset:3680
    s_waitcnt lgkmcnt(8)
    v_mfma_f32_32x32x16_bf16 v[48:63], v[144:147], v[172:175], v[48:63]
    ds_read_b64_tr_b16 v[164:165], v200 offset:2560
    ds_read_b64_tr_b16 v[166:167], v200 offset:3712
    s_waitcnt lgkmcnt(8)
    v_mfma_f32_32x32x16_bf16 v[64:79], v[148:151], v[172:175], v[64:79]
    s_waitcnt vmcnt(7)
    s_barrier
    s_add_u32 s38, s36, 1622016
    s_add_u32 m0, s32, 56064
    s_nop 0
    buffer_load_dwordx4 v204, s[20:23], s38 offen lds
    s_add_u32 m0, s33, 56064
    s_nop 0
    buffer_load_dwordx4 v205, s[24:27], s38 offen lds
    s_add_u32 m0, s34, 56064
    s_nop 0
    buffer_load_dwordx4 v206, s[28:31], s38 offen lds
    ds_read_b64_tr_b16 v[144:145], v201 offset:0
    ds_read_b64_tr_b16 v[146:147], v201 offset:1152
    s_waitcnt lgkmcnt(8)
    v_mfma_f32_32x32x16_bf16 v[80:95], v[152:155], v[172:175], v[80:95]
    ds_read_b64_tr_b16 v[148:149], v201 offset:32
    ds_read_b64_tr_b16 v[150:151], v201 offset:1184
    s_waitcnt lgkmcnt(8)
    v_mfma_f32_32x32x16_bf16 v[96:111], v[156:159], v[172:175], v[96:111]
    ds_read_b64_tr_b16 v[152:153], v201 offset:64
    ds_read_b64_tr_b16 v[154:155], v201 offset:1216
    s_waitcnt lgkmcnt(8)
    v_mfma_f32_32x32x16_bf16 v[112:127], v[160:163], v[172:175], v[112:127]
    ds_read_b64_tr_b16 v[156:157], v201 offset:96
    ds_read_b64_tr_b16 v[158:159], v201 offset:1248
    s_waitcnt lgkmcnt(8)
    v_mfma_f32_32x32x16_bf16 v[128:143], v[164:167], v[172:175], v[128:143]
    ds_read_b64_tr_b16 v[160:161], v201 offset:128
    ds_read_b64_tr_b16 v[162:163], v201 offset:1280
    s_waitcnt lgkmcnt(8)
    v_mfma_f32_32x32x16_bf16 v[0:15], v[144:147], v[176:179], v[0:15]
    s_add_u32 s39, s37, 24576
    buffer_load_dwordx4 v[168:171], v207, s[12:15], s39 offen offset:0
    buffer_load_dwordx4 v[172:175], v207, s[12:15], s39 offen offset:1024
    ds_read_b64_tr_b16 v[164:165], v201 offset:160
    ds_read_b64_tr_b16 v[166:167], v201 offset:1312
    s_waitcnt lgkmcnt(8)
    v_mfma_f32_32x32x16_bf16 v[16:31], v[148:151], v[176:179], v[16:31]
    ds_read_b64_tr_b16 v[144:145], v201 offset:192
    ds_read_b64_tr_b16 v[146:147], v201 offset:1344
    s_waitcnt lgkmcnt(8)
    v_mfma_f32_32x32x16_bf16 v[32:47], v[152:155], v[176:179], v[32:47]
    ds_read_b64_tr_b16 v[148:149], v201 offset:224
    ds_read_b64_tr_b16 v[150:151], v201 offset:1376
    s_waitcnt lgkmcnt(8)
    v_mfma_f32_32x32x16_bf16 v[48:63], v[156:159], v[176:179], v[48:63]
    ds_read_b64_tr_b16 v[152:153], v201 offset:256
    ds_read_b64_tr_b16 v[154:155], v201 offset:1408
    s_waitcnt lgkmcnt(8)
    v_mfma_f32_32x32x16_bf16 v[64:79], v[160:163], v[176:179], v[64:79]
    ds_read_b64_tr_b16 v[156:157], v201 offset:2304
    ds_read_b64_tr_b16 v[158:159], v201 offset:3456
    s_waitcnt lgkmcnt(8)
    v_mfma_f32_32x32x16_bf16 v[80:95], v[164:167], v[176:179], v[80:95]
    ds_read_b64_tr_b16 v[160:161], v201 offset:2336
    ds_read_b64_tr_b16 v[162:163], v201 offset:3488
    s_waitcnt lgkmcnt(8)
    v_mfma_f32_32x32x16_bf16 v[96:111], v[144:147], v[176:179], v[96:111]
    ds_read_b64_tr_b16 v[164:165], v201 offset:2368
    ds_read_b64_tr_b16 v[166:167], v201 offset:3520
    s_waitcnt lgkmcnt(8)
    v_mfma_f32_32x32x16_bf16 v[112:127], v[148:151], v[176:179], v[112:127]
    ds_read_b64_tr_b16 v[144:145], v201 offset:2400
    ds_read_b64_tr_b16 v[146:147], v201 offset:3552
    s_waitcnt lgkmcnt(8)
    v_mfma_f32_32x32x16_bf16 v[128:143], v[152:155], v[176:179], v[128:143]
    ds_read_b64_tr_b16 v[148:149], v201 offset:2432
    ds_read_b64_tr_b16 v[150:151], v201 offset:3584
    s_waitcnt lgkmcnt(8)
    v_mfma_f32_32x32x16_bf16 v[0:15], v[156:159], v[180:183], v[0:15]
    ds_read_b64_tr_b16 v[152:153], v201 offset:2464
    ds_read_b64_tr_b16 v[154:155], v201 offset:3616
    s_waitcnt lgkmcnt(8)
    v_mfma_f32_32x32x16_bf16 v[16:31], v[160:163], v[180:183], v[16:31]
    ds_read_b64_tr_b16 v[156:157], v201 offset:2496
    ds_read_b64_tr_b16 v[158:159], v201 offset:3648
    s_waitcnt lgkmcnt(8)
    v_mfma_f32_32x32x16_bf16 v[32:47], v[164:167], v[180:183], v[32:47]
    ds_read_b64_tr_b16 v[160:161], v201 offset:2528
    ds_read_b64_tr_b16 v[162:163], v201 offset:3680
    s_waitcnt lgkmcnt(8)
    v_mfma_f32_32x32x16_bf16 v[48:63], v[144:147], v[180:183], v[48:63]
    ds_read_b64_tr_b16 v[164:165], v201 offset:2560
    ds_read_b64_tr_b16 v[166:167], v201 offset:3712
    s_waitcnt lgkmcnt(8)
    v_mfma_f32_32x32x16_bf16 v[64:79], v[148:151], v[180:183], v[64:79]
    s_waitcnt vmcnt(7)
    s_barrier
    s_add_u32 s38, s36, 1769472
    s_add_u32 m0, s32, 0
    s_nop 0
    buffer_load_dwordx4 v204, s[20:23], s38 offen lds
    s_add_u32 m0, s33, 0
    s_nop 0
    buffer_load_dwordx4 v205, s[24:27], s38 offen lds
    s_add_u32 m0, s34, 0
    s_nop 0
    buffer_load_dwordx4 v206, s[28:31], s38 offen lds
    ds_read_b64_tr_b16 v[144:145], v202 offset:0
    ds_read_b64_tr_b16 v[146:147], v202 offset:1152
    s_waitcnt lgkmcnt(8)
    v_mfma_f32_32x32x16_bf16 v[80:95], v[152:155], v[180:183], v[80:95]
    ds_read_b64_tr_b16 v[148:149], v202 offset:32
    ds_read_b64_tr_b16 v[150:151], v202 offset:1184
    s_waitcnt lgkmcnt(8)
    v_mfma_f32_32x32x16_bf16 v[96:111], v[156:159], v[180:183], v[96:111]
    ds_read_b64_tr_b16 v[152:153], v202 offset:64
    ds_read_b64_tr_b16 v[154:155], v202 offset:1216
    s_waitcnt lgkmcnt(8)
    v_mfma_f32_32x32x16_bf16 v[112:127], v[160:163], v[180:183], v[112:127]
    ds_read_b64_tr_b16 v[156:157], v202 offset:96
    ds_read_b64_tr_b16 v[158:159], v202 offset:1248
    s_waitcnt lgkmcnt(8)
    v_mfma_f32_32x32x16_bf16 v[128:143], v[164:167], v[180:183], v[128:143]
    ds_read_b64_tr_b16 v[160:161], v202 offset:128
    ds_read_b64_tr_b16 v[162:163], v202 offset:1280
    s_waitcnt lgkmcnt(8)
    v_mfma_f32_32x32x16_bf16 v[0:15], v[144:147], v[184:187], v[0:15]
    s_add_u32 s39, s37, 26624
    buffer_load_dwordx4 v[176:179], v207, s[12:15], s39 offen offset:0
    buffer_load_dwordx4 v[180:183], v207, s[12:15], s39 offen offset:1024
    ds_read_b64_tr_b16 v[164:165], v202 offset:160
    ds_read_b64_tr_b16 v[166:167], v202 offset:1312
    s_waitcnt lgkmcnt(8)
    v_mfma_f32_32x32x16_bf16 v[16:31], v[148:151], v[184:187], v[16:31]
    ds_read_b64_tr_b16 v[144:145], v202 offset:192
    ds_read_b64_tr_b16 v[146:147], v202 offset:1344
    s_waitcnt lgkmcnt(8)
    v_mfma_f32_32x32x16_bf16 v[32:47], v[152:155], v[184:187], v[32:47]
    ds_read_b64_tr_b16 v[148:149], v202 offset:224
    ds_read_b64_tr_b16 v[150:151], v202 offset:1376
    s_waitcnt lgkmcnt(8)
    v_mfma_f32_32x32x16_bf16 v[48:63], v[156:159], v[184:187], v[48:63]
    ds_read_b64_tr_b16 v[152:153], v202 offset:256
    ds_read_b64_tr_b16 v[154:155], v202 offset:1408
    s_waitcnt lgkmcnt(8)
    v_mfma_f32_32x32x16_bf16 v[64:79], v[160:163], v[184:187], v[64:79]
    ds_read_b64_tr_b16 v[156:157], v202 offset:2304
    ds_read_b64_tr_b16 v[158:159], v202 offset:3456
    s_waitcnt lgkmcnt(8)
    v_mfma_f32_32x32x16_bf16 v[80:95], v[164:167], v[184:187], v[80:95]
    ds_read_b64_tr_b16 v[160:161], v202 offset:2336
    ds_read_b64_tr_b16 v[162:163], v202 offset:3488
    s_waitcnt lgkmcnt(8)
    v_mfma_f32_32x32x16_bf16 v[96:111], v[144:147], v[184:187], v[96:111]
    ds_read_b64_tr_b16 v[164:165], v202 offset:2368
    ds_read_b64_tr_b16 v[166:167], v202 offset:3520
    s_waitcnt lgkmcnt(8)
    v_mfma_f32_32x32x16_bf16 v[112:127], v[148:151], v[184:187], v[112:127]
    ds_read_b64_tr_b16 v[144:145], v202 offset:2400
    ds_read_b64_tr_b16 v[146:147], v202 offset:3552
    s_waitcnt lgkmcnt(8)
    v_mfma_f32_32x32x16_bf16 v[128:143], v[152:155], v[184:187], v[128:143]
    ds_read_b64_tr_b16 v[148:149], v202 offset:2432
    ds_read_b64_tr_b16 v[150:151], v202 offset:3584
    s_waitcnt lgkmcnt(8)
    v_mfma_f32_32x32x16_bf16 v[0:15], v[156:159], v[188:191], v[0:15]
    ds_read_b64_tr_b16 v[152:153], v202 offset:2464
    ds_read_b64_tr_b16 v[154:155], v202 offset:3616
    s_waitcnt lgkmcnt(8)
    v_mfma_f32_32x32x16_bf16 v[16:31], v[160:163], v[188:191], v[16:31]
    ds_read_b64_tr_b16 v[156:157], v202 offset:2496
    ds_read_b64_tr_b16 v[158:159], v202 offset:3648
    s_waitcnt lgkmcnt(8)
    v_mfma_f32_32x32x16_bf16 v[32:47], v[164:167], v[188:191], v[32:47]
    ds_read_b64_tr_b16 v[160:161], v202 offset:2528
    ds_read_b64_tr_b16 v[162:163], v202 offset:3680
    s_waitcnt lgkmcnt(8)
    v_mfma_f32_32x32x16_bf16 v[48:63], v[144:147], v[188:191], v[48:63]
    ds_read_b64_tr_b16 v[164:165], v202 offset:2560
    ds_read_b64_tr_b16 v[166:167], v202 offset:3712
    s_waitcnt lgkmcnt(8)
    v_mfma_f32_32x32x16_bf16 v[64:79], v[148:151], v[188:191], v[64:79]
    s_waitcnt vmcnt(7)
    s_barrier
    s_add_u32 s38, s36, 1916928
    s_add_u32 m0, s32, 18688
    s_nop 0
    buffer_load_dwordx4 v204, s[20:23], s38 offen lds
    s_add_u32 m0, s33, 18688
    s_nop 0
    buffer_load_dwordx4 v205, s[24:27], s38 offen lds
    s_add_u32 m0, s34, 18688
    s_nop 0
    buffer_load_dwordx4 v206, s[28:31], s38 offen lds
    ds_read_b64_tr_b16 v[144:145], v203 offset:0
    ds_read_b64_tr_b16 v[146:147], v203 offset:1152
    s_waitcnt lgkmcnt(8)
    v_mfma_f32_32x32x16_bf16 v[80:95], v[152:155], v[188:191], v[80:95]
    ds_read_b64_tr_b16 v[148:149], v203 offset:32
    ds_read_b64_tr_b16 v[150:151], v203 offset:1184
    s_waitcnt lgkmcnt(8)
    v_mfma_f32_32x32x16_bf16 v[96:111], v[156:159], v[188:191], v[96:111]
    ds_read_b64_tr_b16 v[152:153], v203 offset:64
    ds_read_b64_tr_b16 v[154:155], v203 offset:1216
    s_waitcnt lgkmcnt(8)
    v_mfma_f32_32x32x16_bf16 v[112:127], v[160:163], v[188:191], v[112:127]
    ds_read_b64_tr_b16 v[156:157], v203 offset:96
    ds_read_b64_tr_b16 v[158:159], v203 offset:1248
    s_waitcnt lgkmcnt(8)
    v_mfma_f32_32x32x16_bf16 v[128:143], v[164:167], v[188:191], v[128:143]
    ds_read_b64_tr_b16 v[160:161], v203 offset:128
    ds_read_b64_tr_b16 v[162:163], v203 offset:1280
    s_waitcnt lgkmcnt(8)
    v_mfma_f32_32x32x16_bf16 v[0:15], v[144:147], v[192:195], v[0:15]
    s_add_u32 s39, s37, 28672
    buffer_load_dwordx4 v[184:187], v207, s[12:15], s39 offen offset:0
    buffer_load_dwordx4 v[188:191], v207, s[12:15], s39 offen offset:1024
    ds_read_b64_tr_b16 v[164:165], v203 offset:160
    ds_read_b64_tr_b16 v[166:167], v203 offset:1312
    s_waitcnt lgkmcnt(8)
    v_mfma_f32_32x32x16_bf16 v[16:31], v[148:151], v[192:195], v[16:31]
    ds_read_b64_tr_b16 v[144:145], v203 offset:192
    ds_read_b64_tr_b16 v[146:147], v203 offset:1344
    s_waitcnt lgkmcnt(8)
    v_mfma_f32_32x32x16_bf16 v[32:47], v[152:155], v[192:195], v[32:47]
    ds_read_b64_tr_b16 v[148:149], v203 offset:224
    ds_read_b64_tr_b16 v[150:151], v203 offset:1376
    s_waitcnt lgkmcnt(8)
    v_mfma_f32_32x32x16_bf16 v[48:63], v[156:159], v[192:195], v[48:63]
    ds_read_b64_tr_b16 v[152:153], v203 offset:256
    ds_read_b64_tr_b16 v[154:155], v203 offset:1408
    s_waitcnt lgkmcnt(8)
    v_mfma_f32_32x32x16_bf16 v[64:79], v[160:163], v[192:195], v[64:79]
    ds_read_b64_tr_b16 v[156:157], v203 offset:2304
    ds_read_b64_tr_b16 v[158:159], v203 offset:3456
    s_waitcnt lgkmcnt(8)
    v_mfma_f32_32x32x16_bf16 v[80:95], v[164:167], v[192:195], v[80:95]
    ds_read_b64_tr_b16 v[160:161], v203 offset:2336
    ds_read_b64_tr_b16 v[162:163], v203 offset:3488
    s_waitcnt lgkmcnt(8)
    v_mfma_f32_32x32x16_bf16 v[96:111], v[144:147], v[192:195], v[96:111]
    ds_read_b64_tr_b16 v[164:165], v203 offset:2368
    ds_read_b64_tr_b16 v[166:167], v203 offset:3520
    s_waitcnt lgkmcnt(8)
    v_mfma_f32_32x32x16_bf16 v[112:127], v[148:151], v[192:195], v[112:127]
    ds_read_b64_tr_b16 v[144:145], v203 offset:2400
    ds_read_b64_tr_b16 v[146:147], v203 offset:3552
    s_waitcnt lgkmcnt(8)
    v_mfma_f32_32x32x16_bf16 v[128:143], v[152:155], v[192:195], v[128:143]
    ds_read_b64_tr_b16 v[148:149], v203 offset:2432
    ds_read_b64_tr_b16 v[150:151], v203 offset:3584
    s_waitcnt lgkmcnt(8)
    v_mfma_f32_32x32x16_bf16 v[0:15], v[156:159], v[196:199], v[0:15]
    ds_read_b64_tr_b16 v[152:153], v203 offset:2464
    ds_read_b64_tr_b16 v[154:155], v203 offset:3616
    s_waitcnt lgkmcnt(8)
    v_mfma_f32_32x32x16_bf16 v[16:31], v[160:163], v[196:199], v[16:31]
    ds_read_b64_tr_b16 v[156:157], v203 offset:2496
    ds_read_b64_tr_b16 v[158:159], v203 offset:3648
    s_waitcnt lgkmcnt(8)
    v_mfma_f32_32x32x16_bf16 v[32:47], v[164:167], v[196:199], v[32:47]
    ds_read_b64_tr_b16 v[160:161], v203 offset:2528
    ds_read_b64_tr_b16 v[162:163], v203 offset:3680
    s_waitcnt lgkmcnt(8)
    v_mfma_f32_32x32x16_bf16 v[48:63], v[144:147], v[196:199], v[48:63]
    ds_read_b64_tr_b16 v[164:165], v203 offset:2560
    ds_read_b64_tr_b16 v[166:167], v203 offset:3712
    s_waitcnt lgkmcnt(8)
    v_mfma_f32_32x32x16_bf16 v[64:79], v[148:151], v[196:199], v[64:79]
    s_waitcnt vmcnt(7)
    s_barrier
    s_add_u32 s38, s36, 2064384
    s_add_u32 m0, s32, 37376
    s_nop 0
    buffer_load_dwordx4 v204, s[20:23], s38 offen lds
    s_add_u32 m0, s33, 37376
    s_nop 0
    buffer_load_dwordx4 v205, s[24:27], s38 offen lds
    s_add_u32 m0, s34, 37376
    s_nop 0
    buffer_load_dwordx4 v206, s[28:31], s38 offen lds
    ds_read_b64_tr_b16 v[144:145], v200 offset:0
    ds_read_b64_tr_b16 v[146:147], v200 offset:1152
    s_waitcnt lgkmcnt(8)
    v_mfma_f32_32x32x16_bf16 v[80:95], v[152:155], v[196:199], v[80:95]
    ds_read_b64_tr_b16 v[148:149], v200 offset:32
    ds_read_b64_tr_b16 v[150:151], v200 offset:1184
    s_waitcnt lgkmcnt(8)
    v_mfma_f32_32x32x16_bf16 v[96:111], v[156:159], v[196:199], v[96:111]
    ds_read_b64_tr_b16 v[152:153], v200 offset:64
    ds_read_b64_tr_b16 v[154:155], v200 offset:1216
    s_waitcnt lgkmcnt(8)
    v_mfma_f32_32x32x16_bf16 v[112:127], v[160:163], v[196:199], v[112:127]
    ds_read_b64_tr_b16 v[156:157], v200 offset:96
    ds_read_b64_tr_b16 v[158:159], v200 offset:1248
    s_waitcnt lgkmcnt(8)
    v_mfma_f32_32x32x16_bf16 v[128:143], v[164:167], v[196:199], v[128:143]
    ds_read_b64_tr_b16 v[160:161], v200 offset:128
    ds_read_b64_tr_b16 v[162:163], v200 offset:1280
    s_waitcnt lgkmcnt(8)
    v_mfma_f32_32x32x16_bf16 v[0:15], v[144:147], v[168:171], v[0:15]
    s_add_u32 s39, s37, 30720
    buffer_load_dwordx4 v[192:195], v207, s[12:15], s39 offen offset:0
    buffer_load_dwordx4 v[196:199], v207, s[12:15], s39 offen offset:1024
    ds_read_b64_tr_b16 v[164:165], v200 offset:160
    ds_read_b64_tr_b16 v[166:167], v200 offset:1312
    s_waitcnt lgkmcnt(8)
    v_mfma_f32_32x32x16_bf16 v[16:31], v[148:151], v[168:171], v[16:31]
    ds_read_b64_tr_b16 v[144:145], v200 offset:192
    ds_read_b64_tr_b16 v[146:147], v200 offset:1344
    s_waitcnt lgkmcnt(8)
    v_mfma_f32_32x32x16_bf16 v[32:47], v[152:155], v[168:171], v[32:47]
    ds_read_b64_tr_b16 v[148:149], v200 offset:224
    ds_read_b64_tr_b16 v[150:151], v200 offset:1376
    s_waitcnt lgkmcnt(8)
    v_mfma_f32_32x32x16_bf16 v[48:63], v[156:159], v[168:171], v[48:63]
    ds_read_b64_tr_b16 v[152:153], v200 offset:256
    ds_read_b64_tr_b16 v[154:155], v200 offset:1408
    s_waitcnt lgkmcnt(8)
    v_mfma_f32_32x32x16_bf16 v[64:79], v[160:163], v[168:171], v[64:79]
    ds_read_b64_tr_b16 v[156:157], v200 offset:2304
    ds_read_b64_tr_b16 v[158:159], v200 offset:3456
    s_waitcnt lgkmcnt(8)
    v_mfma_f32_32x32x16_bf16 v[80:95], v[164:167], v[168:171], v[80:95]
    ds_read_b64_tr_b16 v[160:161], v200 offset:2336
    ds_read_b64_tr_b16 v[162:163], v200 offset:3488
    s_waitcnt lgkmcnt(8)
    v_mfma_f32_32x32x16_bf16 v[96:111], v[144:147], v[168:171], v[96:111]
    ds_read_b64_tr_b16 v[164:165], v200 offset:2368
    ds_read_b64_tr_b16 v[166:167], v200 offset:3520
    s_waitcnt lgkmcnt(8)
    v_mfma_f32_32x32x16_bf16 v[112:127], v[148:151], v[168:171], v[112:127]
    ds_read_b64_tr_b16 v[144:145], v200 offset:2400
    ds_read_b64_tr_b16 v[146:147], v200 offset:3552
    s_waitcnt lgkmcnt(8)
    v_mfma_f32_32x32x16_bf16 v[128:143], v[152:155], v[168:171], v[128:143]
    ds_read_b64_tr_b16 v[148:149], v200 offset:2432
    ds_read_b64_tr_b16 v[150:151], v200 offset:3584
    s_waitcnt lgkmcnt(8)
    v_mfma_f32_32x32x16_bf16 v[0:15], v[156:159], v[172:175], v[0:15]
    ds_read_b64_tr_b16 v[152:153], v200 offset:2464
    ds_read_b64_tr_b16 v[154:155], v200 offset:3616
    s_waitcnt lgkmcnt(8)
    v_mfma_f32_32x32x16_bf16 v[16:31], v[160:163], v[172:175], v[16:31]
    ds_read_b64_tr_b16 v[156:157], v200 offset:2496
    ds_read_b64_tr_b16 v[158:159], v200 offset:3648
    s_waitcnt lgkmcnt(8)
    v_mfma_f32_32x32x16_bf16 v[32:47], v[164:167], v[172:175], v[32:47]
    ds_read_b64_tr_b16 v[160:161], v200 offset:2528
    ds_read_b64_tr_b16 v[162:163], v200 offset:3680
    s_waitcnt lgkmcnt(8)
    v_mfma_f32_32x32x16_bf16 v[48:63], v[144:147], v[172:175], v[48:63]
    ds_read_b64_tr_b16 v[164:165], v200 offset:2560
    ds_read_b64_tr_b16 v[166:167], v200 offset:3712
    s_waitcnt lgkmcnt(8)
    v_mfma_f32_32x32x16_bf16 v[64:79], v[148:151], v[172:175], v[64:79]
    s_waitcnt vmcnt(7)
    s_barrier
    s_add_u32 s38, s36, 2211840
    s_add_u32 m0, s32, 56064
    s_nop 0
    buffer_load_dwordx4 v204, s[20:23], s38 offen lds
    s_add_u32 m0, s33, 56064
    s_nop 0
    buffer_load_dwordx4 v205, s[24:27], s38 offen lds
    s_add_u32 m0, s34, 56064
    s_nop 0
    buffer_load_dwordx4 v206, s[28:31], s38 offen lds
    ds_read_b64_tr_b16 v[144:145], v201 offset:0
    ds_read_b64_tr_b16 v[146:147], v201 offset:1152
    s_waitcnt lgkmcnt(8)
    v_mfma_f32_32x32x16_bf16 v[80:95], v[152:155], v[172:175], v[80:95]
    ds_read_b64_tr_b16 v[148:149], v201 offset:32
    ds_read_b64_tr_b16 v[150:151], v201 offset:1184
    s_waitcnt lgkmcnt(8)
    v_mfma_f32_32x32x16_bf16 v[96:111], v[156:159], v[172:175], v[96:111]
    ds_read_b64_tr_b16 v[152:153], v201 offset:64
    ds_read_b64_tr_b16 v[154:155], v201 offset:1216
    s_waitcnt lgkmcnt(8)
    v_mfma_f32_32x32x16_bf16 v[112:127], v[160:163], v[172:175], v[112:127]
    ds_read_b64_tr_b16 v[156:157], v201 offset:96
    ds_read_b64_tr_b16 v[158:159], v201 offset:1248
    s_waitcnt lgkmcnt(8)
    v_mfma_f32_32x32x16_bf16 v[128:143], v[164:167], v[172:175], v[128:143]
    ds_read_b64_tr_b16 v[160:161], v201 offset:128
    ds_read_b64_tr_b16 v[162:163], v201 offset:1280
    s_waitcnt lgkmcnt(8)
    v_mfma_f32_32x32x16_bf16 v[0:15], v[144:147], v[176:179], v[0:15]
    s_add_u32 s39, s37, 32768
    buffer_load_dwordx4 v[168:171], v207, s[12:15], s39 offen offset:0
    buffer_load_dwordx4 v[172:175], v207, s[12:15], s39 offen offset:1024
    ds_read_b64_tr_b16 v[164:165], v201 offset:160
    ds_read_b64_tr_b16 v[166:167], v201 offset:1312
    s_waitcnt lgkmcnt(8)
    v_mfma_f32_32x32x16_bf16 v[16:31], v[148:151], v[176:179], v[16:31]
    ds_read_b64_tr_b16 v[144:145], v201 offset:192
    ds_read_b64_tr_b16 v[146:147], v201 offset:1344
    s_waitcnt lgkmcnt(8)
    v_mfma_f32_32x32x16_bf16 v[32:47], v[152:155], v[176:179], v[32:47]
    ds_read_b64_tr_b16 v[148:149], v201 offset:224
    ds_read_b64_tr_b16 v[150:151], v201 offset:1376
    s_waitcnt lgkmcnt(8)
    v_mfma_f32_32x32x16_bf16 v[48:63], v[156:159], v[176:179], v[48:63]
    ds_read_b64_tr_b16 v[152:153], v201 offset:256
    ds_read_b64_tr_b16 v[154:155], v201 offset:1408
    s_waitcnt lgkmcnt(8)
    v_mfma_f32_32x32x16_bf16 v[64:79], v[160:163], v[176:179], v[64:79]
    ds_read_b64_tr_b16 v[156:157], v201 offset:2304
    ds_read_b64_tr_b16 v[158:159], v201 offset:3456
    s_waitcnt lgkmcnt(8)
    v_mfma_f32_32x32x16_bf16 v[80:95], v[164:167], v[176:179], v[80:95]
    ds_read_b64_tr_b16 v[160:161], v201 offset:2336
    ds_read_b64_tr_b16 v[162:163], v201 offset:3488
    s_waitcnt lgkmcnt(8)
    v_mfma_f32_32x32x16_bf16 v[96:111], v[144:147], v[176:179], v[96:111]
    ds_read_b64_tr_b16 v[164:165], v201 offset:2368
    ds_read_b64_tr_b16 v[166:167], v201 offset:3520
    s_waitcnt lgkmcnt(8)
    v_mfma_f32_32x32x16_bf16 v[112:127], v[148:151], v[176:179], v[112:127]
    ds_read_b64_tr_b16 v[144:145], v201 offset:2400
    ds_read_b64_tr_b16 v[146:147], v201 offset:3552
    s_waitcnt lgkmcnt(8)
    v_mfma_f32_32x32x16_bf16 v[128:143], v[152:155], v[176:179], v[128:143]
    ds_read_b64_tr_b16 v[148:149], v201 offset:2432
    ds_read_b64_tr_b16 v[150:151], v201 offset:3584
    s_waitcnt lgkmcnt(8)
    v_mfma_f32_32x32x16_bf16 v[0:15], v[156:159], v[180:183], v[0:15]
    ds_read_b64_tr_b16 v[152:153], v201 offset:2464
    ds_read_b64_tr_b16 v[154:155], v201 offset:3616
    s_waitcnt lgkmcnt(8)
    v_mfma_f32_32x32x16_bf16 v[16:31], v[160:163], v[180:183], v[16:31]
    ds_read_b64_tr_b16 v[156:157], v201 offset:2496
    ds_read_b64_tr_b16 v[158:159], v201 offset:3648
    s_waitcnt lgkmcnt(8)
    v_mfma_f32_32x32x16_bf16 v[32:47], v[164:167], v[180:183], v[32:47]
    ds_read_b64_tr_b16 v[160:161], v201 offset:2528
    ds_read_b64_tr_b16 v[162:163], v201 offset:3680
    s_waitcnt lgkmcnt(8)
    v_mfma_f32_32x32x16_bf16 v[48:63], v[144:147], v[180:183], v[48:63]
    ds_read_b64_tr_b16 v[164:165], v201 offset:2560
    ds_read_b64_tr_b16 v[166:167], v201 offset:3712
    s_waitcnt lgkmcnt(8)
    v_mfma_f32_32x32x16_bf16 v[64:79], v[148:151], v[180:183], v[64:79]
    s_waitcnt vmcnt(7)
    s_barrier
    s_add_u32 s38, s36, 2359296
    s_add_u32 m0, s32, 0
    s_nop 0
    buffer_load_dwordx4 v204, s[20:23], s38 offen lds
    s_add_u32 m0, s33, 0
    s_nop 0
    buffer_load_dwordx4 v205, s[24:27], s38 offen lds
    s_add_u32 m0, s34, 0
    s_nop 0
    buffer_load_dwordx4 v206, s[28:31], s38 offen lds
    ds_read_b64_tr_b16 v[144:145], v202 offset:0
    ds_read_b64_tr_b16 v[146:147], v202 offset:1152
    s_waitcnt lgkmcnt(8)
    v_mfma_f32_32x32x16_bf16 v[80:95], v[152:155], v[180:183], v[80:95]
    ds_read_b64_tr_b16 v[148:149], v202 offset:32
    ds_read_b64_tr_b16 v[150:151], v202 offset:1184
    s_waitcnt lgkmcnt(8)
    v_mfma_f32_32x32x16_bf16 v[96:111], v[156:159], v[180:183], v[96:111]
    ds_read_b64_tr_b16 v[152:153], v202 offset:64
    ds_read_b64_tr_b16 v[154:155], v202 offset:1216
    s_waitcnt lgkmcnt(8)
    v_mfma_f32_32x32x16_bf16 v[112:127], v[160:163], v[180:183], v[112:127]
    ds_read_b64_tr_b16 v[156:157], v202 offset:96
    ds_read_b64_tr_b16 v[158:159], v202 offset:1248
    s_waitcnt lgkmcnt(8)
    v_mfma_f32_32x32x16_bf16 v[128:143], v[164:167], v[180:183], v[128:143]
    ds_read_b64_tr_b16 v[160:161], v202 offset:128
    ds_read_b64_tr_b16 v[162:163], v202 offset:1280
    s_waitcnt lgkmcnt(8)
    v_mfma_f32_32x32x16_bf16 v[0:15], v[144:147], v[184:187], v[0:15]
    s_add_u32 s39, s37, 34816
    buffer_load_dwordx4 v[176:179], v207, s[12:15], s39 offen offset:0
    buffer_load_dwordx4 v[180:183], v207, s[12:15], s39 offen offset:1024
    ds_read_b64_tr_b16 v[164:165], v202 offset:160
    ds_read_b64_tr_b16 v[166:167], v202 offset:1312
    s_waitcnt lgkmcnt(8)
    v_mfma_f32_32x32x16_bf16 v[16:31], v[148:151], v[184:187], v[16:31]
    ds_read_b64_tr_b16 v[144:145], v202 offset:192
    ds_read_b64_tr_b16 v[146:147], v202 offset:1344
    s_waitcnt lgkmcnt(8)
    v_mfma_f32_32x32x16_bf16 v[32:47], v[152:155], v[184:187], v[32:47]
    ds_read_b64_tr_b16 v[148:149], v202 offset:224
    ds_read_b64_tr_b16 v[150:151], v202 offset:1376
    s_waitcnt lgkmcnt(8)
    v_mfma_f32_32x32x16_bf16 v[48:63], v[156:159], v[184:187], v[48:63]
    ds_read_b64_tr_b16 v[152:153], v202 offset:256
    ds_read_b64_tr_b16 v[154:155], v202 offset:1408
    s_waitcnt lgkmcnt(8)
    v_mfma_f32_32x32x16_bf16 v[64:79], v[160:163], v[184:187], v[64:79]
    ds_read_b64_tr_b16 v[156:157], v202 offset:2304
    ds_read_b64_tr_b16 v[158:159], v202 offset:3456
    s_waitcnt lgkmcnt(8)
    v_mfma_f32_32x32x16_bf16 v[80:95], v[164:167], v[184:187], v[80:95]
    ds_read_b64_tr_b16 v[160:161], v202 offset:2336
    ds_read_b64_tr_b16 v[162:163], v202 offset:3488
    s_waitcnt lgkmcnt(8)
    v_mfma_f32_32x32x16_bf16 v[96:111], v[144:147], v[184:187], v[96:111]
    ds_read_b64_tr_b16 v[164:165], v202 offset:2368
    ds_read_b64_tr_b16 v[166:167], v202 offset:3520
    s_waitcnt lgkmcnt(8)
    v_mfma_f32_32x32x16_bf16 v[112:127], v[148:151], v[184:187], v[112:127]
    ds_read_b64_tr_b16 v[144:145], v202 offset:2400
    ds_read_b64_tr_b16 v[146:147], v202 offset:3552
    s_waitcnt lgkmcnt(8)
    v_mfma_f32_32x32x16_bf16 v[128:143], v[152:155], v[184:187], v[128:143]
    ds_read_b64_tr_b16 v[148:149], v202 offset:2432
    ds_read_b64_tr_b16 v[150:151], v202 offset:3584
    s_waitcnt lgkmcnt(8)
    v_mfma_f32_32x32x16_bf16 v[0:15], v[156:159], v[188:191], v[0:15]
    ds_read_b64_tr_b16 v[152:153], v202 offset:2464
    ds_read_b64_tr_b16 v[154:155], v202 offset:3616
    s_waitcnt lgkmcnt(8)
    v_mfma_f32_32x32x16_bf16 v[16:31], v[160:163], v[188:191], v[16:31]
    ds_read_b64_tr_b16 v[156:157], v202 offset:2496
    ds_read_b64_tr_b16 v[158:159], v202 offset:3648
    s_waitcnt lgkmcnt(8)
    v_mfma_f32_32x32x16_bf16 v[32:47], v[164:167], v[188:191], v[32:47]
    ds_read_b64_tr_b16 v[160:161], v202 offset:2528
    ds_read_b64_tr_b16 v[162:163], v202 offset:3680
    s_waitcnt lgkmcnt(8)
    v_mfma_f32_32x32x16_bf16 v[48:63], v[144:147], v[188:191], v[48:63]
    ds_read_b64_tr_b16 v[164:165], v202 offset:2560
    ds_read_b64_tr_b16 v[166:167], v202 offset:3712
    s_waitcnt lgkmcnt(8)
    v_mfma_f32_32x32x16_bf16 v[64:79], v[148:151], v[188:191], v[64:79]
    s_waitcnt vmcnt(7)
    s_barrier
    s_add_u32 s38, s36, 2506752
    s_add_u32 m0, s32, 18688
    s_nop 0
    buffer_load_dwordx4 v204, s[20:23], s38 offen lds
    s_add_u32 m0, s33, 18688
    s_nop 0
    buffer_load_dwordx4 v205, s[24:27], s38 offen lds
    s_add_u32 m0, s34, 18688
    s_nop 0
    buffer_load_dwordx4 v206, s[28:31], s38 offen lds
    ds_read_b64_tr_b16 v[144:145], v203 offset:0
    ds_read_b64_tr_b16 v[146:147], v203 offset:1152
    s_waitcnt lgkmcnt(8)
    v_mfma_f32_32x32x16_bf16 v[80:95], v[152:155], v[188:191], v[80:95]
    ds_read_b64_tr_b16 v[148:149], v203 offset:32
    ds_read_b64_tr_b16 v[150:151], v203 offset:1184
    s_waitcnt lgkmcnt(8)
    v_mfma_f32_32x32x16_bf16 v[96:111], v[156:159], v[188:191], v[96:111]
    ds_read_b64_tr_b16 v[152:153], v203 offset:64
    ds_read_b64_tr_b16 v[154:155], v203 offset:1216
    s_waitcnt lgkmcnt(8)
    v_mfma_f32_32x32x16_bf16 v[112:127], v[160:163], v[188:191], v[112:127]
    ds_read_b64_tr_b16 v[156:157], v203 offset:96
    ds_read_b64_tr_b16 v[158:159], v203 offset:1248
    s_waitcnt lgkmcnt(8)
    v_mfma_f32_32x32x16_bf16 v[128:143], v[164:167], v[188:191], v[128:143]
    ds_read_b64_tr_b16 v[160:161], v203 offset:128
    ds_read_b64_tr_b16 v[162:163], v203 offset:1280
    s_waitcnt lgkmcnt(8)
    v_mfma_f32_32x32x16_bf16 v[0:15], v[144:147], v[192:195], v[0:15]
    ds_read_b64_tr_b16 v[164:165], v203 offset:160
    ds_read_b64_tr_b16 v[166:167], v203 offset:1312
    s_waitcnt lgkmcnt(8)
    v_mfma_f32_32x32x16_bf16 v[16:31], v[148:151], v[192:195], v[16:31]
    ds_read_b64_tr_b16 v[144:145], v203 offset:192
    ds_read_b64_tr_b16 v[146:147], v203 offset:1344
    s_waitcnt lgkmcnt(8)
    v_mfma_f32_32x32x16_bf16 v[32:47], v[152:155], v[192:195], v[32:47]
    ds_read_b64_tr_b16 v[148:149], v203 offset:224
    ds_read_b64_tr_b16 v[150:151], v203 offset:1376
    s_waitcnt lgkmcnt(8)
    v_mfma_f32_32x32x16_bf16 v[48:63], v[156:159], v[192:195], v[48:63]
    ds_read_b64_tr_b16 v[152:153], v203 offset:256
    ds_read_b64_tr_b16 v[154:155], v203 offset:1408
    s_waitcnt lgkmcnt(8)
    v_mfma_f32_32x32x16_bf16 v[64:79], v[160:163], v[192:195], v[64:79]
    ds_read_b64_tr_b16 v[156:157], v203 offset:2304
    ds_read_b64_tr_b16 v[158:159], v203 offset:3456
    s_waitcnt lgkmcnt(8)
    v_mfma_f32_32x32x16_bf16 v[80:95], v[164:167], v[192:195], v[80:95]
    ds_read_b64_tr_b16 v[160:161], v203 offset:2336
    ds_read_b64_tr_b16 v[162:163], v203 offset:3488
    s_waitcnt lgkmcnt(8)
    v_mfma_f32_32x32x16_bf16 v[96:111], v[144:147], v[192:195], v[96:111]
    ds_read_b64_tr_b16 v[164:165], v203 offset:2368
    ds_read_b64_tr_b16 v[166:167], v203 offset:3520
    s_waitcnt lgkmcnt(8)
    v_mfma_f32_32x32x16_bf16 v[112:127], v[148:151], v[192:195], v[112:127]
    ds_read_b64_tr_b16 v[144:145], v203 offset:2400
    ds_read_b64_tr_b16 v[146:147], v203 offset:3552
    s_waitcnt lgkmcnt(8)
    v_mfma_f32_32x32x16_bf16 v[128:143], v[152:155], v[192:195], v[128:143]
    ds_read_b64_tr_b16 v[148:149], v203 offset:2432
    ds_read_b64_tr_b16 v[150:151], v203 offset:3584
    s_waitcnt lgkmcnt(8)
    v_mfma_f32_32x32x16_bf16 v[0:15], v[156:159], v[196:199], v[0:15]
    ds_read_b64_tr_b16 v[152:153], v203 offset:2464
    ds_read_b64_tr_b16 v[154:155], v203 offset:3616
    s_waitcnt lgkmcnt(8)
    v_mfma_f32_32x32x16_bf16 v[16:31], v[160:163], v[196:199], v[16:31]
    ds_read_b64_tr_b16 v[156:157], v203 offset:2496
    ds_read_b64_tr_b16 v[158:159], v203 offset:3648
    s_waitcnt lgkmcnt(8)
    v_mfma_f32_32x32x16_bf16 v[32:47], v[164:167], v[196:199], v[32:47]
    ds_read_b64_tr_b16 v[160:161], v203 offset:2528
    ds_read_b64_tr_b16 v[162:163], v203 offset:3680
    s_waitcnt lgkmcnt(8)
    v_mfma_f32_32x32x16_bf16 v[48:63], v[144:147], v[196:199], v[48:63]
    ds_read_b64_tr_b16 v[164:165], v203 offset:2560
    ds_read_b64_tr_b16 v[166:167], v203 offset:3712
    s_waitcnt lgkmcnt(8)
    v_mfma_f32_32x32x16_bf16 v[64:79], v[148:151], v[196:199], v[64:79]
    s_waitcnt vmcnt(5)
    s_barrier
    ds_read_b64_tr_b16 v[144:145], v200 offset:0
    ds_read_b64_tr_b16 v[146:147], v200 offset:1152
    s_waitcnt lgkmcnt(8)
    v_mfma_f32_32x32x16_bf16 v[80:95], v[152:155], v[196:199], v[80:95]
    ds_read_b64_tr_b16 v[148:149], v200 offset:32
    ds_read_b64_tr_b16 v[150:151], v200 offset:1184
    s_waitcnt lgkmcnt(8)
    v_mfma_f32_32x32x16_bf16 v[96:111], v[156:159], v[196:199], v[96:111]
    ds_read_b64_tr_b16 v[152:153], v200 offset:64
    ds_read_b64_tr_b16 v[154:155], v200 offset:1216
    s_waitcnt lgkmcnt(8)
    v_mfma_f32_32x32x16_bf16 v[112:127], v[160:163], v[196:199], v[112:127]
    ds_read_b64_tr_b16 v[156:157], v200 offset:96
    ds_read_b64_tr_b16 v[158:159], v200 offset:1248
    s_waitcnt lgkmcnt(8)
    v_mfma_f32_32x32x16_bf16 v[128:143], v[164:167], v[196:199], v[128:143]
    ds_read_b64_tr_b16 v[160:161], v200 offset:128
    ds_read_b64_tr_b16 v[162:163], v200 offset:1280
    s_waitcnt lgkmcnt(8)
    v_mfma_f32_32x32x16_bf16 v[0:15], v[144:147], v[168:171], v[0:15]
    ds_read_b64_tr_b16 v[164:165], v200 offset:160
    ds_read_b64_tr_b16 v[166:167], v200 offset:1312
    s_waitcnt lgkmcnt(8)
    v_mfma_f32_32x32x16_bf16 v[16:31], v[148:151], v[168:171], v[16:31]
    ds_read_b64_tr_b16 v[144:145], v200 offset:192
    ds_read_b64_tr_b16 v[146:147], v200 offset:1344
    s_waitcnt lgkmcnt(8)
    v_mfma_f32_32x32x16_bf16 v[32:47], v[152:155], v[168:171], v[32:47]
    ds_read_b64_tr_b16 v[148:149], v200 offset:224
    ds_read_b64_tr_b16 v[150:151], v200 offset:1376
    s_waitcnt lgkmcnt(8)
    v_mfma_f32_32x32x16_bf16 v[48:63], v[156:159], v[168:171], v[48:63]
    ds_read_b64_tr_b16 v[152:153], v200 offset:256
    ds_read_b64_tr_b16 v[154:155], v200 offset:1408
    s_waitcnt lgkmcnt(8)
    v_mfma_f32_32x32x16_bf16 v[64:79], v[160:163], v[168:171], v[64:79]
    ds_read_b64_tr_b16 v[156:157], v200 offset:2304
    ds_read_b64_tr_b16 v[158:159], v200 offset:3456
    s_waitcnt lgkmcnt(8)
    v_mfma_f32_32x32x16_bf16 v[80:95], v[164:167], v[168:171], v[80:95]
    ds_read_b64_tr_b16 v[160:161], v200 offset:2336
    ds_read_b64_tr_b16 v[162:163], v200 offset:3488
    s_waitcnt lgkmcnt(8)
    v_mfma_f32_32x32x16_bf16 v[96:111], v[144:147], v[168:171], v[96:111]
    ds_read_b64_tr_b16 v[164:165], v200 offset:2368
    ds_read_b64_tr_b16 v[166:167], v200 offset:3520
    s_waitcnt lgkmcnt(8)
    v_mfma_f32_32x32x16_bf16 v[112:127], v[148:151], v[168:171], v[112:127]
    ds_read_b64_tr_b16 v[144:145], v200 offset:2400
    ds_read_b64_tr_b16 v[146:147], v200 offset:3552
    s_waitcnt lgkmcnt(8)
    v_mfma_f32_32x32x16_bf16 v[128:143], v[152:155], v[168:171], v[128:143]
    ds_read_b64_tr_b16 v[148:149], v200 offset:2432
    ds_read_b64_tr_b16 v[150:151], v200 offset:3584
    s_waitcnt lgkmcnt(8)
    v_mfma_f32_32x32x16_bf16 v[0:15], v[156:159], v[172:175], v[0:15]
    ds_read_b64_tr_b16 v[152:153], v200 offset:2464
    ds_read_b64_tr_b16 v[154:155], v200 offset:3616
    s_waitcnt lgkmcnt(8)
    v_mfma_f32_32x32x16_bf16 v[16:31], v[160:163], v[172:175], v[16:31]
    ds_read_b64_tr_b16 v[156:157], v200 offset:2496
    ds_read_b64_tr_b16 v[158:159], v200 offset:3648
    s_waitcnt lgkmcnt(8)
    v_mfma_f32_32x32x16_bf16 v[32:47], v[164:167], v[172:175], v[32:47]
    ds_read_b64_tr_b16 v[160:161], v200 offset:2528
    ds_read_b64_tr_b16 v[162:163], v200 offset:3680
    s_waitcnt lgkmcnt(8)
    v_mfma_f32_32x32x16_bf16 v[48:63], v[144:147], v[172:175], v[48:63]
    ds_read_b64_tr_b16 v[164:165], v200 offset:2560
    ds_read_b64_tr_b16 v[166:167], v200 offset:3712
    s_waitcnt lgkmcnt(8)
    v_mfma_f32_32x32x16_bf16 v[64:79], v[148:151], v[172:175], v[64:79]
    s_waitcnt vmcnt(0)
    s_barrier
    ds_read_b64_tr_b16 v[144:145], v201 offset:0
    ds_read_b64_tr_b16 v[146:147], v201 offset:1152
    s_waitcnt lgkmcnt(8)
    v_mfma_f32_32x32x16_bf16 v[80:95], v[152:155], v[172:175], v[80:95]
    ds_read_b64_tr_b16 v[148:149], v201 offset:32
    ds_read_b64_tr_b16 v[150:151], v201 offset:1184
    s_waitcnt lgkmcnt(8)
    v_mfma_f32_32x32x16_bf16 v[96:111], v[156:159], v[172:175], v[96:111]
    ds_read_b64_tr_b16 v[152:153], v201 offset:64
    ds_read_b64_tr_b16 v[154:155], v201 offset:1216
    s_waitcnt lgkmcnt(8)
    v_mfma_f32_32x32x16_bf16 v[112:127], v[160:163], v[172:175], v[112:127]
    ds_read_b64_tr_b16 v[156:157], v201 offset:96
    ds_read_b64_tr_b16 v[158:159], v201 offset:1248
    s_waitcnt lgkmcnt(8)
    v_mfma_f32_32x32x16_bf16 v[128:143], v[164:167], v[172:175], v[128:143]
    ds_read_b64_tr_b16 v[160:161], v201 offset:128
    ds_read_b64_tr_b16 v[162:163], v201 offset:1280
    s_waitcnt lgkmcnt(8)
    v_mfma_f32_32x32x16_bf16 v[0:15], v[144:147], v[176:179], v[0:15]
    ds_read_b64_tr_b16 v[164:165], v201 offset:160
    ds_read_b64_tr_b16 v[166:167], v201 offset:1312
    s_waitcnt lgkmcnt(8)
    v_mfma_f32_32x32x16_bf16 v[16:31], v[148:151], v[176:179], v[16:31]
    ds_read_b64_tr_b16 v[144:145], v201 offset:192
    ds_read_b64_tr_b16 v[146:147], v201 offset:1344
    s_waitcnt lgkmcnt(8)
    v_mfma_f32_32x32x16_bf16 v[32:47], v[152:155], v[176:179], v[32:47]
    ds_read_b64_tr_b16 v[148:149], v201 offset:224
    ds_read_b64_tr_b16 v[150:151], v201 offset:1376
    s_waitcnt lgkmcnt(8)
    v_mfma_f32_32x32x16_bf16 v[48:63], v[156:159], v[176:179], v[48:63]
    ds_read_b64_tr_b16 v[152:153], v201 offset:256
    ds_read_b64_tr_b16 v[154:155], v201 offset:1408
    s_waitcnt lgkmcnt(8)
    v_mfma_f32_32x32x16_bf16 v[64:79], v[160:163], v[176:179], v[64:79]
    ds_read_b64_tr_b16 v[156:157], v201 offset:2304
    ds_read_b64_tr_b16 v[158:159], v201 offset:3456
    s_waitcnt lgkmcnt(8)
    v_mfma_f32_32x32x16_bf16 v[80:95], v[164:167], v[176:179], v[80:95]
    ds_read_b64_tr_b16 v[160:161], v201 offset:2336
    ds_read_b64_tr_b16 v[162:163], v201 offset:3488
    s_waitcnt lgkmcnt(8)
    v_mfma_f32_32x32x16_bf16 v[96:111], v[144:147], v[176:179], v[96:111]
    ds_read_b64_tr_b16 v[164:165], v201 offset:2368
    ds_read_b64_tr_b16 v[166:167], v201 offset:3520
    s_waitcnt lgkmcnt(8)
    v_mfma_f32_32x32x16_bf16 v[112:127], v[148:151], v[176:179], v[112:127]
    ds_read_b64_tr_b16 v[144:145], v201 offset:2400
    ds_read_b64_tr_b16 v[146:147], v201 offset:3552
    s_waitcnt lgkmcnt(8)
    v_mfma_f32_32x32x16_bf16 v[128:143], v[152:155], v[176:179], v[128:143]
    ds_read_b64_tr_b16 v[148:149], v201 offset:2432
    ds_read_b64_tr_b16 v[150:151], v201 offset:3584
    s_waitcnt lgkmcnt(8)
    v_mfma_f32_32x32x16_bf16 v[0:15], v[156:159], v[180:183], v[0:15]
    ds_read_b64_tr_b16 v[152:153], v201 offset:2464
    ds_read_b64_tr_b16 v[154:155], v201 offset:3616
    s_waitcnt lgkmcnt(8)
    v_mfma_f32_32x32x16_bf16 v[16:31], v[160:163], v[180:183], v[16:31]
    ds_read_b64_tr_b16 v[156:157], v201 offset:2496
    ds_read_b64_tr_b16 v[158:159], v201 offset:3648
    s_waitcnt lgkmcnt(8)
    v_mfma_f32_32x32x16_bf16 v[32:47], v[164:167], v[180:183], v[32:47]
    ds_read_b64_tr_b16 v[160:161], v201 offset:2528
    ds_read_b64_tr_b16 v[162:163], v201 offset:3680
    s_waitcnt lgkmcnt(8)
    v_mfma_f32_32x32x16_bf16 v[48:63], v[144:147], v[180:183], v[48:63]
    ds_read_b64_tr_b16 v[164:165], v201 offset:2560
    ds_read_b64_tr_b16 v[166:167], v201 offset:3712
    s_waitcnt lgkmcnt(8)
    v_mfma_f32_32x32x16_bf16 v[64:79], v[148:151], v[180:183], v[64:79]
    s_waitcnt lgkmcnt(6)
    v_mfma_f32_32x32x16_bf16 v[80:95], v[152:155], v[180:183], v[80:95]
    s_waitcnt lgkmcnt(4)
    v_mfma_f32_32x32x16_bf16 v[96:111], v[156:159], v[180:183], v[96:111]
    s_waitcnt lgkmcnt(2)
    v_mfma_f32_32x32x16_bf16 v[112:127], v[160:163], v[180:183], v[112:127]
    s_waitcnt lgkmcnt(0)
    v_mfma_f32_32x32x16_bf16 v[128:143], v[164:167], v[180:183], v[128:143]
    s_nop 7
    s_nop 7
    s_mov_b32 s38, 0xc0135761
    s_mov_b32 s39, 0xbdd2d3e8
    v_mov_b32 v176, s39
    v_mov_b32 v177, s38
    v_mov_b32 v178, 1.0
    v_pk_mul_f32 v[144:145], v[0:1], v[0:1]
    v_pk_mul_f32 v[146:147], v[2:3], v[2:3]
    v_pk_mul_f32 v[148:149], v[4:5], v[4:5]
    v_pk_mul_f32 v[150:151], v[6:7], v[6:7]
    v_pk_fma_f32 v[144:145], v[144:145], v[176:177], v[176:177] op_sel:[0,0,1] op_sel_hi:[1,0,1]
    v_pk_fma_f32 v[146:147], v[146:147], v[176:177], v[176:177] op_sel:[0,0,1] op_sel_hi:[1,0,1]
    v_pk_fma_f32 v[148:149], v[148:149], v[176:177], v[176:177] op_sel:[0,0,1] op_sel_hi:[1,0,1]
    v_pk_fma_f32 v[150:151], v[150:151], v[176:177], v[176:177] op_sel:[0,0,1] op_sel_hi:[1,0,1]
    v_pk_mul_f32 v[144:145], v[144:145], v[0:1]
    v_pk_mul_f32 v[146:147], v[146:147], v[2:3]
    v_pk_mul_f32 v[148:149], v[148:149], v[4:5]
    v_pk_mul_f32 v[150:151], v[150:151], v[6:7]
    v_exp_f32 v144, v144
    v_exp_f32 v145, v145
    v_exp_f32 v146, v146
    v_exp_f32 v147, v147
    v_exp_f32 v148, v148
    v_exp_f32 v149, v149
    v_exp_f32 v150, v150
    v_exp_f32 v151, v151
    v_pk_mul_f32 v[0:1], v[0:1], v[8:9]
    v_pk_mul_f32 v[2:3], v[2:3], v[10:11]
    v_pk_mul_f32 v[4:5], v[4:5], v[12:13]
    v_pk_mul_f32 v[6:7], v[6:7], v[14:15]
    v_pk_add_f32 v[144:145], v[144:145], v[178:179] op_sel:[0,0] op_sel_hi:[1,0]
    v_pk_add_f32 v[146:147], v[146:147], v[178:179] op_sel:[0,0] op_sel_hi:[1,0]
    v_pk_add_f32 v[148:149], v[148:149], v[178:179] op_sel:[0,0] op_sel_hi:[1,0]
    v_pk_add_f32 v[150:151], v[150:151], v[178:179] op_sel:[0,0] op_sel_hi:[1,0]
    v_rcp_f32 v144, v144
    v_rcp_f32 v145, v145
    v_rcp_f32 v146, v146
    v_rcp_f32 v147, v147
    v_rcp_f32 v148, v148
    v_rcp_f32 v149, v149
    v_rcp_f32 v150, v150
    v_rcp_f32 v151, v151
    s_nop 0
    v_pk_mul_f32 v[0:1], v[0:1], v[144:145]
    v_pk_mul_f32 v[2:3], v[2:3], v[146:147]
    v_pk_mul_f32 v[4:5], v[4:5], v[148:149]
    v_pk_mul_f32 v[6:7], v[6:7], v[150:151]
    v_cvt_pk_bf16_f32 v152, v0, v1
    v_cvt_pk_bf16_f32 v153, v2, v3
    v_cvt_pk_bf16_f32 v154, v4, v5
    v_cvt_pk_bf16_f32 v155, v6, v7
    s_add_u32 s40, s3, 0
    buffer_store_dwordx4 v[152:155], v207, s[16:19], s40 offen nt
    v_pk_mul_f32 v[160:161], v[16:17], v[16:17]
    v_pk_mul_f32 v[162:163], v[18:19], v[18:19]
    v_pk_mul_f32 v[164:165], v[20:21], v[20:21]
    v_pk_mul_f32 v[166:167], v[22:23], v[22:23]
    v_pk_fma_f32 v[160:161], v[160:161], v[176:177], v[176:177] op_sel:[0,0,1] op_sel_hi:[1,0,1]
    v_pk_fma_f32 v[162:163], v[162:163], v[176:177], v[176:177] op_sel:[0,0,1] op_sel_hi:[1,0,1]
    v_pk_fma_f32 v[164:165], v[164:165], v[176:177], v[176:177] op_sel:[0,0,1] op_sel_hi:[1,0,1]
    v_pk_fma_f32 v[166:167], v[166:167], v[176:177], v[176:177] op_sel:[0,0,1] op_sel_hi:[1,0,1]
    v_pk_mul_f32 v[160:161], v[160:161], v[16:17]
    v_pk_mul_f32 v[162:163], v[162:163], v[18:19]
    v_pk_mul_f32 v[164:165], v[164:165], v[20:21]
    v_pk_mul_f32 v[166:167], v[166:167], v[22:23]
    v_exp_f32 v160, v160
    v_exp_f32 v161, v161
    v_exp_f32 v162, v162
    v_exp_f32 v163, v163
    v_exp_f32 v164, v164
    v_exp_f32 v165, v165
    v_exp_f32 v166, v166
    v_exp_f32 v167, v167
    v_pk_mul_f32 v[16:17], v[16:17], v[24:25]
    v_pk_mul_f32 v[18:19], v[18:19], v[26:27]
    v_pk_mul_f32 v[20:21], v[20:21], v[28:29]
    v_pk_mul_f32 v[22:23], v[22:23], v[30:31]
    v_pk_add_f32 v[160:161], v[160:161], v[178:179] op_sel:[0,0] op_sel_hi:[1,0]
    v_pk_add_f32 v[162:163], v[162:163], v[178:179] op_sel:[0,0] op_sel_hi:[1,0]
    v_pk_add_f32 v[164:165], v[164:165], v[178:179] op_sel:[0,0] op_sel_hi:[1,0]
    v_pk_add_f32 v[166:167], v[166:167], v[178:179] op_sel:[0,0] op_sel_hi:[1,0]
    v_rcp_f32 v160, v160
    v_rcp_f32 v161, v161
    v_rcp_f32 v162, v162
    v_rcp_f32 v163, v163
    v_rcp_f32 v164, v164
    v_rcp_f32 v165, v165
    v_rcp_f32 v166, v166
    v_rcp_f32 v167, v167
    s_nop 0
    v_pk_mul_f32 v[16:17], v[16:17], v[160:161]
    v_pk_mul_f32 v[18:19], v[18:19], v[162:163]
    v_pk_mul_f32 v[20:21], v[20:21], v[164:165]
    v_pk_mul_f32 v[22:23], v[22:23], v[166:167]
    v_cvt_pk_bf16_f32 v168, v16, v17
    v_cvt_pk_bf16_f32 v169, v18, v19
    v_cvt_pk_bf16_f32 v170, v20, v21
    v_cvt_pk_bf16_f32 v171, v22, v23
    s_add_u32 s40, s3, 1024
    buffer_store_dwordx4 v[168:171], v207, s[16:19], s40 offen nt
    v_pk_mul_f32 v[144:145], v[32:33], v[32:33]
    v_pk_mul_f32 v[146:147], v[34:35], v[34:35]
    v_pk_mul_f32 v[148:149], v[36:37], v[36:37]
    v_pk_mul_f32 v[150:151], v[38:39], v[38:39]
    v_pk_fma_f32 v[144:145], v[144:145], v[176:177], v[176:177] op_sel:[0,0,1] op_sel_hi:[1,0,1]
    v_pk_fma_f32 v[146:147], v[146:147], v[176:177], v[176:177] op_sel:[0,0,1] op_sel_hi:[1,0,1]
    v_pk_fma_f32 v[148:149], v[148:149], v[176:177], v[176:177] op_sel:[0,0,1] op_sel_hi:[1,0,1]
    v_pk_fma_f32 v[150:151], v[150:151], v[176:177], v[176:177] op_sel:[0,0,1] op_sel_hi:[1,0,1]
    v_pk_mul_f32 v[144:145], v[144:145], v[32:33]
    v_pk_mul_f32 v[146:147], v[146:147], v[34:35]
    v_pk_mul_f32 v[148:149], v[148:149], v[36:37]
    v_pk_mul_f32 v[150:151], v[150:151], v[38:39]
    v_exp_f32 v144, v144
    v_exp_f32 v145, v145
    v_exp_f32 v146, v146
    v_exp_f32 v147, v147
    v_exp_f32 v148, v148
    v_exp_f32 v149, v149
    v_exp_f32 v150, v150
    v_exp_f32 v151, v151
    v_pk_mul_f32 v[32:33], v[32:33], v[40:41]
    v_pk_mul_f32 v[34:35], v[34:35], v[42:43]
    v_pk_mul_f32 v[36:37], v[36:37], v[44:45]
    v_pk_mul_f32 v[38:39], v[38:39], v[46:47]
    v_pk_add_f32 v[144:145], v[144:145], v[178:179] op_sel:[0,0] op_sel_hi:[1,0]
    v_pk_add_f32 v[146:147], v[146:147], v[178:179] op_sel:[0,0] op_sel_hi:[1,0]
    v_pk_add_f32 v[148:149], v[148:149], v[178:179] op_sel:[0,0] op_sel_hi:[1,0]
    v_pk_add_f32 v[150:151], v[150:151], v[178:179] op_sel:[0,0] op_sel_hi:[1,0]
    v_rcp_f32 v144, v144
    v_rcp_f32 v145, v145
    v_rcp_f32 v146, v146
    v_rcp_f32 v147, v147
    v_rcp_f32 v148, v148
    v_rcp_f32 v149, v149
    v_rcp_f32 v150, v150
    v_rcp_f32 v151, v151
    s_nop 0
    v_pk_mul_f32 v[32:33], v[32:33], v[144:145]
    v_pk_mul_f32 v[34:35], v[34:35], v[146:147]
    v_pk_mul_f32 v[36:37], v[36:37], v[148:149]
    v_pk_mul_f32 v[38:39], v[38:39], v[150:151]
    v_cvt_pk_bf16_f32 v152, v32, v33
    v_cvt_pk_bf16_f32 v153, v34, v35
    v_cvt_pk_bf16_f32 v154, v36, v37
    v_cvt_pk_bf16_f32 v155, v38, v39
    s_add_u32 s40, s3, 2048
    buffer_store_dwordx4 v[152:155], v207, s[16:19], s40 offen nt
    v_pk_mul_f32 v[160:161], v[48:49], v[48:49]
    v_pk_mul_f32 v[162:163], v[50:51], v[50:51]
    v_pk_mul_f32 v[164:165], v[52:53], v[52:53]
    v_pk_mul_f32 v[166:167], v[54:55], v[54:55]
    v_pk_fma_f32 v[160:161], v[160:161], v[176:177], v[176:177] op_sel:[0,0,1] op_sel_hi:[1,0,1]
    v_pk_fma_f32 v[162:163], v[162:163], v[176:177], v[176:177] op_sel:[0,0,1] op_sel_hi:[1,0,1]
    v_pk_fma_f32 v[164:165], v[164:165], v[176:177], v[176:177] op_sel:[0,0,1] op_sel_hi:[1,0,1]
    v_pk_fma_f32 v[166:167], v[166:167], v[176:177], v[176:177] op_sel:[0,0,1] op_sel_hi:[1,0,1]
    v_pk_mul_f32 v[160:161], v[160:161], v[48:49]
    v_pk_mul_f32 v[162:163], v[162:163], v[50:51]
    v_pk_mul_f32 v[164:165], v[164:165], v[52:53]
    v_pk_mul_f32 v[166:167], v[166:167], v[54:55]
    v_exp_f32 v160, v160
    v_exp_f32 v161, v161
    v_exp_f32 v162, v162
    v_exp_f32 v163, v163
    v_exp_f32 v164, v164
    v_exp_f32 v165, v165
    v_exp_f32 v166, v166
    v_exp_f32 v167, v167
    v_pk_mul_f32 v[48:49], v[48:49], v[56:57]
    v_pk_mul_f32 v[50:51], v[50:51], v[58:59]
    v_pk_mul_f32 v[52:53], v[52:53], v[60:61]
    v_pk_mul_f32 v[54:55], v[54:55], v[62:63]
    v_pk_add_f32 v[160:161], v[160:161], v[178:179] op_sel:[0,0] op_sel_hi:[1,0]
    v_pk_add_f32 v[162:163], v[162:163], v[178:179] op_sel:[0,0] op_sel_hi:[1,0]
    v_pk_add_f32 v[164:165], v[164:165], v[178:179] op_sel:[0,0] op_sel_hi:[1,0]
    v_pk_add_f32 v[166:167], v[166:167], v[178:179] op_sel:[0,0] op_sel_hi:[1,0]
    v_rcp_f32 v160, v160
    v_rcp_f32 v161, v161
    v_rcp_f32 v162, v162
    v_rcp_f32 v163, v163
    v_rcp_f32 v164, v164
    v_rcp_f32 v165, v165
    v_rcp_f32 v166, v166
    v_rcp_f32 v167, v167
    s_nop 0
    v_pk_mul_f32 v[48:49], v[48:49], v[160:161]
    v_pk_mul_f32 v[50:51], v[50:51], v[162:163]
    v_pk_mul_f32 v[52:53], v[52:53], v[164:165]
    v_pk_mul_f32 v[54:55], v[54:55], v[166:167]
    v_cvt_pk_bf16_f32 v168, v48, v49
    v_cvt_pk_bf16_f32 v169, v50, v51
    v_cvt_pk_bf16_f32 v170, v52, v53
    v_cvt_pk_bf16_f32 v171, v54, v55
    s_add_u32 s40, s3, 3072
    buffer_store_dwordx4 v[168:171], v207, s[16:19], s40 offen nt
    v_pk_mul_f32 v[144:145], v[64:65], v[64:65]
    v_pk_mul_f32 v[146:147], v[66:67], v[66:67]
    v_pk_mul_f32 v[148:149], v[68:69], v[68:69]
    v_pk_mul_f32 v[150:151], v[70:71], v[70:71]
    v_pk_fma_f32 v[144:145], v[144:145], v[176:177], v[176:177] op_sel:[0,0,1] op_sel_hi:[1,0,1]
    v_pk_fma_f32 v[146:147], v[146:147], v[176:177], v[176:177] op_sel:[0,0,1] op_sel_hi:[1,0,1]
    v_pk_fma_f32 v[148:149], v[148:149], v[176:177], v[176:177] op_sel:[0,0,1] op_sel_hi:[1,0,1]
    v_pk_fma_f32 v[150:151], v[150:151], v[176:177], v[176:177] op_sel:[0,0,1] op_sel_hi:[1,0,1]
    v_pk_mul_f32 v[144:145], v[144:145], v[64:65]
    v_pk_mul_f32 v[146:147], v[146:147], v[66:67]
    v_pk_mul_f32 v[148:149], v[148:149], v[68:69]
    v_pk_mul_f32 v[150:151], v[150:151], v[70:71]
    v_exp_f32 v144, v144
    v_exp_f32 v145, v145
    v_exp_f32 v146, v146
    v_exp_f32 v147, v147
    v_exp_f32 v148, v148
    v_exp_f32 v149, v149
    v_exp_f32 v150, v150
    v_exp_f32 v151, v151
    v_pk_mul_f32 v[64:65], v[64:65], v[72:73]
    v_pk_mul_f32 v[66:67], v[66:67], v[74:75]
    v_pk_mul_f32 v[68:69], v[68:69], v[76:77]
    v_pk_mul_f32 v[70:71], v[70:71], v[78:79]
    v_pk_add_f32 v[144:145], v[144:145], v[178:179] op_sel:[0,0] op_sel_hi:[1,0]
    v_pk_add_f32 v[146:147], v[146:147], v[178:179] op_sel:[0,0] op_sel_hi:[1,0]
    v_pk_add_f32 v[148:149], v[148:149], v[178:179] op_sel:[0,0] op_sel_hi:[1,0]
    v_pk_add_f32 v[150:151], v[150:151], v[178:179] op_sel:[0,0] op_sel_hi:[1,0]
    v_rcp_f32 v144, v144
    v_rcp_f32 v145, v145
    v_rcp_f32 v146, v146
    v_rcp_f32 v147, v147
    v_rcp_f32 v148, v148
    v_rcp_f32 v149, v149
    v_rcp_f32 v150, v150
    v_rcp_f32 v151, v151
    s_nop 0
    v_pk_mul_f32 v[64:65], v[64:65], v[144:145]
    v_pk_mul_f32 v[66:67], v[66:67], v[146:147]
    v_pk_mul_f32 v[68:69], v[68:69], v[148:149]
    v_pk_mul_f32 v[70:71], v[70:71], v[150:151]
    v_cvt_pk_bf16_f32 v152, v64, v65
    v_cvt_pk_bf16_f32 v153, v66, v67
    v_cvt_pk_bf16_f32 v154, v68, v69
    v_cvt_pk_bf16_f32 v155, v70, v71
    s_add_u32 s40, s3, 4096
    buffer_store_dwordx4 v[152:155], v207, s[16:19], s40 offen nt
    v_pk_mul_f32 v[160:161], v[80:81], v[80:81]
    v_pk_mul_f32 v[162:163], v[82:83], v[82:83]
    v_pk_mul_f32 v[164:165], v[84:85], v[84:85]
    v_pk_mul_f32 v[166:167], v[86:87], v[86:87]
    v_pk_fma_f32 v[160:161], v[160:161], v[176:177], v[176:177] op_sel:[0,0,1] op_sel_hi:[1,0,1]
    v_pk_fma_f32 v[162:163], v[162:163], v[176:177], v[176:177] op_sel:[0,0,1] op_sel_hi:[1,0,1]
    v_pk_fma_f32 v[164:165], v[164:165], v[176:177], v[176:177] op_sel:[0,0,1] op_sel_hi:[1,0,1]
    v_pk_fma_f32 v[166:167], v[166:167], v[176:177], v[176:177] op_sel:[0,0,1] op_sel_hi:[1,0,1]
    v_pk_mul_f32 v[160:161], v[160:161], v[80:81]
    v_pk_mul_f32 v[162:163], v[162:163], v[82:83]
    v_pk_mul_f32 v[164:165], v[164:165], v[84:85]
    v_pk_mul_f32 v[166:167], v[166:167], v[86:87]
    v_exp_f32 v160, v160
    v_exp_f32 v161, v161
    v_exp_f32 v162, v162
    v_exp_f32 v163, v163
    v_exp_f32 v164, v164
    v_exp_f32 v165, v165
    v_exp_f32 v166, v166
    v_exp_f32 v167, v167
    v_pk_mul_f32 v[80:81], v[80:81], v[88:89]
    v_pk_mul_f32 v[82:83], v[82:83], v[90:91]
    v_pk_mul_f32 v[84:85], v[84:85], v[92:93]
    v_pk_mul_f32 v[86:87], v[86:87], v[94:95]
    v_pk_add_f32 v[160:161], v[160:161], v[178:179] op_sel:[0,0] op_sel_hi:[1,0]
    v_pk_add_f32 v[162:163], v[162:163], v[178:179] op_sel:[0,0] op_sel_hi:[1,0]
    v_pk_add_f32 v[164:165], v[164:165], v[178:179] op_sel:[0,0] op_sel_hi:[1,0]
    v_pk_add_f32 v[166:167], v[166:167], v[178:179] op_sel:[0,0] op_sel_hi:[1,0]
    v_rcp_f32 v160, v160
    v_rcp_f32 v161, v161
    v_rcp_f32 v162, v162
    v_rcp_f32 v163, v163
    v_rcp_f32 v164, v164
    v_rcp_f32 v165, v165
    v_rcp_f32 v166, v166
    v_rcp_f32 v167, v167
    s_nop 0
    v_pk_mul_f32 v[80:81], v[80:81], v[160:161]
    v_pk_mul_f32 v[82:83], v[82:83], v[162:163]
    v_pk_mul_f32 v[84:85], v[84:85], v[164:165]
    v_pk_mul_f32 v[86:87], v[86:87], v[166:167]
    v_cvt_pk_bf16_f32 v168, v80, v81
    v_cvt_pk_bf16_f32 v169, v82, v83
    v_cvt_pk_bf16_f32 v170, v84, v85
    v_cvt_pk_bf16_f32 v171, v86, v87
    s_add_u32 s40, s3, 5120
    buffer_store_dwordx4 v[168:171], v207, s[16:19], s40 offen nt
    v_pk_mul_f32 v[144:145], v[96:97], v[96:97]
    v_pk_mul_f32 v[146:147], v[98:99], v[98:99]
    v_pk_mul_f32 v[148:149], v[100:101], v[100:101]
    v_pk_mul_f32 v[150:151], v[102:103], v[102:103]
    v_pk_fma_f32 v[144:145], v[144:145], v[176:177], v[176:177] op_sel:[0,0,1] op_sel_hi:[1,0,1]
    v_pk_fma_f32 v[146:147], v[146:147], v[176:177], v[176:177] op_sel:[0,0,1] op_sel_hi:[1,0,1]
    v_pk_fma_f32 v[148:149], v[148:149], v[176:177], v[176:177] op_sel:[0,0,1] op_sel_hi:[1,0,1]
    v_pk_fma_f32 v[150:151], v[150:151], v[176:177], v[176:177] op_sel:[0,0,1] op_sel_hi:[1,0,1]
    v_pk_mul_f32 v[144:145], v[144:145], v[96:97]
    v_pk_mul_f32 v[146:147], v[146:147], v[98:99]
    v_pk_mul_f32 v[148:149], v[148:149], v[100:101]
    v_pk_mul_f32 v[150:151], v[150:151], v[102:103]
    v_exp_f32 v144, v144
    v_exp_f32 v145, v145
    v_exp_f32 v146, v146
    v_exp_f32 v147, v147
    v_exp_f32 v148, v148
    v_exp_f32 v149, v149
    v_exp_f32 v150, v150
    v_exp_f32 v151, v151
    v_pk_mul_f32 v[96:97], v[96:97], v[104:105]
    v_pk_mul_f32 v[98:99], v[98:99], v[106:107]
    v_pk_mul_f32 v[100:101], v[100:101], v[108:109]
    v_pk_mul_f32 v[102:103], v[102:103], v[110:111]
    v_pk_add_f32 v[144:145], v[144:145], v[178:179] op_sel:[0,0] op_sel_hi:[1,0]
    v_pk_add_f32 v[146:147], v[146:147], v[178:179] op_sel:[0,0] op_sel_hi:[1,0]
    v_pk_add_f32 v[148:149], v[148:149], v[178:179] op_sel:[0,0] op_sel_hi:[1,0]
    v_pk_add_f32 v[150:151], v[150:151], v[178:179] op_sel:[0,0] op_sel_hi:[1,0]
    v_rcp_f32 v144, v144
    v_rcp_f32 v145, v145
    v_rcp_f32 v146, v146
    v_rcp_f32 v147, v147
    v_rcp_f32 v148, v148
    v_rcp_f32 v149, v149
    v_rcp_f32 v150, v150
    v_rcp_f32 v151, v151
    s_nop 0
    v_pk_mul_f32 v[96:97], v[96:97], v[144:145]
    v_pk_mul_f32 v[98:99], v[98:99], v[146:147]
    v_pk_mul_f32 v[100:101], v[100:101], v[148:149]
    v_pk_mul_f32 v[102:103], v[102:103], v[150:151]
    v_cvt_pk_bf16_f32 v152, v96, v97
    v_cvt_pk_bf16_f32 v153, v98, v99
    v_cvt_pk_bf16_f32 v154, v100, v101
    v_cvt_pk_bf16_f32 v155, v102, v103
    s_add_u32 s40, s3, 6144
    buffer_store_dwordx4 v[152:155], v207, s[16:19], s40 offen nt
    v_pk_mul_f32 v[160:161], v[112:113], v[112:113]
    v_pk_mul_f32 v[162:163], v[114:115], v[114:115]
    v_pk_mul_f32 v[164:165], v[116:117], v[116:117]
    v_pk_mul_f32 v[166:167], v[118:119], v[118:119]
    v_pk_fma_f32 v[160:161], v[160:161], v[176:177], v[176:177] op_sel:[0,0,1] op_sel_hi:[1,0,1]
    v_pk_fma_f32 v[162:163], v[162:163], v[176:177], v[176:177] op_sel:[0,0,1] op_sel_hi:[1,0,1]
    v_pk_fma_f32 v[164:165], v[164:165], v[176:177], v[176:177] op_sel:[0,0,1] op_sel_hi:[1,0,1]
    v_pk_fma_f32 v[166:167], v[166:167], v[176:177], v[176:177] op_sel:[0,0,1] op_sel_hi:[1,0,1]
    v_pk_mul_f32 v[160:161], v[160:161], v[112:113]
    v_pk_mul_f32 v[162:163], v[162:163], v[114:115]
    v_pk_mul_f32 v[164:165], v[164:165], v[116:117]
    v_pk_mul_f32 v[166:167], v[166:167], v[118:119]
    v_exp_f32 v160, v160
    v_exp_f32 v161, v161
    v_exp_f32 v162, v162
    v_exp_f32 v163, v163
    v_exp_f32 v164, v164
    v_exp_f32 v165, v165
    v_exp_f32 v166, v166
    v_exp_f32 v167, v167
    v_pk_mul_f32 v[112:113], v[112:113], v[120:121]
    v_pk_mul_f32 v[114:115], v[114:115], v[122:123]
    v_pk_mul_f32 v[116:117], v[116:117], v[124:125]
    v_pk_mul_f32 v[118:119], v[118:119], v[126:127]
    v_pk_add_f32 v[160:161], v[160:161], v[178:179] op_sel:[0,0] op_sel_hi:[1,0]
    v_pk_add_f32 v[162:163], v[162:163], v[178:179] op_sel:[0,0] op_sel_hi:[1,0]
    v_pk_add_f32 v[164:165], v[164:165], v[178:179] op_sel:[0,0] op_sel_hi:[1,0]
    v_pk_add_f32 v[166:167], v[166:167], v[178:179] op_sel:[0,0] op_sel_hi:[1,0]
    v_rcp_f32 v160, v160
    v_rcp_f32 v161, v161
    v_rcp_f32 v162, v162
    v_rcp_f32 v163, v163
    v_rcp_f32 v164, v164
    v_rcp_f32 v165, v165
    v_rcp_f32 v166, v166
    v_rcp_f32 v167, v167
    s_nop 0
    v_pk_mul_f32 v[112:113], v[112:113], v[160:161]
    v_pk_mul_f32 v[114:115], v[114:115], v[162:163]
    v_pk_mul_f32 v[116:117], v[116:117], v[164:165]
    v_pk_mul_f32 v[118:119], v[118:119], v[166:167]
    v_cvt_pk_bf16_f32 v168, v112, v113
    v_cvt_pk_bf16_f32 v169, v114, v115
    v_cvt_pk_bf16_f32 v170, v116, v117
    v_cvt_pk_bf16_f32 v171, v118, v119
    s_add_u32 s40, s3, 7168
    buffer_store_dwordx4 v[168:171], v207, s[16:19], s40 offen nt
    v_pk_mul_f32 v[144:145], v[128:129], v[128:129]
    v_pk_mul_f32 v[146:147], v[130:131], v[130:131]
    v_pk_mul_f32 v[148:149], v[132:133], v[132:133]
    v_pk_mul_f32 v[150:151], v[134:135], v[134:135]
    v_pk_fma_f32 v[144:145], v[144:145], v[176:177], v[176:177] op_sel:[0,0,1] op_sel_hi:[1,0,1]
    v_pk_fma_f32 v[146:147], v[146:147], v[176:177], v[176:177] op_sel:[0,0,1] op_sel_hi:[1,0,1]
    v_pk_fma_f32 v[148:149], v[148:149], v[176:177], v[176:177] op_sel:[0,0,1] op_sel_hi:[1,0,1]
    v_pk_fma_f32 v[150:151], v[150:151], v[176:177], v[176:177] op_sel:[0,0,1] op_sel_hi:[1,0,1]
    v_pk_mul_f32 v[144:145], v[144:145], v[128:129]
    v_pk_mul_f32 v[146:147], v[146:147], v[130:131]
    v_pk_mul_f32 v[148:149], v[148:149], v[132:133]
    v_pk_mul_f32 v[150:151], v[150:151], v[134:135]
    v_exp_f32 v144, v144
    v_exp_f32 v145, v145
    v_exp_f32 v146, v146
    v_exp_f32 v147, v147
    v_exp_f32 v148, v148
    v_exp_f32 v149, v149
    v_exp_f32 v150, v150
    v_exp_f32 v151, v151
    v_pk_mul_f32 v[128:129], v[128:129], v[136:137]
    v_pk_mul_f32 v[130:131], v[130:131], v[138:139]
    v_pk_mul_f32 v[132:133], v[132:133], v[140:141]
    v_pk_mul_f32 v[134:135], v[134:135], v[142:143]
    v_pk_add_f32 v[144:145], v[144:145], v[178:179] op_sel:[0,0] op_sel_hi:[1,0]
    v_pk_add_f32 v[146:147], v[146:147], v[178:179] op_sel:[0,0] op_sel_hi:[1,0]
    v_pk_add_f32 v[148:149], v[148:149], v[178:179] op_sel:[0,0] op_sel_hi:[1,0]
    v_pk_add_f32 v[150:151], v[150:151], v[178:179] op_sel:[0,0] op_sel_hi:[1,0]
    v_rcp_f32 v144, v144
    v_rcp_f32 v145, v145
    v_rcp_f32 v146, v146
    v_rcp_f32 v147, v147
    v_rcp_f32 v148, v148
    v_rcp_f32 v149, v149
    v_rcp_f32 v150, v150
    v_rcp_f32 v151, v151
    s_nop 0
    v_pk_mul_f32 v[128:129], v[128:129], v[144:145]
    v_pk_mul_f32 v[130:131], v[130:131], v[146:147]
    v_pk_mul_f32 v[132:133], v[132:133], v[148:149]
    v_pk_mul_f32 v[134:135], v[134:135], v[150:151]
    v_cvt_pk_bf16_f32 v152, v128, v129
    v_cvt_pk_bf16_f32 v153, v130, v131
    v_cvt_pk_bf16_f32 v154, v132, v133
    v_cvt_pk_bf16_f32 v155, v134, v135
    s_add_u32 s40, s3, 8192
    buffer_store_dwordx4 v[152:155], v207, s[16:19], s40 offen nt
    s_waitcnt vmcnt(0)
    s_waitcnt vmcnt(0)
    s_endpgm
Lf1_end:
    s_endpgm
.globl g2_kernel
.p2align 8
.type g2_kernel,@function
g2_kernel:
    s_cmp_ge_u32 s2, 256
    s_cbranch_scc1 Lg2_a2
    s_load_dwordx2 s[4:5], s[0:1], 48
    s_load_dwordx2 s[8:9], s[0:1], 72
    v_lshrrev_b32 v242, 6, v0
    v_and_b32 v0, 63, v0
    s_nop 0
    v_readfirstlane_b32 s45, v242
    s_and_b32 s48, s2, 7
    s_lshr_b32 s49, s2, 3
    s_and_b32 s50, s49, 1
    s_lshr_b32 s49, s49, 1
    s_lshl_b32 s49, s49, 2
    s_add_u32 s49, s49, s45
    s_mul_i32 s46, s48, 663552
    s_mul_i32 s3, s50, 576
    s_add_u32 s46, s46, s3
    s_mul_i32 s47, s49, 288
    s_mul_i32 s3, s48, 36
    s_add_u32 s47, s47, s3
    s_lshl_b32 s47, s47, 10
    s_lshl_b32 s3, s48, 6
    s_add_u32 s3, s3, s49
    s_mul_i32 s3, s3, 18
    s_mul_i32 s50, s50, 9
    s_add_u32 s3, s3, s50
    s_lshl_b32 s3, s3, 11
    s_add_u32 s48, s45, 0
    s_mov_b32 s49, s48
    s_mov_b32 s50, 0
    s_lshl_b32 s40, s49, 10
    s_add_u32 s40, s40, s50
    s_lshl_b32 s49, s49, 6
    v_add_u32 v242, s49, v0
    s_mov_b32 s49, 29128
    v_mul_u32_u24 v243, s49, v242
    v_lshrrev_b32 v243, 20, v243
    v_mul_u32_u24 v244, 36, v243
    v_sub_u32 v242, v242, v244
    v_lshlrev_b32 v242, 4, v242
    v_mul_u32_u24 v243, 1152, v243
    v_add_u32 v236, v242, v243
    s_add_u32 s48, s45, 4
    s_mov_b32 s49, s48
    s_mov_b32 s50, 0
    s_lshl_b32 s41, s49, 10
    s_add_u32 s41, s41, s50
    s_lshl_b32 s49, s49, 6
    v_add_u32 v242, s49, v0
    s_mov_b32 s49, 29128
    v_mul_u32_u24 v243, s49, v242
    v_lshrrev_b32 v243, 20, v243
    v_mul_u32_u24 v244, 36, v243
    v_sub_u32 v242, v242, v244
    v_lshlrev_b32 v242, 4, v242
    v_mul_u32_u24 v243, 1152, v243
    v_add_u32 v237, v242, v243
    s_add_u32 s48, s45, 8
    s_mov_b32 s49, s48
    s_mov_b32 s50, 0
    s_lshl_b32 s42, s49, 10
    s_add_u32 s42, s42, s50
    s_lshl_b32 s49, s49, 6
    v_add_u32 v242, s49, v0
    s_mov_b32 s49, 29128
    v_mul_u32_u24 v243, s49, v242
    v_lshrrev_b32 v243, 20, v243
    v_mul_u32_u24 v244, 36, v243
    v_sub_u32 v242, v242, v244
    v_lshlrev_b32 v242, 4, v242
    v_mul_u32_u24 v243, 1152, v243
    v_add_u32 v238, v242, v243
    s_add_u32 s48, s45, 12
    s_mov_b32 s49, s48
    s_mov_b32 s50, 0
    s_lshl_b32 s43, s49, 10
    s_add_u32 s43, s43, s50
    s_lshl_b32 s49, s49, 6
    v_add_u32 v242, s49, v0
    s_mov_b32 s49, 29128
    v_mul_u32_u24 v243, s49, v242
    v_lshrrev_b32 v243, 20, v243
    v_mul_u32_u24 v244, 36, v243
    v_sub_u32 v242, v242, v244
    v_lshlrev_b32 v242, 4, v242
    v_mul_u32_u24 v243, 1152, v243
    v_add_u32 v239, v242, v243
    s_add_u32 s48, s45, 16
    s_mov_b32 s49, s48
    s_mov_b32 s50, 0
    s_lshl_b32 s44, s49, 10
    s_add_u32 s44, s44, s50
    s_lshl_b32 s49, s49, 6
    v_add_u32 v242, s49, v0
    s_mov_b32 s49, 29128
    v_mul_u32_u24 v243, s49, v242
    v_lshrrev_b32 v243, 20, v243
    v_mul_u32_u24 v244, 36, v243
    v_sub_u32 v242, v242, v244
    v_lshlrev_b32 v242, 4, v242
    v_mul_u32_u24 v243, 1152, v243
    v_add_u32 v240, v242, v243
    s_cmp_ge_u32 s48, 18
    s_cselect_b32 s49, 0x40000000, 0
    s_cselect_b32 s44, 73728, s44
    v_add_u32 v240, s49, v240
    v_lshlrev_b32 v241, 4, v0
    v_lshrrev_b32 v242, 5, v0
    v_bfe_u32 v243, v0, 4, 1
    v_bfe_u32 v244, v0, 2, 2
    v_and_b32 v245, 3, v0
    v_lshlrev_b32 v245, 3, v245
    v_lshlrev_b32 v242, 2, v242
    v_add_u32 v242, v242, v244
    v_mul_u32_u24 v242, 576, v242
    v_lshlrev_b32 v243, 5, v243
    v_add3_u32 v232, v242, v243, v245
    v_add_u32 v233, 18432, v232
    v_add_u32 v234, 36864, v232
    v_add_u32 v235, 55296, v232
    s_waitcnt lgkmcnt(0)
    s_mov_b32 s20, s4
    s_mov_b32 s21, s5
    s_mov_b32 s22, 5308416
    s_mov_b32 s23, 0x00020000
    s_mov_b32 s24, s4
    s_mov_b32 s25, s5
    s_mov_b32 s26, 5308416
    s_mov_b32 s27, 0x00020000
    s_mov_b32 s28, s4
    s_mov_b32 s29, s5
    s_mov_b32 s30, 5308416
    s_mov_b32 s31, 0x00020000
    s_mov_b32 s32, s4
    s_mov_b32 s33, s5
    s_mov_b32 s34, 5308416
    s_mov_b32 s35, 0x00020000
    s_mov_b32 s36, s4
    s_mov_b32 s37, s5
    s_mov_b32 s38, 5308416
    s_mov_b32 s39, 0x00020000
    s_add_u32 s12, s8, 10153984
    s_addc_u32 s13, s9, 0
    s_mov_b32 s14, 18874368
    s_mov_b32 s15, 0x00020000
    s_add_u32 s16, s8, 29028352
    s_addc_u32 s17, s9, 0
    s_mov_b32 s18, 18874368
    s_mov_b32 s19, 0x00020000
    s_add_u32 s48, s46, 0
    s_add_u32 m0, s40, 0
    s_nop 0
    buffer_load_dwordx4 v236, s[20:23], s48 offen lds
    s_add_u32 m0, s41, 0
    s_nop 0
    buffer_load_dwordx4 v237, s[24:27], s48 offen lds
    s_add_u32 m0, s42, 0
    s_nop 0
    buffer_load_dwordx4 v238, s[28:31], s48 offen lds
    s_add_u32 m0, s43, 0
    s_nop 0
    buffer_load_dwordx4 v239, s[32:35], s48 offen lds
    s_add_u32 m0, s44, 0
    s_nop 0
    buffer_load_dwordx4 v240, s[36:39], s48 offen lds
    s_add_u32 s49, s47, 0
    buffer_load_dwordx4 v[168:171], v241, s[12:15], s49 offen offset:0
    buffer_load_dwordx4 v[172:175], v241, s[12:15], s49 offen offset:1024
    s_lshr_b32 s50, s2, 3
    s_mul_i32 s50, s50, 20736
    s_and_b32 s49, s2, 7
    s_mul_i32 s49, s49, 663552
    s_add_u32 s50, s50, s49
    s_mul_i32 s49, s45, 5184
    s_add_u32 s50, s50, s49
    v_lshlrev_b32 v252, 7, v0
    v_min_u32 v252, 5180, v252
    buffer_load_dword v253, v252, s[20:23], s50 offen
    s_add_u32 s48, s46, 36864
    s_add_u32 m0, s40, 18432
    s_nop 0
    buffer_load_dwordx4 v236, s[20:23], s48 offen lds
    s_add_u32 m0, s41, 18432
    s_nop 0
    buffer_load_dwordx4 v237, s[24:27], s48 offen lds
    s_add_u32 m0, s42, 18432
    s_nop 0
    buffer_load_dwordx4 v238, s[28:31], s48 offen lds
    s_add_u32 m0, s43, 18432
    s_nop 0
    buffer_load_dwordx4 v239, s[32:35], s48 offen lds
    s_add_u32 m0, s44, 18432
    s_nop 0
    buffer_load_dwordx4 v240, s[36:39], s48 offen lds
    s_add_u32 s49, s47, 2048
    buffer_load_dwordx4 v[176:179], v241, s[12:15], s49 offen offset:0
    buffer_load_dwordx4 v[180:183], v241, s[12:15], s49 offen offset:1024
    v_mov_b32 v0, 0
    v_mov_b32 v1, 0
    v_mov_b32 v2, 0
    v_mov_b32 v3, 0
    v_mov_b32 v4, 0
    v_mov_b32 v5, 0
    v_mov_b32 v6, 0
    v_mov_b32 v7, 0
    v_mov_b32 v8, 0
    v_mov_b32 v9, 0
    v_mov_b32 v10, 0
    v_mov_b32 v11, 0
    v_mov_b32 v12, 0
    v_mov_b32 v13, 0
    v_mov_b32 v14, 0
    v_mov_b32 v15, 0
    v_mov_b32 v16, 0
    v_mov_b32 v17, 0
    v_mov_b32 v18, 0
    v_mov_b32 v19, 0
    v_mov_b32 v20, 0
    v_mov_b32 v21, 0
    v_mov_b32 v22, 0
    v_mov_b32 v23, 0
    v_mov_b32 v24, 0
    v_mov_b32 v25, 0
    v_mov_b32 v26, 0
    v_mov_b32 v27, 0
    v_mov_b32 v28, 0
    v_mov_b32 v29, 0
    v_mov_b32 v30, 0
    v_mov_b32 v31, 0
    v_mov_b32 v32, 0
    v_mov_b32 v33, 0
    v_mov_b32 v34, 0
    v_mov_b32 v35, 0
    v_mov_b32 v36, 0
    v_mov_b32 v37, 0
    v_mov_b32 v38, 0
    v_mov_b32 v39, 0
    v_mov_b32 v40, 0
    v_mov_b32 v41, 0
    v_mov_b32 v42, 0
    v_mov_b32 v43, 0
    v_mov_b32 v44, 0
    v_mov_b32 v45, 0
    v_mov_b32 v46, 0
    v_mov_b32 v47, 0
    v_mov_b32 v48, 0
    v_mov_b32 v49, 0
    v_mov_b32 v50, 0
    v_mov_b32 v51, 0
    v_mov_b32 v52, 0
    v_mov_b32 v53, 0
    v_mov_b32 v54, 0
    v_mov_b32 v55, 0
    v_mov_b32 v56, 0
    v_mov_b32 v57, 0
    v_mov_b32 v58, 0
    v_mov_b32 v59, 0
    v_mov_b32 v60, 0
    v_mov_b32 v61, 0
    v_mov_b32 v62, 0
    v_mov_b32 v63, 0
    v_mov_b32 v64, 0
    v_mov_b32 v65, 0
    v_mov_b32 v66, 0
    v_mov_b32 v67, 0
    v_mov_b32 v68, 0
    v_mov_b32 v69, 0
    v_mov_b32 v70, 0
    v_mov_b32 v71, 0
    v_mov_b32 v72, 0
    v_mov_b32 v73, 0
    v_mov_b32 v74, 0
    v_mov_b32 v75, 0
    v_mov_b32 v76, 0
    v_mov_b32 v77, 0
    v_mov_b32 v78, 0
    v_mov_b32 v79, 0
    v_mov_b32 v80, 0
    v_mov_b32 v81, 0
    v_mov_b32 v82, 0
    v_mov_b32 v83, 0
    v_mov_b32 v84, 0
    v_mov_b32 v85, 0
    v_mov_b32 v86, 0
    v_mov_b32 v87, 0
    v_mov_b32 v88, 0
    v_mov_b32 v89, 0
    v_mov_b32 v90, 0
    v_mov_b32 v91, 0
    v_mov_b32 v92, 0
    v_mov_b32 v93, 0
    v_mov_b32 v94, 0
    v_mov_b32 v95, 0
    v_mov_b32 v96, 0
    v_mov_b32 v97, 0
    v_mov_b32 v98, 0
    v_mov_b32 v99, 0
    v_mov_b32 v100, 0
    v_mov_b32 v101, 0
    v_mov_b32 v102, 0
    v_mov_b32 v103, 0
    v_mov_b32 v104, 0
    v_mov_b32 v105, 0
    v_mov_b32 v106, 0
    v_mov_b32 v107, 0
    v_mov_b32 v108, 0
    v_mov_b32 v109, 0
    v_mov_b32 v110, 0
    v_mov_b32 v111, 0
    v_mov_b32 v112, 0
    v_mov_b32 v113, 0
    v_mov_b32 v114, 0
    v_mov_b32 v115, 0
    v_mov_b32 v116, 0
    v_mov_b32 v117, 0
    v_mov_b32 v118, 0
    v_mov_b32 v119, 0
    v_mov_b32 v120, 0
    v_mov_b32 v121, 0
    v_mov_b32 v122, 0
    v_mov_b32 v123, 0
    v_mov_b32 v124, 0
    v_mov_b32 v125, 0
    v_mov_b32 v126, 0
    v_mov_b32 v127, 0
    v_mov_b32 v128, 0
    v_mov_b32 v129, 0
    v_mov_b32 v130, 0
    v_mov_b32 v131, 0
    v_mov_b32 v132, 0
    v_mov_b32 v133, 0
    v_mov_b32 v134, 0
    v_mov_b32 v135, 0
    v_mov_b32 v136, 0
    v_mov_b32 v137, 0
    v_mov_b32 v138, 0
    v_mov_b32 v139, 0
    v_mov_b32 v140, 0
    v_mov_b32 v141, 0
    v_mov_b32 v142, 0
    v_mov_b32 v143, 0
    s_waitcnt vmcnt(8)
    s_barrier
    s_add_u32 s48, s46, 73728
    s_add_u32 m0, s40, 36864
    s_nop 0
    buffer_load_dwordx4 v236, s[20:23], s48 offen lds
    s_add_u32 m0, s41, 36864
    s_nop 0
    buffer_load_dwordx4 v237, s[24:27], s48 offen lds
    s_add_u32 m0, s42, 36864
    s_nop 0
    buffer_load_dwordx4 v238, s[28:31], s48 offen lds
    s_add_u32 m0, s43, 36864
    s_nop 0
    buffer_load_dwordx4 v239, s[32:35], s48 offen lds
    s_add_u32 m0, s44, 36864
    s_nop 0
    buffer_load_dwordx4 v240, s[36:39], s48 offen lds
    ds_read_b64_tr_b16 v[144:145], v232 offset:0
    ds_read_b64_tr_b16 v[146:147], v232 offset:4608
    ds_read_b64_tr_b16 v[148:149], v232 offset:64
    ds_read_b64_tr_b16 v[150:151], v232 offset:4672
    ds_read_b64_tr_b16 v[152:153], v232 offset:128
    ds_read_b64_tr_b16 v[154:155], v232 offset:4736
    ds_read_b64_tr_b16 v[156:157], v232 offset:192
    ds_read_b64_tr_b16 v[158:159], v232 offset:4800
    ds_read_b64_tr_b16 v[160:161], v232 offset:256
    ds_read_b64_tr_b16 v[162:163], v232 offset:4864
    s_waitcnt lgkmcnt(8)
    v_mfma_f32_32x32x16_bf16 v[0:15], v[144:147], v[168:171], v[0:15]
    s_add_u32 s49, s47, 4096
    buffer_load_dwordx4 v[184:187], v241, s[12:15], s49 offen offset:0
    buffer_load_dwordx4 v[188:191], v241, s[12:15], s49 offen offset:1024
    s_add_u32 s49, s47, 6144
    buffer_load_dwordx4 v[192:195], v241, s[12:15], s49 offen offset:0
    buffer_load_dwordx4 v[196:199], v241, s[12:15], s49 offen offset:1024
    ds_read_b64_tr_b16 v[164:165], v232 offset:320
    ds_read_b64_tr_b16 v[166:167], v232 offset:4928
    s_waitcnt lgkmcnt(8)
    v_mfma_f32_32x32x16_bf16 v[16:31], v[148:151], v[168:171], v[16:31]
    ds_read_b64_tr_b16 v[144:145], v232 offset:384
    ds_read_b64_tr_b16 v[146:147], v232 offset:4992
    s_waitcnt lgkmcnt(8)
    v_mfma_f32_32x32x16_bf16 v[32:47], v[152:155], v[168:171], v[32:47]
    ds_read_b64_tr_b16 v[148:149], v232 offset:448
    ds_read_b64_tr_b16 v[150:151], v232 offset:5056
    s_waitcnt lgkmcnt(8)
    v_mfma_f32_32x32x16_bf16 v[48:63], v[156:159], v[168:171], v[48:63]
    ds_read_b64_tr_b16 v[152:153], v232 offset:512
    ds_read_b64_tr_b16 v[154:155], v232 offset:5120
    s_waitcnt lgkmcnt(8)
    v_mfma_f32_32x32x16_bf16 v[64:79], v[160:163], v[168:171], v[64:79]
    ds_read_b64_tr_b16 v[156:157], v232 offset:9216
    ds_read_b64_tr_b16 v[158:159], v232 offset:13824
    s_waitcnt lgkmcnt(8)
    v_mfma_f32_32x32x16_bf16 v[80:95], v[164:167], v[168:171], v[80:95]
    ds_read_b64_tr_b16 v[160:161], v232 offset:9280
    ds_read_b64_tr_b16 v[162:163], v232 offset:13888
    s_waitcnt lgkmcnt(8)
    v_mfma_f32_32x32x16_bf16 v[96:111], v[144:147], v[168:171], v[96:111]
    ds_read_b64_tr_b16 v[164:165], v232 offset:9344
    ds_read_b64_tr_b16 v[166:167], v232 offset:13952
    s_waitcnt lgkmcnt(8)
    v_mfma_f32_32x32x16_bf16 v[112:127], v[148:151], v[168:171], v[112:127]
    ds_read_b64_tr_b16 v[144:145], v232 offset:9408
    ds_read_b64_tr_b16 v[146:147], v232 offset:14016
    s_waitcnt lgkmcnt(8)
    v_mfma_f32_32x32x16_bf16 v[128:143], v[152:155], v[168:171], v[128:143]
    ds_read_b64_tr_b16 v[148:149], v232 offset:9472
    ds_read_b64_tr_b16 v[150:151], v232 offset:14080
    s_waitcnt lgkmcnt(8)
    v_mfma_f32_32x32x16_bf16 v[0:15], v[156:159], v[172:175], v[0:15]
    ds_read_b64_tr_b16 v[152:153], v232 offset:9536
    ds_read_b64_tr_b16 v[154:155], v232 offset:14144
    s_waitcnt lgkmcnt(8)
    v_mfma_f32_32x32x16_bf16 v[16:31], v[160:163], v[172:175], v[16:31]
    ds_read_b64_tr_b16 v[156:157], v232 offset:9600
    ds_read_b64_tr_b16 v[158:159], v232 offset:14208
    s_waitcnt lgkmcnt(8)
    v_mfma_f32_32x32x16_bf16 v[32:47], v[164:167], v[172:175], v[32:47]
    ds_read_b64_tr_b16 v[160:161], v232 offset:9664
    ds_read_b64_tr_b16 v[162:163], v232 offset:14272
    s_waitcnt lgkmcnt(8)
    v_mfma_f32_32x32x16_bf16 v[48:63], v[144:147], v[172:175], v[48:63]
    ds_read_b64_tr_b16 v[164:165], v232 offset:9728
    ds_read_b64_tr_b16 v[166:167], v232 offset:14336
    s_waitcnt lgkmcnt(8)
    v_mfma_f32_32x32x16_bf16 v[64:79], v[148:151], v[172:175], v[64:79]
    s_waitcnt vmcnt(9)
    s_barrier
    s_add_u32 s48, s46, 110592
    s_add_u32 m0, s40, 55296
    s_nop 0
    buffer_load_dwordx4 v236, s[20:23], s48 offen lds
    s_add_u32 m0, s41, 55296
    s_nop 0
    buffer_load_dwordx4 v237, s[24:27], s48 offen lds
    s_add_u32 m0, s42, 55296
    s_nop 0
    buffer_load_dwordx4 v238, s[28:31], s48 offen lds
    s_add_u32 m0, s43, 55296
    s_nop 0
    buffer_load_dwordx4 v239, s[32:35], s48 offen lds
    s_add_u32 m0, s44, 55296
    s_nop 0
    buffer_load_dwordx4 v240, s[36:39], s48 offen lds
    ds_read_b64_tr_b16 v[144:145], v233 offset:0
    ds_read_b64_tr_b16 v[146:147], v233 offset:4608
    s_waitcnt lgkmcnt(8)
    v_mfma_f32_32x32x16_bf16 v[80:95], v[152:155], v[172:175], v[80:95]
    ds_read_b64_tr_b16 v[148:149], v233 offset:64
    ds_read_b64_tr_b16 v[150:151], v233 offset:4672
    s_waitcnt lgkmcnt(8)
    v_mfma_f32_32x32x16_bf16 v[96:111], v[156:159], v[172:175], v[96:111]
    ds_read_b64_tr_b16 v[152:153], v233 offset:128
    ds_read_b64_tr_b16 v[154:155], v233 offset:4736
    s_waitcnt lgkmcnt(8)
    v_mfma_f32_32x32x16_bf16 v[112:127], v[160:163], v[172:175], v[112:127]
    ds_read_b64_tr_b16 v[156:157], v233 offset:192
    ds_read_b64_tr_b16 v[158:159], v233 offset:4800
    s_waitcnt lgkmcnt(8)
    v_mfma_f32_32x32x16_bf16 v[128:143], v[164:167], v[172:175], v[128:143]
    ds_read_b64_tr_b16 v[160:161], v233 offset:256
    ds_read_b64_tr_b16 v[162:163], v233 offset:4864
    s_waitcnt lgkmcnt(8)
    v_mfma_f32_32x32x16_bf16 v[0:15], v[144:147], v[176:179], v[0:15]
    s_add_u32 s49, s47, 8192
    buffer_load_dwordx4 v[200:203], v241, s[12:15], s49 offen offset:0
    buffer_load_dwordx4 v[204:207], v241, s[12:15], s49 offen offset:1024
    s_add_u32 s49, s47, 10240
    buffer_load_dwordx4 v[208:211], v241, s[12:15], s49 offen offset:0
    buffer_load_dwordx4 v[212:215], v241, s[12:15], s49 offen offset:1024
    ds_read_b64_tr_b16 v[164:165], v233 offset:320
    ds_read_b64_tr_b16 v[166:167], v233 offset:4928
    s_waitcnt lgkmcnt(8)
    v_mfma_f32_32x32x16_bf16 v[16:31], v[148:151], v[176:179], v[16:31]
    ds_read_b64_tr_b16 v[144:145], v233 offset:384
    ds_read_b64_tr_b16 v[146:147], v233 offset:4992
    s_waitcnt lgkmcnt(8)
    v_mfma_f32_32x32x16_bf16 v[32:47], v[152:155], v[176:179], v[32:47]
    ds_read_b64_tr_b16 v[148:149], v233 offset:448
    ds_read_b64_tr_b16 v[150:151], v233 offset:5056
    s_waitcnt lgkmcnt(8)
    v_mfma_f32_32x32x16_bf16 v[48:63], v[156:159], v[176:179], v[48:63]
    ds_read_b64_tr_b16 v[152:153], v233 offset:512
    ds_read_b64_tr_b16 v[154:155], v233 offset:5120
    s_waitcnt lgkmcnt(8)
    v_mfma_f32_32x32x16_bf16 v[64:79], v[160:163], v[176:179], v[64:79]
    ds_read_b64_tr_b16 v[156:157], v233 offset:9216
    ds_read_b64_tr_b16 v[158:159], v233 offset:13824
    s_waitcnt lgkmcnt(8)
    v_mfma_f32_32x32x16_bf16 v[80:95], v[164:167], v[176:179], v[80:95]
    ds_read_b64_tr_b16 v[160:161], v233 offset:9280
    ds_read_b64_tr_b16 v[162:163], v233 offset:13888
    s_waitcnt lgkmcnt(8)
    v_mfma_f32_32x32x16_bf16 v[96:111], v[144:147], v[176:179], v[96:111]
    ds_read_b64_tr_b16 v[164:165], v233 offset:9344
    ds_read_b64_tr_b16 v[166:167], v233 offset:13952
    s_waitcnt lgkmcnt(8)
    v_mfma_f32_32x32x16_bf16 v[112:127], v[148:151], v[176:179], v[112:127]
    ds_read_b64_tr_b16 v[144:145], v233 offset:9408
    ds_read_b64_tr_b16 v[146:147], v233 offset:14016
    s_waitcnt lgkmcnt(8)
    v_mfma_f32_32x32x16_bf16 v[128:143], v[152:155], v[176:179], v[128:143]
    ds_read_b64_tr_b16 v[148:149], v233 offset:9472
    ds_read_b64_tr_b16 v[150:151], v233 offset:14080
    s_waitcnt lgkmcnt(8)
    v_mfma_f32_32x32x16_bf16 v[0:15], v[156:159], v[180:183], v[0:15]
    ds_read_b64_tr_b16 v[152:153], v233 offset:9536
    ds_read_b64_tr_b16 v[154:155], v233 offset:14144
    s_waitcnt lgkmcnt(8)
    v_mfma_f32_32x32x16_bf16 v[16:31], v[160:163], v[180:183], v[16:31]
    ds_read_b64_tr_b16 v[156:157], v233 offset:9600
    ds_read_b64_tr_b16 v[158:159], v233 offset:14208
    s_waitcnt lgkmcnt(8)
    v_mfma_f32_32x32x16_bf16 v[32:47], v[164:167], v[180:183], v[32:47]
    ds_read_b64_tr_b16 v[160:161], v233 offset:9664
    ds_read_b64_tr_b16 v[162:163], v233 offset:14272
    s_waitcnt lgkmcnt(8)
    v_mfma_f32_32x32x16_bf16 v[48:63], v[144:147], v[180:183], v[48:63]
    ds_read_b64_tr_b16 v[164:165], v233 offset:9728
    ds_read_b64_tr_b16 v[166:167], v233 offset:14336
    s_waitcnt lgkmcnt(8)
    v_mfma_f32_32x32x16_bf16 v[64:79], v[148:151], v[180:183], v[64:79]
    s_waitcnt vmcnt(11)
    s_barrier
    s_add_u32 s48, s46, 147456
    s_add_u32 m0, s40, 0
    s_nop 0
    buffer_load_dwordx4 v236, s[20:23], s48 offen lds
    s_add_u32 m0, s41, 0
    s_nop 0
    buffer_load_dwordx4 v237, s[24:27], s48 offen lds
    s_add_u32 m0, s42, 0
    s_nop 0
    buffer_load_dwordx4 v238, s[28:31], s48 offen lds
    s_add_u32 m0, s43, 0
    s_nop 0
    buffer_load_dwordx4 v239, s[32:35], s48 offen lds
    s_add_u32 m0, s44, 0
    s_nop 0
    buffer_load_dwordx4 v240, s[36:39], s48 offen lds
    ds_read_b64_tr_b16 v[144:145], v234 offset:0
    ds_read_b64_tr_b16 v[146:147], v234 offset:4608
    s_waitcnt lgkmcnt(8)
    v_mfma_f32_32x32x16_bf16 v[80:95], v[152:155], v[180:183], v[80:95]
    ds_read_b64_tr_b16 v[148:149], v234 offset:64
    ds_read_b64_tr_b16 v[150:151], v234 offset:4672
    s_waitcnt lgkmcnt(8)
    v_mfma_f32_32x32x16_bf16 v[96:111], v[156:159], v[180:183], v[96:111]
    ds_read_b64_tr_b16 v[152:153], v234 offset:128
    ds_read_b64_tr_b16 v[154:155], v234 offset:4736
    s_waitcnt lgkmcnt(8)
    v_mfma_f32_32x32x16_bf16 v[112:127], v[160:163], v[180:183], v[112:127]
    ds_read_b64_tr_b16 v[156:157], v234 offset:192
    ds_read_b64_tr_b16 v[158:159], v234 offset:4800
    s_waitcnt lgkmcnt(8)
    v_mfma_f32_32x32x16_bf16 v[128:143], v[164:167], v[180:183], v[128:143]
    ds_read_b64_tr_b16 v[160:161], v234 offset:256
    ds_read_b64_tr_b16 v[162:163], v234 offset:4864
    s_waitcnt lgkmcnt(8)
    v_mfma_f32_32x32x16_bf16 v[0:15], v[144:147], v[184:187], v[0:15]
    s_add_u32 s49, s47, 12288
    buffer_load_dwordx4 v[216:219], v241, s[12:15], s49 offen offset:0
    buffer_load_dwordx4 v[220:223], v241, s[12:15], s49 offen offset:1024
    s_add_u32 s49, s47, 14336
    buffer_load_dwordx4 v[224:227], v241, s[12:15], s49 offen offset:0
    buffer_load_dwordx4 v[228:231], v241, s[12:15], s49 offen offset:1024
    ds_read_b64_tr_b16 v[164:165], v234 offset:320
    ds_read_b64_tr_b16 v[166:167], v234 offset:4928
    s_waitcnt lgkmcnt(8)
    v_mfma_f32_32x32x16_bf16 v[16:31], v[148:151], v[184:187], v[16:31]
    ds_read_b64_tr_b16 v[144:145], v234 offset:384
    ds_read_b64_tr_b16 v[146:147], v234 offset:4992
    s_waitcnt lgkmcnt(8)
    v_mfma_f32_32x32x16_bf16 v[32:47], v[152:155], v[184:187], v[32:47]
    ds_read_b64_tr_b16 v[148:149], v234 offset:448
    ds_read_b64_tr_b16 v[150:151], v234 offset:5056
    s_waitcnt lgkmcnt(8)
    v_mfma_f32_32x32x16_bf16 v[48:63], v[156:159], v[184:187], v[48:63]
    ds_read_b64_tr_b16 v[152:153], v234 offset:512
    ds_read_b64_tr_b16 v[154:155], v234 offset:5120
    s_waitcnt lgkmcnt(8)
    v_mfma_f32_32x32x16_bf16 v[64:79], v[160:163], v[184:187], v[64:79]
    ds_read_b64_tr_b16 v[156:157], v234 offset:9216
    ds_read_b64_tr_b16 v[158:159], v234 offset:13824
    s_waitcnt lgkmcnt(8)
    v_mfma_f32_32x32x16_bf16 v[80:95], v[164:167], v[184:187], v[80:95]
    ds_read_b64_tr_b16 v[160:161], v234 offset:9280
    ds_read_b64_tr_b16 v[162:163], v234 offset:13888
    s_waitcnt lgkmcnt(8)
    v_mfma_f32_32x32x16_bf16 v[96:111], v[144:147], v[184:187], v[96:111]
    ds_read_b64_tr_b16 v[164:165], v234 offset:9344
    ds_read_b64_tr_b16 v[166:167], v234 offset:13952
    s_waitcnt lgkmcnt(8)
    v_mfma_f32_32x32x16_bf16 v[112:127], v[148:151], v[184:187], v[112:127]
    ds_read_b64_tr_b16 v[144:145], v234 offset:9408
    ds_read_b64_tr_b16 v[146:147], v234 offset:14016
    s_waitcnt lgkmcnt(8)
    v_mfma_f32_32x32x16_bf16 v[128:143], v[152:155], v[184:187], v[128:143]
    ds_read_b64_tr_b16 v[148:149], v234 offset:9472
    ds_read_b64_tr_b16 v[150:151], v234 offset:14080
    s_waitcnt lgkmcnt(8)
    v_mfma_f32_32x32x16_bf16 v[0:15], v[156:159], v[188:191], v[0:15]
    ds_read_b64_tr_b16 v[152:153], v234 offset:9536
    ds_read_b64_tr_b16 v[154:155], v234 offset:14144
    s_waitcnt lgkmcnt(8)
    v_mfma_f32_32x32x16_bf16 v[16:31], v[160:163], v[188:191], v[16:31]
    ds_read_b64_tr_b16 v[156:157], v234 offset:9600
    ds_read_b64_tr_b16 v[158:159], v234 offset:14208
    s_waitcnt lgkmcnt(8)
    v_mfma_f32_32x32x16_bf16 v[32:47], v[164:167], v[188:191], v[32:47]
    ds_read_b64_tr_b16 v[160:161], v234 offset:9664
    ds_read_b64_tr_b16 v[162:163], v234 offset:14272
    s_waitcnt lgkmcnt(8)
    v_mfma_f32_32x32x16_bf16 v[48:63], v[144:147], v[188:191], v[48:63]
    ds_read_b64_tr_b16 v[164:165], v234 offset:9728
    ds_read_b64_tr_b16 v[166:167], v234 offset:14336
    s_waitcnt lgkmcnt(8)
    v_mfma_f32_32x32x16_bf16 v[64:79], v[148:151], v[188:191], v[64:79]
    s_waitcnt vmcnt(13)
    s_barrier
    s_add_u32 s48, s46, 184320
    s_add_u32 m0, s40, 18432
    s_nop 0
    buffer_load_dwordx4 v236, s[20:23], s48 offen lds
    s_add_u32 m0, s41, 18432
    s_nop 0
    buffer_load_dwordx4 v237, s[24:27], s48 offen lds
    s_add_u32 m0, s42, 18432
    s_nop 0
    buffer_load_dwordx4 v238, s[28:31], s48 offen lds
    s_add_u32 m0, s43, 18432
    s_nop 0
    buffer_load_dwordx4 v239, s[32:35], s48 offen lds
    s_add_u32 m0, s44, 18432
    s_nop 0
    buffer_load_dwordx4 v240, s[36:39], s48 offen lds
    ds_read_b64_tr_b16 v[144:145], v235 offset:0
    ds_read_b64_tr_b16 v[146:147], v235 offset:4608
    s_waitcnt lgkmcnt(8)
    v_mfma_f32_32x32x16_bf16 v[80:95], v[152:155], v[188:191], v[80:95]
    ds_read_b64_tr_b16 v[148:149], v235 offset:64
    ds_read_b64_tr_b16 v[150:151], v235 offset:4672
    s_waitcnt lgkmcnt(8)
    v_mfma_f32_32x32x16_bf16 v[96:111], v[156:159], v[188:191], v[96:111]
    ds_read_b64_tr_b16 v[152:153], v235 offset:128
    ds_read_b64_tr_b16 v[154:155], v235 offset:4736
    s_waitcnt lgkmcnt(8)
    v_mfma_f32_32x32x16_bf16 v[112:127], v[160:163], v[188:191], v[112:127]
    ds_read_b64_tr_b16 v[156:157], v235 offset:192
    ds_read_b64_tr_b16 v[158:159], v235 offset:4800
    s_waitcnt lgkmcnt(8)
    v_mfma_f32_32x32x16_bf16 v[128:143], v[164:167], v[188:191], v[128:143]
    ds_read_b64_tr_b16 v[160:161], v235 offset:256
    ds_read_b64_tr_b16 v[162:163], v235 offset:4864
    s_waitcnt lgkmcnt(8)
    v_mfma_f32_32x32x16_bf16 v[0:15], v[144:147], v[192:195], v[0:15]
    s_add_u32 s49, s47, 16384
    buffer_load_dwordx4 v[168:171], v241, s[12:15], s49 offen offset:0
    buffer_load_dwordx4 v[172:175], v241, s[12:15], s49 offen offset:1024
    s_add_u32 s49, s47, 18432
    buffer_load_dwordx4 v[176:179], v241, s[12:15], s49 offen offset:0
    buffer_load_dwordx4 v[180:183], v241, s[12:15], s49 offen offset:1024
    ds_read_b64_tr_b16 v[164:165], v235 offset:320
    ds_read_b64_tr_b16 v[166:167], v235 offset:4928
    s_waitcnt lgkmcnt(8)
    v_mfma_f32_32x32x16_bf16 v[16:31], v[148:151], v[192:195], v[16:31]
    ds_read_b64_tr_b16 v[144:145], v235 offset:384
    ds_read_b64_tr_b16 v[146:147], v235 offset:4992
    s_waitcnt lgkmcnt(8)
    v_mfma_f32_32x32x16_bf16 v[32:47], v[152:155], v[192:195], v[32:47]
    ds_read_b64_tr_b16 v[148:149], v235 offset:448
    ds_read_b64_tr_b16 v[150:151], v235 offset:5056
    s_waitcnt lgkmcnt(8)
    v_mfma_f32_32x32x16_bf16 v[48:63], v[156:159], v[192:195], v[48:63]
    ds_read_b64_tr_b16 v[152:153], v235 offset:512
    ds_read_b64_tr_b16 v[154:155], v235 offset:5120
    s_waitcnt lgkmcnt(8)
    v_mfma_f32_32x32x16_bf16 v[64:79], v[160:163], v[192:195], v[64:79]
    ds_read_b64_tr_b16 v[156:157], v235 offset:9216
    ds_read_b64_tr_b16 v[158:159], v235 offset:13824
    s_waitcnt lgkmcnt(8)
    v_mfma_f32_32x32x16_bf16 v[80:95], v[164:167], v[192:195], v[80:95]
    ds_read_b64_tr_b16 v[160:161], v235 offset:9280
    ds_read_b64_tr_b16 v[162:163], v235 offset:13888
    s_waitcnt lgkmcnt(8)
    v_mfma_f32_32x32x16_bf16 v[96:111], v[144:147], v[192:195], v[96:111]
    ds_read_b64_tr_b16 v[164:165], v235 offset:9344
    ds_read_b64_tr_b16 v[166:167], v235 offset:13952
    s_waitcnt lgkmcnt(8)
    v_mfma_f32_32x32x16_bf16 v[112:127], v[148:151], v[192:195], v[112:127]
    ds_read_b64_tr_b16 v[144:145], v235 offset:9408
    ds_read_b64_tr_b16 v[146:147], v235 offset:14016
    s_waitcnt lgkmcnt(8)
    v_mfma_f32_32x32x16_bf16 v[128:143], v[152:155], v[192:195], v[128:143]
    ds_read_b64_tr_b16 v[148:149], v235 offset:9472
    ds_read_b64_tr_b16 v[150:151], v235 offset:14080
    s_waitcnt lgkmcnt(8)
    v_mfma_f32_32x32x16_bf16 v[0:15], v[156:159], v[196:199], v[0:15]
    ds_read_b64_tr_b16 v[152:153], v235 offset:9536
    ds_read_b64_tr_b16 v[154:155], v235 offset:14144
    s_waitcnt lgkmcnt(8)
    v_mfma_f32_32x32x16_bf16 v[16:31], v[160:163], v[196:199], v[16:31]
    ds_read_b64_tr_b16 v[156:157], v235 offset:9600
    ds_read_b64_tr_b16 v[158:159], v235 offset:14208
    s_waitcnt lgkmcnt(8)
    v_mfma_f32_32x32x16_bf16 v[32:47], v[164:167], v[196:199], v[32:47]
    ds_read_b64_tr_b16 v[160:161], v235 offset:9664
    ds_read_b64_tr_b16 v[162:163], v235 offset:14272
    s_waitcnt lgkmcnt(8)
    v_mfma_f32_32x32x16_bf16 v[48:63], v[144:147], v[196:199], v[48:63]
    ds_read_b64_tr_b16 v[164:165], v235 offset:9728
    ds_read_b64_tr_b16 v[166:167], v235 offset:14336
    s_waitcnt lgkmcnt(8)
    v_mfma_f32_32x32x16_bf16 v[64:79], v[148:151], v[196:199], v[64:79]
    s_waitcnt vmcnt(13)
    s_barrier
    s_add_u32 s48, s46, 221184
    s_add_u32 m0, s40, 36864
    s_nop 0
    buffer_load_dwordx4 v236, s[20:23], s48 offen lds
    s_add_u32 m0, s41, 36864
    s_nop 0
    buffer_load_dwordx4 v237, s[24:27], s48 offen lds
    s_add_u32 m0, s42, 36864
    s_nop 0
    buffer_load_dwordx4 v238, s[28:31], s48 offen lds
    s_add_u32 m0, s43, 36864
    s_nop 0
    buffer_load_dwordx4 v239, s[32:35], s48 offen lds
    s_add_u32 m0, s44, 36864
    s_nop 0
    buffer_load_dwordx4 v240, s[36:39], s48 offen lds
    ds_read_b64_tr_b16 v[144:145], v232 offset:0
    ds_read_b64_tr_b16 v[146:147], v232 offset:4608
    s_waitcnt lgkmcnt(8)
    v_mfma_f32_32x32x16_bf16 v[80:95], v[152:155], v[196:199], v[80:95]
    ds_read_b64_tr_b16 v[148:149], v232 offset:64
    ds_read_b64_tr_b16 v[150:151], v232 offset:4672
    s_waitcnt lgkmcnt(8)
    v_mfma_f32_32x32x16_bf16 v[96:111], v[156:159], v[196:199], v[96:111]
    ds_read_b64_tr_b16 v[152:153], v232 offset:128
    ds_read_b64_tr_b16 v[154:155], v232 offset:4736
    s_waitcnt lgkmcnt(8)
    v_mfma_f32_32x32x16_bf16 v[112:127], v[160:163], v[196:199], v[112:127]
    ds_read_b64_tr_b16 v[156:157], v232 offset:192
    ds_read_b64_tr_b16 v[158:159], v232 offset:4800
    s_waitcnt lgkmcnt(8)
    v_mfma_f32_32x32x16_bf16 v[128:143], v[164:167], v[196:199], v[128:143]
    ds_read_b64_tr_b16 v[160:161], v232 offset:256
    ds_read_b64_tr_b16 v[162:163], v232 offset:4864
    s_waitcnt lgkmcnt(8)
    v_mfma_f32_32x32x16_bf16 v[0:15], v[144:147], v[200:203], v[0:15]
    s_add_u32 s49, s47, 20480
    buffer_load_dwordx4 v[184:187], v241, s[12:15], s49 offen offset:0
    buffer_load_dwordx4 v[188:191], v241, s[12:15], s49 offen offset:1024
    s_add_u32 s49, s47, 22528
    buffer_load_dwordx4 v[192:195], v241, s[12:15], s49 offen offset:0
    buffer_load_dwordx4 v[196:199], v241, s[12:15], s49 offen offset:1024
    ds_read_b64_tr_b16 v[164:165], v232 offset:320
    ds_read_b64_tr_b16 v[166:167], v232 offset:4928
    s_waitcnt lgkmcnt(8)
    v_mfma_f32_32x32x16_bf16 v[16:31], v[148:151], v[200:203], v[16:31]
    ds_read_b64_tr_b16 v[144:145], v232 offset:384
    ds_read_b64_tr_b16 v[146:147], v232 offset:4992
    s_waitcnt lgkmcnt(8)
    v_mfma_f32_32x32x16_bf16 v[32:47], v[152:155], v[200:203], v[32:47]
    ds_read_b64_tr_b16 v[148:149], v232 offset:448
    ds_read_b64_tr_b16 v[150:151], v232 offset:5056
    s_waitcnt lgkmcnt(8)
    v_mfma_f32_32x32x16_bf16 v[48:63], v[156:159], v[200:203], v[48:63]
    ds_read_b64_tr_b16 v[152:153], v232 offset:512
    ds_read_b64_tr_b16 v[154:155], v232 offset:5120
    s_waitcnt lgkmcnt(8)
    v_mfma_f32_32x32x16_bf16 v[64:79], v[160:163], v[200:203], v[64:79]
    ds_read_b64_tr_b16 v[156:157], v232 offset:9216
    ds_read_b64_tr_b16 v[158:159], v232 offset:13824
    s_waitcnt lgkmcnt(8)
    v_mfma_f32_32x32x16_bf16 v[80:95], v[164:167], v[200:203], v[80:95]
    ds_read_b64_tr_b16 v[160:161], v232 offset:9280
    ds_read_b64_tr_b16 v[162:163], v232 offset:13888
    s_waitcnt lgkmcnt(8)
    v_mfma_f32_32x32x16_bf16 v[96:111], v[144:147], v[200:203], v[96:111]
    ds_read_b64_tr_b16 v[164:165], v232 offset:9344
    ds_read_b64_tr_b16 v[166:167], v232 offset:13952
    s_waitcnt lgkmcnt(8)
    v_mfma_f32_32x32x16_bf16 v[112:127], v[148:151], v[200:203], v[112:127]
    ds_read_b64_tr_b16 v[144:145], v232 offset:9408
    ds_read_b64_tr_b16 v[146:147], v232 offset:14016
    s_waitcnt lgkmcnt(8)
    v_mfma_f32_32x32x16_bf16 v[128:143], v[152:155], v[200:203], v[128:143]
    ds_read_b64_tr_b16 v[148:149], v232 offset:9472
    ds_read_b64_tr_b16 v[150:151], v232 offset:14080
    s_waitcnt lgkmcnt(8)
    v_mfma_f32_32x32x16_bf16 v[0:15], v[156:159], v[204:207], v[0:15]
    ds_read_b64_tr_b16 v[152:153], v232 offset:9536
    ds_read_b64_tr_b16 v[154:155], v232 offset:14144
    s_waitcnt lgkmcnt(8)
    v_mfma_f32_32x32x16_bf16 v[16:31], v[160:163], v[204:207], v[16:31]
    ds_read_b64_tr_b16 v[156:157], v232 offset:9600
    ds_read_b64_tr_b16 v[158:159], v232 offset:14208
    s_waitcnt lgkmcnt(8)
    v_mfma_f32_32x32x16_bf16 v[32:47], v[164:167], v[204:207], v[32:47]
    ds_read_b64_tr_b16 v[160:161], v232 offset:9664
    ds_read_b64_tr_b16 v[162:163], v232 offset:14272
    s_waitcnt lgkmcnt(8)
    v_mfma_f32_32x32x16_bf16 v[48:63], v[144:147], v[204:207], v[48:63]
    ds_read_b64_tr_b16 v[164:165], v232 offset:9728
    ds_read_b64_tr_b16 v[166:167], v232 offset:14336
    s_waitcnt lgkmcnt(8)
    v_mfma_f32_32x32x16_bf16 v[64:79], v[148:151], v[204:207], v[64:79]
    s_waitcnt vmcnt(13)
    s_barrier
    s_add_u32 s48, s46, 258048
    s_add_u32 m0, s40, 55296
    s_nop 0
    buffer_load_dwordx4 v236, s[20:23], s48 offen lds
    s_add_u32 m0, s41, 55296
    s_nop 0
    buffer_load_dwordx4 v237, s[24:27], s48 offen lds
    s_add_u32 m0, s42, 55296
    s_nop 0
    buffer_load_dwordx4 v238, s[28:31], s48 offen lds
    s_add_u32 m0, s43, 55296
    s_nop 0
    buffer_load_dwordx4 v239, s[32:35], s48 offen lds
    s_add_u32 m0, s44, 55296
    s_nop 0
    buffer_load_dwordx4 v240, s[36:39], s48 offen lds
    ds_read_b64_tr_b16 v[144:145], v233 offset:0
    ds_read_b64_tr_b16 v[146:147], v233 offset:4608
    s_waitcnt lgkmcnt(8)
    v_mfma_f32_32x32x16_bf16 v[80:95], v[152:155], v[204:207], v[80:95]
    ds_read_b64_tr_b16 v[148:149], v233 offset:64
    ds_read_b64_tr_b16 v[150:151], v233 offset:4672
    s_waitcnt lgkmcnt(8)
    v_mfma_f32_32x32x16_bf16 v[96:111], v[156:159], v[204:207], v[96:111]
    ds_read_b64_tr_b16 v[152:153], v233 offset:128
    ds_read_b64_tr_b16 v[154:155], v233 offset:4736
    s_waitcnt lgkmcnt(8)
    v_mfma_f32_32x32x16_bf16 v[112:127], v[160:163], v[204:207], v[112:127]
    ds_read_b64_tr_b16 v[156:157], v233 offset:192
    ds_read_b64_tr_b16 v[158:159], v233 offset:4800
    s_waitcnt lgkmcnt(8)
    v_mfma_f32_32x32x16_bf16 v[128:143], v[164:167], v[204:207], v[128:143]
    ds_read_b64_tr_b16 v[160:161], v233 offset:256
    ds_read_b64_tr_b16 v[162:163], v233 offset:4864
    s_waitcnt lgkmcnt(8)
    v_mfma_f32_32x32x16_bf16 v[0:15], v[144:147], v[208:211], v[0:15]
    s_add_u32 s49, s47, 24576
    buffer_load_dwordx4 v[200:203], v241, s[12:15], s49 offen offset:0
    buffer_load_dwordx4 v[204:207], v241, s[12:15], s49 offen offset:1024
    ds_read_b64_tr_b16 v[164:165], v233 offset:320
    ds_read_b64_tr_b16 v[166:167], v233 offset:4928
    s_waitcnt lgkmcnt(8)
    v_mfma_f32_32x32x16_bf16 v[16:31], v[148:151], v[208:211], v[16:31]
    ds_read_b64_tr_b16 v[144:145], v233 offset:384
    ds_read_b64_tr_b16 v[146:147], v233 offset:4992
    s_waitcnt lgkmcnt(8)
    v_mfma_f32_32x32x16_bf16 v[32:47], v[152:155], v[208:211], v[32:47]
    ds_read_b64_tr_b16 v[148:149], v233 offset:448
    ds_read_b64_tr_b16 v[150:151], v233 offset:5056
    s_waitcnt lgkmcnt(8)
    v_mfma_f32_32x32x16_bf16 v[48:63], v[156:159], v[208:211], v[48:63]
    ds_read_b64_tr_b16 v[152:153], v233 offset:512
    ds_read_b64_tr_b16 v[154:155], v233 offset:5120
    s_waitcnt lgkmcnt(8)
    v_mfma_f32_32x32x16_bf16 v[64:79], v[160:163], v[208:211], v[64:79]
    ds_read_b64_tr_b16 v[156:157], v233 offset:9216
    ds_read_b64_tr_b16 v[158:159], v233 offset:13824
    s_waitcnt lgkmcnt(8)
    v_mfma_f32_32x32x16_bf16 v[80:95], v[164:167], v[208:211], v[80:95]
    ds_read_b64_tr_b16 v[160:161], v233 offset:9280
    ds_read_b64_tr_b16 v[162:163], v233 offset:13888
    s_waitcnt lgkmcnt(8)
    v_mfma_f32_32x32x16_bf16 v[96:111], v[144:147], v[208:211], v[96:111]
    ds_read_b64_tr_b16 v[164:165], v233 offset:9344
    ds_read_b64_tr_b16 v[166:167], v233 offset:13952
    s_waitcnt lgkmcnt(8)
    v_mfma_f32_32x32x16_bf16 v[112:127], v[148:151], v[208:211], v[112:127]
    ds_read_b64_tr_b16 v[144:145], v233 offset:9408
    ds_read_b64_tr_b16 v[146:147], v233 offset:14016
    s_waitcnt lgkmcnt(8)
    v_mfma_f32_32x32x16_bf16 v[128:143], v[152:155], v[208:211], v[128:143]
    ds_read_b64_tr_b16 v[148:149], v233 offset:9472
    ds_read_b64_tr_b16 v[150:151], v233 offset:14080
    s_waitcnt lgkmcnt(8)
    v_mfma_f32_32x32x16_bf16 v[0:15], v[156:159], v[212:215], v[0:15]
    ds_read_b64_tr_b16 v[152:153], v233 offset:9536
    ds_read_b64_tr_b16 v[154:155], v233 offset:14144
    s_waitcnt lgkmcnt(8)
    v_mfma_f32_32x32x16_bf16 v[16:31], v[160:163], v[212:215], v[16:31]
    ds_read_b64_tr_b16 v[156:157], v233 offset:9600
    ds_read_b64_tr_b16 v[158:159], v233 offset:14208
    s_waitcnt lgkmcnt(8)
    v_mfma_f32_32x32x16_bf16 v[32:47], v[164:167], v[212:215], v[32:47]
    ds_read_b64_tr_b16 v[160:161], v233 offset:9664
    ds_read_b64_tr_b16 v[162:163], v233 offset:14272
    s_waitcnt lgkmcnt(8)
    v_mfma_f32_32x32x16_bf16 v[48:63], v[144:147], v[212:215], v[48:63]
    ds_read_b64_tr_b16 v[164:165], v233 offset:9728
    ds_read_b64_tr_b16 v[166:167], v233 offset:14336
    s_waitcnt lgkmcnt(8)
    v_mfma_f32_32x32x16_bf16 v[64:79], v[148:151], v[212:215], v[64:79]
    s_waitcnt vmcnt(11)
    s_barrier
    s_add_u32 s48, s46, 294912
    s_add_u32 m0, s40, 0
    s_nop 0
    buffer_load_dwordx4 v236, s[20:23], s48 offen lds
    s_add_u32 m0, s41, 0
    s_nop 0
    buffer_load_dwordx4 v237, s[24:27], s48 offen lds
    s_add_u32 m0, s42, 0
    s_nop 0
    buffer_load_dwordx4 v238, s[28:31], s48 offen lds
    s_add_u32 m0, s43, 0
    s_nop 0
    buffer_load_dwordx4 v239, s[32:35], s48 offen lds
    s_add_u32 m0, s44, 0
    s_nop 0
    buffer_load_dwordx4 v240, s[36:39], s48 offen lds
    ds_read_b64_tr_b16 v[144:145], v234 offset:0
    ds_read_b64_tr_b16 v[146:147], v234 offset:4608
    s_waitcnt lgkmcnt(8)
    v_mfma_f32_32x32x16_bf16 v[80:95], v[152:155], v[212:215], v[80:95]
    ds_read_b64_tr_b16 v[148:149], v234 offset:64
    ds_read_b64_tr_b16 v[150:151], v234 offset:4672
    s_waitcnt lgkmcnt(8)
    v_mfma_f32_32x32x16_bf16 v[96:111], v[156:159], v[212:215], v[96:111]
    ds_read_b64_tr_b16 v[152:153], v234 offset:128
    ds_read_b64_tr_b16 v[154:155], v234 offset:4736
    s_waitcnt lgkmcnt(8)
    v_mfma_f32_32x32x16_bf16 v[112:127], v[160:163], v[212:215], v[112:127]
    ds_read_b64_tr_b16 v[156:157], v234 offset:192
    ds_read_b64_tr_b16 v[158:159], v234 offset:4800
    s_waitcnt lgkmcnt(8)
    v_mfma_f32_32x32x16_bf16 v[128:143], v[164:167], v[212:215], v[128:143]
    ds_read_b64_tr_b16 v[160:161], v234 offset:256
    ds_read_b64_tr_b16 v[162:163], v234 offset:4864
    s_waitcnt lgkmcnt(8)
    v_mfma_f32_32x32x16_bf16 v[0:15], v[144:147], v[216:219], v[0:15]
    s_add_u32 s49, s47, 26624
    buffer_load_dwordx4 v[208:211], v241, s[12:15], s49 offen offset:0
    buffer_load_dwordx4 v[212:215], v241, s[12:15], s49 offen offset:1024
    ds_read_b64_tr_b16 v[164:165], v234 offset:320
    ds_read_b64_tr_b16 v[166:167], v234 offset:4928
    s_waitcnt lgkmcnt(8)
    v_mfma_f32_32x32x16_bf16 v[16:31], v[148:151], v[216:219], v[16:31]
    ds_read_b64_tr_b16 v[144:145], v234 offset:384
    ds_read_b64_tr_b16 v[146:147], v234 offset:4992
    s_waitcnt lgkmcnt(8)
    v_mfma_f32_32x32x16_bf16 v[32:47], v[152:155], v[216:219], v[32:47]
    ds_read_b64_tr_b16 v[148:149], v234 offset:448
    ds_read_b64_tr_b16 v[150:151], v234 offset:5056
    s_waitcnt lgkmcnt(8)
    v_mfma_f32_32x32x16_bf16 v[48:63], v[156:159], v[216:219], v[48:63]
    ds_read_b64_tr_b16 v[152:153], v234 offset:512
    ds_read_b64_tr_b16 v[154:155], v234 offset:5120
    s_waitcnt lgkmcnt(8)
    v_mfma_f32_32x32x16_bf16 v[64:79], v[160:163], v[216:219], v[64:79]
    ds_read_b64_tr_b16 v[156:157], v234 offset:9216
    ds_read_b64_tr_b16 v[158:159], v234 offset:13824
    s_waitcnt lgkmcnt(8)
    v_mfma_f32_32x32x16_bf16 v[80:95], v[164:167], v[216:219], v[80:95]
    ds_read_b64_tr_b16 v[160:161], v234 offset:9280
    ds_read_b64_tr_b16 v[162:163], v234 offset:13888
    s_waitcnt lgkmcnt(8)
    v_mfma_f32_32x32x16_bf16 v[96:111], v[144:147], v[216:219], v[96:111]
    ds_read_b64_tr_b16 v[164:165], v234 offset:9344
    ds_read_b64_tr_b16 v[166:167], v234 offset:13952
    s_waitcnt lgkmcnt(8)
    v_mfma_f32_32x32x16_bf16 v[112:127], v[148:151], v[216:219], v[112:127]
    ds_read_b64_tr_b16 v[144:145], v234 offset:9408
    ds_read_b64_tr_b16 v[146:147], v234 offset:14016
    s_waitcnt lgkmcnt(8)
    v_mfma_f32_32x32x16_bf16 v[128:143], v[152:155], v[216:219], v[128:143]
    ds_read_b64_tr_b16 v[148:149], v234 offset:9472
    ds_read_b64_tr_b16 v[150:151], v234 offset:14080
    s_waitcnt lgkmcnt(8)
    v_mfma_f32_32x32x16_bf16 v[0:15], v[156:159], v[220:223], v[0:15]
    ds_read_b64_tr_b16 v[152:153], v234 offset:9536
    ds_read_b64_tr_b16 v[154:155], v234 offset:14144
    s_waitcnt lgkmcnt(8)
    v_mfma_f32_32x32x16_bf16 v[16:31], v[160:163], v[220:223], v[16:31]
    ds_read_b64_tr_b16 v[156:157], v234 offset:9600
    ds_read_b64_tr_b16 v[158:159], v234 offset:14208
    s_waitcnt lgkmcnt(8)
    v_mfma_f32_32x32x16_bf16 v[32:47], v[164:167], v[220:223], v[32:47]
    ds_read_b64_tr_b16 v[160:161], v234 offset:9664
    ds_read_b64_tr_b16 v[162:163], v234 offset:14272
    s_waitcnt lgkmcnt(8)
    v_mfma_f32_32x32x16_bf16 v[48:63], v[144:147], v[220:223], v[48:63]
    ds_read_b64_tr_b16 v[164:165], v234 offset:9728
    ds_read_b64_tr_b16 v[166:167], v234 offset:14336
    s_waitcnt lgkmcnt(8)
    v_mfma_f32_32x32x16_bf16 v[64:79], v[148:151], v[220:223], v[64:79]
    s_waitcnt vmcnt(9)
    s_barrier
    s_add_u32 s48, s46, 331776
    s_add_u32 m0, s40, 18432
    s_nop 0
    buffer_load_dwordx4 v236, s[20:23], s48 offen lds
    s_add_u32 m0, s41, 18432
    s_nop 0
    buffer_load_dwordx4 v237, s[24:27], s48 offen lds
    s_add_u32 m0, s42, 18432
    s_nop 0
    buffer_load_dwordx4 v238, s[28:31], s48 offen lds
    s_add_u32 m0, s43, 18432
    s_nop 0
    buffer_load_dwordx4 v239, s[32:35], s48 offen lds
    s_add_u32 m0, s44, 18432
    s_nop 0
    buffer_load_dwordx4 v240, s[36:39], s48 offen lds
    ds_read_b64_tr_b16 v[144:145], v235 offset:0
    ds_read_b64_tr_b16 v[146:147], v235 offset:4608
    s_waitcnt lgkmcnt(8)
    v_mfma_f32_32x32x16_bf16 v[80:95], v[152:155], v[220:223], v[80:95]
    ds_read_b64_tr_b16 v[148:149], v235 offset:64
    ds_read_b64_tr_b16 v[150:151], v235 offset:4672
    s_waitcnt lgkmcnt(8)
    v_mfma_f32_32x32x16_bf16 v[96:111], v[156:159], v[220:223], v[96:111]
    ds_read_b64_tr_b16 v[152:153], v235 offset:128
    ds_read_b64_tr_b16 v[154:155], v235 offset:4736
    s_waitcnt lgkmcnt(8)
    v_mfma_f32_32x32x16_bf16 v[112:127], v[160:163], v[220:223], v[112:127]
    ds_read_b64_tr_b16 v[156:157], v235 offset:192
    ds_read_b64_tr_b16 v[158:159], v235 offset:4800
    s_waitcnt lgkmcnt(8)
    v_mfma_f32_32x32x16_bf16 v[128:143], v[164:167], v[220:223], v[128:143]
    ds_read_b64_tr_b16 v[160:161], v235 offset:256
    ds_read_b64_tr_b16 v[162:163], v235 offset:4864
    s_waitcnt lgkmcnt(8)
    v_mfma_f32_32x32x16_bf16 v[0:15], v[144:147], v[224:227], v[0:15]
    s_add_u32 s49, s47, 28672
    buffer_load_dwordx4 v[216:219], v241, s[12:15], s49 offen offset:0
    buffer_load_dwordx4 v[220:223], v241, s[12:15], s49 offen offset:1024
    ds_read_b64_tr_b16 v[164:165], v235 offset:320
    ds_read_b64_tr_b16 v[166:167], v235 offset:4928
    s_waitcnt lgkmcnt(8)
    v_mfma_f32_32x32x16_bf16 v[16:31], v[148:151], v[224:227], v[16:31]
    ds_read_b64_tr_b16 v[144:145], v235 offset:384
    ds_read_b64_tr_b16 v[146:147], v235 offset:4992
    s_waitcnt lgkmcnt(8)
    v_mfma_f32_32x32x16_bf16 v[32:47], v[152:155], v[224:227], v[32:47]
    ds_read_b64_tr_b16 v[148:149], v235 offset:448
    ds_read_b64_tr_b16 v[150:151], v235 offset:5056
    s_waitcnt lgkmcnt(8)
    v_mfma_f32_32x32x16_bf16 v[48:63], v[156:159], v[224:227], v[48:63]
    ds_read_b64_tr_b16 v[152:153], v235 offset:512
    ds_read_b64_tr_b16 v[154:155], v235 offset:5120
    s_waitcnt lgkmcnt(8)
    v_mfma_f32_32x32x16_bf16 v[64:79], v[160:163], v[224:227], v[64:79]
    ds_read_b64_tr_b16 v[156:157], v235 offset:9216
    ds_read_b64_tr_b16 v[158:159], v235 offset:13824
    s_waitcnt lgkmcnt(8)
    v_mfma_f32_32x32x16_bf16 v[80:95], v[164:167], v[224:227], v[80:95]
    ds_read_b64_tr_b16 v[160:161], v235 offset:9280
    ds_read_b64_tr_b16 v[162:163], v235 offset:13888
    s_waitcnt lgkmcnt(8)
    v_mfma_f32_32x32x16_bf16 v[96:111], v[144:147], v[224:227], v[96:111]
    ds_read_b64_tr_b16 v[164:165], v235 offset:9344
    ds_read_b64_tr_b16 v[166:167], v235 offset:13952
    s_waitcnt lgkmcnt(8)
    v_mfma_f32_32x32x16_bf16 v[112:127], v[148:151], v[224:227], v[112:127]
    ds_read_b64_tr_b16 v[144:145], v235 offset:9408
    ds_read_b64_tr_b16 v[146:147], v235 offset:14016
    s_waitcnt lgkmcnt(8)
    v_mfma_f32_32x32x16_bf16 v[128:143], v[152:155], v[224:227], v[128:143]
    ds_read_b64_tr_b16 v[148:149], v235 offset:9472
    ds_read_b64_tr_b16 v[150:151], v235 offset:14080
    s_waitcnt lgkmcnt(8)
    v_mfma_f32_32x32x16_bf16 v[0:15], v[156:159], v[228:231], v[0:15]
    ds_read_b64_tr_b16 v[152:153], v235 offset:9536
    ds_read_b64_tr_b16 v[154:155], v235 offset:14144
    s_waitcnt lgkmcnt(8)
    v_mfma_f32_32x32x16_bf16 v[16:31], v[160:163], v[228:231], v[16:31]
    ds_read_b64_tr_b16 v[156:157], v235 offset:9600
    ds_read_b64_tr_b16 v[158:159], v235 offset:14208
    s_waitcnt lgkmcnt(8)
    v_mfma_f32_32x32x16_bf16 v[32:47], v[164:167], v[228:231], v[32:47]
    ds_read_b64_tr_b16 v[160:161], v235 offset:9664
    ds_read_b64_tr_b16 v[162:163], v235 offset:14272
    s_waitcnt lgkmcnt(8)
    v_mfma_f32_32x32x16_bf16 v[48:63], v[144:147], v[228:231], v[48:63]
    ds_read_b64_tr_b16 v[164:165], v235 offset:9728
    ds_read_b64_tr_b16 v[166:167], v235 offset:14336
    s_waitcnt lgkmcnt(8)
    v_mfma_f32_32x32x16_bf16 v[64:79], v[148:151], v[228:231], v[64:79]
    s_waitcnt vmcnt(9)
    s_barrier
    s_add_u32 s48, s46, 368640
    s_add_u32 m0, s40, 36864
    s_nop 0
    buffer_load_dwordx4 v236, s[20:23], s48 offen lds
    s_add_u32 m0, s41, 36864
    s_nop 0
    buffer_load_dwordx4 v237, s[24:27], s48 offen lds
    s_add_u32 m0, s42, 36864
    s_nop 0
    buffer_load_dwordx4 v238, s[28:31], s48 offen lds
    s_add_u32 m0, s43, 36864
    s_nop 0
    buffer_load_dwordx4 v239, s[32:35], s48 offen lds
    s_add_u32 m0, s44, 36864
    s_nop 0
    buffer_load_dwordx4 v240, s[36:39], s48 offen lds
    ds_read_b64_tr_b16 v[144:145], v232 offset:0
    ds_read_b64_tr_b16 v[146:147], v232 offset:4608
    s_waitcnt lgkmcnt(8)
    v_mfma_f32_32x32x16_bf16 v[80:95], v[152:155], v[228:231], v[80:95]
    ds_read_b64_tr_b16 v[148:149], v232 offset:64
    ds_read_b64_tr_b16 v[150:151], v232 offset:4672
    s_waitcnt lgkmcnt(8)
    v_mfma_f32_32x32x16_bf16 v[96:111], v[156:159], v[228:231], v[96:111]
    ds_read_b64_tr_b16 v[152:153], v232 offset:128
    ds_read_b64_tr_b16 v[154:155], v232 offset:4736
    s_waitcnt lgkmcnt(8)
    v_mfma_f32_32x32x16_bf16 v[112:127], v[160:163], v[228:231], v[112:127]
    ds_read_b64_tr_b16 v[156:157], v232 offset:192
    ds_read_b64_tr_b16 v[158:159], v232 offset:4800
    s_waitcnt lgkmcnt(8)
    v_mfma_f32_32x32x16_bf16 v[128:143], v[164:167], v[228:231], v[128:143]
    ds_read_b64_tr_b16 v[160:161], v232 offset:256
    ds_read_b64_tr_b16 v[162:163], v232 offset:4864
    s_waitcnt lgkmcnt(8)
    v_mfma_f32_32x32x16_bf16 v[0:15], v[144:147], v[168:171], v[0:15]
    s_add_u32 s49, s47, 30720
    buffer_load_dwordx4 v[224:227], v241, s[12:15], s49 offen offset:0
    buffer_load_dwordx4 v[228:231], v241, s[12:15], s49 offen offset:1024
    ds_read_b64_tr_b16 v[164:165], v232 offset:320
    ds_read_b64_tr_b16 v[166:167], v232 offset:4928
    s_waitcnt lgkmcnt(8)
    v_mfma_f32_32x32x16_bf16 v[16:31], v[148:151], v[168:171], v[16:31]
    ds_read_b64_tr_b16 v[144:145], v232 offset:384
    ds_read_b64_tr_b16 v[146:147], v232 offset:4992
    s_waitcnt lgkmcnt(8)
    v_mfma_f32_32x32x16_bf16 v[32:47], v[152:155], v[168:171], v[32:47]
    ds_read_b64_tr_b16 v[148:149], v232 offset:448
    ds_read_b64_tr_b16 v[150:151], v232 offset:5056
    s_waitcnt lgkmcnt(8)
    v_mfma_f32_32x32x16_bf16 v[48:63], v[156:159], v[168:171], v[48:63]
    ds_read_b64_tr_b16 v[152:153], v232 offset:512
    ds_read_b64_tr_b16 v[154:155], v232 offset:5120
    s_waitcnt lgkmcnt(8)
    v_mfma_f32_32x32x16_bf16 v[64:79], v[160:163], v[168:171], v[64:79]
    ds_read_b64_tr_b16 v[156:157], v232 offset:9216
    ds_read_b64_tr_b16 v[158:159], v232 offset:13824
    s_waitcnt lgkmcnt(8)
    v_mfma_f32_32x32x16_bf16 v[80:95], v[164:167], v[168:171], v[80:95]
    ds_read_b64_tr_b16 v[160:161], v232 offset:9280
    ds_read_b64_tr_b16 v[162:163], v232 offset:13888
    s_waitcnt lgkmcnt(8)
    v_mfma_f32_32x32x16_bf16 v[96:111], v[144:147], v[168:171], v[96:111]
    ds_read_b64_tr_b16 v[164:165], v232 offset:9344
    ds_read_b64_tr_b16 v[166:167], v232 offset:13952
    s_waitcnt lgkmcnt(8)
    v_mfma_f32_32x32x16_bf16 v[112:127], v[148:151], v[168:171], v[112:127]
    ds_read_b64_tr_b16 v[144:145], v232 offset:9408
    ds_read_b64_tr_b16 v[146:147], v232 offset:14016
    s_waitcnt lgkmcnt(8)
    v_mfma_f32_32x32x16_bf16 v[128:143], v[152:155], v[168:171], v[128:143]
    ds_read_b64_tr_b16 v[148:149], v232 offset:9472
    ds_read_b64_tr_b16 v[150:151], v232 offset:14080
    s_waitcnt lgkmcnt(8)
    v_mfma_f32_32x32x16_bf16 v[0:15], v[156:159], v[172:175], v[0:15]
    ds_read_b64_tr_b16 v[152:153], v232 offset:9536
    ds_read_b64_tr_b16 v[154:155], v232 offset:14144
    s_waitcnt lgkmcnt(8)
    v_mfma_f32_32x32x16_bf16 v[16:31], v[160:163], v[172:175], v[16:31]
    ds_read_b64_tr_b16 v[156:157], v232 offset:9600
    ds_read_b64_tr_b16 v[158:159], v232 offset:14208
    s_waitcnt lgkmcnt(8)
    v_mfma_f32_32x32x16_bf16 v[32:47], v[164:167], v[172:175], v[32:47]
    ds_read_b64_tr_b16 v[160:161], v232 offset:9664
    ds_read_b64_tr_b16 v[162:163], v232 offset:14272
    s_waitcnt lgkmcnt(8)
    v_mfma_f32_32x32x16_bf16 v[48:63], v[144:147], v[172:175], v[48:63]
    ds_read_b64_tr_b16 v[164:165], v232 offset:9728
    ds_read_b64_tr_b16 v[166:167], v232 offset:14336
    s_waitcnt lgkmcnt(8)
    v_mfma_f32_32x32x16_bf16 v[64:79], v[148:151], v[172:175], v[64:79]
    s_waitcnt vmcnt(9)
    s_barrier
    s_add_u32 s48, s46, 405504
    s_add_u32 m0, s40, 55296
    s_nop 0
    buffer_load_dwordx4 v236, s[20:23], s48 offen lds
    s_add_u32 m0, s41, 55296
    s_nop 0
    buffer_load_dwordx4 v237, s[24:27], s48 offen lds
    s_add_u32 m0, s42, 55296
    s_nop 0
    buffer_load_dwordx4 v238, s[28:31], s48 offen lds
    s_add_u32 m0, s43, 55296
    s_nop 0
    buffer_load_dwordx4 v239, s[32:35], s48 offen lds
    s_add_u32 m0, s44, 55296
    s_nop 0
    buffer_load_dwordx4 v240, s[36:39], s48 offen lds
    ds_read_b64_tr_b16 v[144:145], v233 offset:0
    ds_read_b64_tr_b16 v[146:147], v233 offset:4608
    s_waitcnt lgkmcnt(8)
    v_mfma_f32_32x32x16_bf16 v[80:95], v[152:155], v[172:175], v[80:95]
    ds_read_b64_tr_b16 v[148:149], v233 offset:64
    ds_read_b64_tr_b16 v[150:151], v233 offset:4672
    s_waitcnt lgkmcnt(8)
    v_mfma_f32_32x32x16_bf16 v[96:111], v[156:159], v[172:175], v[96:111]
    ds_read_b64_tr_b16 v[152:153], v233 offset:128
    ds_read_b64_tr_b16 v[154:155], v233 offset:4736
    s_waitcnt lgkmcnt(8)
    v_mfma_f32_32x32x16_bf16 v[112:127], v[160:163], v[172:175], v[112:127]
    ds_read_b64_tr_b16 v[156:157], v233 offset:192
    ds_read_b64_tr_b16 v[158:159], v233 offset:4800
    s_waitcnt lgkmcnt(8)
    v_mfma_f32_32x32x16_bf16 v[128:143], v[164:167], v[172:175], v[128:143]
    ds_read_b64_tr_b16 v[160:161], v233 offset:256
    ds_read_b64_tr_b16 v[162:163], v233 offset:4864
    s_waitcnt lgkmcnt(8)
    v_mfma_f32_32x32x16_bf16 v[0:15], v[144:147], v[176:179], v[0:15]
    s_add_u32 s49, s47, 32768
    buffer_load_dwordx4 v[168:171], v241, s[12:15], s49 offen offset:0
    buffer_load_dwordx4 v[172:175], v241, s[12:15], s49 offen offset:1024
    ds_read_b64_tr_b16 v[164:165], v233 offset:320
    ds_read_b64_tr_b16 v[166:167], v233 offset:4928
    s_waitcnt lgkmcnt(8)
    v_mfma_f32_32x32x16_bf16 v[16:31], v[148:151], v[176:179], v[16:31]
    ds_read_b64_tr_b16 v[144:145], v233 offset:384
    ds_read_b64_tr_b16 v[146:147], v233 offset:4992
    s_waitcnt lgkmcnt(8)
    v_mfma_f32_32x32x16_bf16 v[32:47], v[152:155], v[176:179], v[32:47]
    ds_read_b64_tr_b16 v[148:149], v233 offset:448
    ds_read_b64_tr_b16 v[150:151], v233 offset:5056
    s_waitcnt lgkmcnt(8)
    v_mfma_f32_32x32x16_bf16 v[48:63], v[156:159], v[176:179], v[48:63]
    ds_read_b64_tr_b16 v[152:153], v233 offset:512
    ds_read_b64_tr_b16 v[154:155], v233 offset:5120
    s_waitcnt lgkmcnt(8)
    v_mfma_f32_32x32x16_bf16 v[64:79], v[160:163], v[176:179], v[64:79]
    ds_read_b64_tr_b16 v[156:157], v233 offset:9216
    ds_read_b64_tr_b16 v[158:159], v233 offset:13824
    s_waitcnt lgkmcnt(8)
    v_mfma_f32_32x32x16_bf16 v[80:95], v[164:167], v[176:179], v[80:95]
    ds_read_b64_tr_b16 v[160:161], v233 offset:9280
    ds_read_b64_tr_b16 v[162:163], v233 offset:13888
    s_waitcnt lgkmcnt(8)
    v_mfma_f32_32x32x16_bf16 v[96:111], v[144:147], v[176:179], v[96:111]
    ds_read_b64_tr_b16 v[164:165], v233 offset:9344
    ds_read_b64_tr_b16 v[166:167], v233 offset:13952
    s_waitcnt lgkmcnt(8)
    v_mfma_f32_32x32x16_bf16 v[112:127], v[148:151], v[176:179], v[112:127]
    ds_read_b64_tr_b16 v[144:145], v233 offset:9408
    ds_read_b64_tr_b16 v[146:147], v233 offset:14016
    s_waitcnt lgkmcnt(8)
    v_mfma_f32_32x32x16_bf16 v[128:143], v[152:155], v[176:179], v[128:143]
    ds_read_b64_tr_b16 v[148:149], v233 offset:9472
    ds_read_b64_tr_b16 v[150:151], v233 offset:14080
    s_waitcnt lgkmcnt(8)
    v_mfma_f32_32x32x16_bf16 v[0:15], v[156:159], v[180:183], v[0:15]
    ds_read_b64_tr_b16 v[152:153], v233 offset:9536
    ds_read_b64_tr_b16 v[154:155], v233 offset:14144
    s_waitcnt lgkmcnt(8)
    v_mfma_f32_32x32x16_bf16 v[16:31], v[160:163], v[180:183], v[16:31]
    ds_read_b64_tr_b16 v[156:157], v233 offset:9600
    ds_read_b64_tr_b16 v[158:159], v233 offset:14208
    s_waitcnt lgkmcnt(8)
    v_mfma_f32_32x32x16_bf16 v[32:47], v[164:167], v[180:183], v[32:47]
    ds_read_b64_tr_b16 v[160:161], v233 offset:9664
    ds_read_b64_tr_b16 v[162:163], v233 offset:14272
    s_waitcnt lgkmcnt(8)
    v_mfma_f32_32x32x16_bf16 v[48:63], v[144:147], v[180:183], v[48:63]
    ds_read_b64_tr_b16 v[164:165], v233 offset:9728
    ds_read_b64_tr_b16 v[166:167], v233 offset:14336
    s_waitcnt lgkmcnt(8)
    v_mfma_f32_32x32x16_bf16 v[64:79], v[148:151], v[180:183], v[64:79]
    s_waitcnt vmcnt(9)
    s_barrier
    s_add_u32 s48, s46, 442368
    s_add_u32 m0, s40, 0
    s_nop 0
    buffer_load_dwordx4 v236, s[20:23], s48 offen lds
    s_add_u32 m0, s41, 0
    s_nop 0
    buffer_load_dwordx4 v237, s[24:27], s48 offen lds
    s_add_u32 m0, s42, 0
    s_nop 0
    buffer_load_dwordx4 v238, s[28:31], s48 offen lds
    s_add_u32 m0, s43, 0
    s_nop 0
    buffer_load_dwordx4 v239, s[32:35], s48 offen lds
    s_add_u32 m0, s44, 0
    s_nop 0
    buffer_load_dwordx4 v240, s[36:39], s48 offen lds
    ds_read_b64_tr_b16 v[144:145], v234 offset:0
    ds_read_b64_tr_b16 v[146:147], v234 offset:4608
    s_waitcnt lgkmcnt(8)
    v_mfma_f32_32x32x16_bf16 v[80:95], v[152:155], v[180:183], v[80:95]
    ds_read_b64_tr_b16 v[148:149], v234 offset:64
    ds_read_b64_tr_b16 v[150:151], v234 offset:4672
    s_waitcnt lgkmcnt(8)
    v_mfma_f32_32x32x16_bf16 v[96:111], v[156:159], v[180:183], v[96:111]
    ds_read_b64_tr_b16 v[152:153], v234 offset:128
    ds_read_b64_tr_b16 v[154:155], v234 offset:4736
    s_waitcnt lgkmcnt(8)
    v_mfma_f32_32x32x16_bf16 v[112:127], v[160:163], v[180:183], v[112:127]
    ds_read_b64_tr_b16 v[156:157], v234 offset:192
    ds_read_b64_tr_b16 v[158:159], v234 offset:4800
    s_waitcnt lgkmcnt(8)
    v_mfma_f32_32x32x16_bf16 v[128:143], v[164:167], v[180:183], v[128:143]
    ds_read_b64_tr_b16 v[160:161], v234 offset:256
    ds_read_b64_tr_b16 v[162:163], v234 offset:4864
    s_waitcnt lgkmcnt(8)
    v_mfma_f32_32x32x16_bf16 v[0:15], v[144:147], v[184:187], v[0:15]
    s_add_u32 s49, s47, 34816
    buffer_load_dwordx4 v[176:179], v241, s[12:15], s49 offen offset:0
    buffer_load_dwordx4 v[180:183], v241, s[12:15], s49 offen offset:1024
    ds_read_b64_tr_b16 v[164:165], v234 offset:320
    ds_read_b64_tr_b16 v[166:167], v234 offset:4928
    s_waitcnt lgkmcnt(8)
    v_mfma_f32_32x32x16_bf16 v[16:31], v[148:151], v[184:187], v[16:31]
    ds_read_b64_tr_b16 v[144:145], v234 offset:384
    ds_read_b64_tr_b16 v[146:147], v234 offset:4992
    s_waitcnt lgkmcnt(8)
    v_mfma_f32_32x32x16_bf16 v[32:47], v[152:155], v[184:187], v[32:47]
    ds_read_b64_tr_b16 v[148:149], v234 offset:448
    ds_read_b64_tr_b16 v[150:151], v234 offset:5056
    s_waitcnt lgkmcnt(8)
    v_mfma_f32_32x32x16_bf16 v[48:63], v[156:159], v[184:187], v[48:63]
    ds_read_b64_tr_b16 v[152:153], v234 offset:512
    ds_read_b64_tr_b16 v[154:155], v234 offset:5120
    s_waitcnt lgkmcnt(8)
    v_mfma_f32_32x32x16_bf16 v[64:79], v[160:163], v[184:187], v[64:79]
    ds_read_b64_tr_b16 v[156:157], v234 offset:9216
    ds_read_b64_tr_b16 v[158:159], v234 offset:13824
    s_waitcnt lgkmcnt(8)
    v_mfma_f32_32x32x16_bf16 v[80:95], v[164:167], v[184:187], v[80:95]
    ds_read_b64_tr_b16 v[160:161], v234 offset:9280
    ds_read_b64_tr_b16 v[162:163], v234 offset:13888
    s_waitcnt lgkmcnt(8)
    v_mfma_f32_32x32x16_bf16 v[96:111], v[144:147], v[184:187], v[96:111]
    ds_read_b64_tr_b16 v[164:165], v234 offset:9344
    ds_read_b64_tr_b16 v[166:167], v234 offset:13952
    s_waitcnt lgkmcnt(8)
    v_mfma_f32_32x32x16_bf16 v[112:127], v[148:151], v[184:187], v[112:127]
    ds_read_b64_tr_b16 v[144:145], v234 offset:9408
    ds_read_b64_tr_b16 v[146:147], v234 offset:14016
    s_waitcnt lgkmcnt(8)
    v_mfma_f32_32x32x16_bf16 v[128:143], v[152:155], v[184:187], v[128:143]
    ds_read_b64_tr_b16 v[148:149], v234 offset:9472
    ds_read_b64_tr_b16 v[150:151], v234 offset:14080
    s_waitcnt lgkmcnt(8)
    v_mfma_f32_32x32x16_bf16 v[0:15], v[156:159], v[188:191], v[0:15]
    ds_read_b64_tr_b16 v[152:153], v234 offset:9536
    ds_read_b64_tr_b16 v[154:155], v234 offset:14144
    s_waitcnt lgkmcnt(8)
    v_mfma_f32_32x32x16_bf16 v[16:31], v[160:163], v[188:191], v[16:31]
    ds_read_b64_tr_b16 v[156:157], v234 offset:9600
    ds_read_b64_tr_b16 v[158:159], v234 offset:14208
    s_waitcnt lgkmcnt(8)
    v_mfma_f32_32x32x16_bf16 v[32:47], v[164:167], v[188:191], v[32:47]
    ds_read_b64_tr_b16 v[160:161], v234 offset:9664
    ds_read_b64_tr_b16 v[162:163], v234 offset:14272
    s_waitcnt lgkmcnt(8)
    v_mfma_f32_32x32x16_bf16 v[48:63], v[144:147], v[188:191], v[48:63]
    ds_read_b64_tr_b16 v[164:165], v234 offset:9728
    ds_read_b64_tr_b16 v[166:167], v234 offset:14336
    s_waitcnt lgkmcnt(8)
    v_mfma_f32_32x32x16_bf16 v[64:79], v[148:151], v[188:191], v[64:79]
    s_waitcnt vmcnt(9)
    s_barrier
    s_add_u32 s48, s46, 479232
    s_add_u32 m0, s40, 18432
    s_nop 0
    buffer_load_dwordx4 v236, s[20:23], s48 offen lds
    s_add_u32 m0, s41, 18432
    s_nop 0
    buffer_load_dwordx4 v237, s[24:27], s48 offen lds
    s_add_u32 m0, s42, 18432
    s_nop 0
    buffer_load_dwordx4 v238, s[28:31], s48 offen lds
    s_add_u32 m0, s43, 18432
    s_nop 0
    buffer_load_dwordx4 v239, s[32:35], s48 offen lds
    s_add_u32 m0, s44, 18432
    s_nop 0
    buffer_load_dwordx4 v240, s[36:39], s48 offen lds
    ds_read_b64_tr_b16 v[144:145], v235 offset:0
    ds_read_b64_tr_b16 v[146:147], v235 offset:4608
    s_waitcnt lgkmcnt(8)
    v_mfma_f32_32x32x16_bf16 v[80:95], v[152:155], v[188:191], v[80:95]
    ds_read_b64_tr_b16 v[148:149], v235 offset:64
    ds_read_b64_tr_b16 v[150:151], v235 offset:4672
    s_waitcnt lgkmcnt(8)
    v_mfma_f32_32x32x16_bf16 v[96:111], v[156:159], v[188:191], v[96:111]
    ds_read_b64_tr_b16 v[152:153], v235 offset:128
    ds_read_b64_tr_b16 v[154:155], v235 offset:4736
    s_waitcnt lgkmcnt(8)
    v_mfma_f32_32x32x16_bf16 v[112:127], v[160:163], v[188:191], v[112:127]
    ds_read_b64_tr_b16 v[156:157], v235 offset:192
    ds_read_b64_tr_b16 v[158:159], v235 offset:4800
    s_waitcnt lgkmcnt(8)
    v_mfma_f32_32x32x16_bf16 v[128:143], v[164:167], v[188:191], v[128:143]
    ds_read_b64_tr_b16 v[160:161], v235 offset:256
    ds_read_b64_tr_b16 v[162:163], v235 offset:4864
    s_waitcnt lgkmcnt(8)
    v_mfma_f32_32x32x16_bf16 v[0:15], v[144:147], v[192:195], v[0:15]
    ds_read_b64_tr_b16 v[164:165], v235 offset:320
    ds_read_b64_tr_b16 v[166:167], v235 offset:4928
    s_waitcnt lgkmcnt(8)
    v_mfma_f32_32x32x16_bf16 v[16:31], v[148:151], v[192:195], v[16:31]
    ds_read_b64_tr_b16 v[144:145], v235 offset:384
    ds_read_b64_tr_b16 v[146:147], v235 offset:4992
    s_waitcnt lgkmcnt(8)
    v_mfma_f32_32x32x16_bf16 v[32:47], v[152:155], v[192:195], v[32:47]
    ds_read_b64_tr_b16 v[148:149], v235 offset:448
    ds_read_b64_tr_b16 v[150:151], v235 offset:5056
    s_waitcnt lgkmcnt(8)
    v_mfma_f32_32x32x16_bf16 v[48:63], v[156:159], v[192:195], v[48:63]
    ds_read_b64_tr_b16 v[152:153], v235 offset:512
    ds_read_b64_tr_b16 v[154:155], v235 offset:5120
    s_waitcnt lgkmcnt(8)
    v_mfma_f32_32x32x16_bf16 v[64:79], v[160:163], v[192:195], v[64:79]
    ds_read_b64_tr_b16 v[156:157], v235 offset:9216
    ds_read_b64_tr_b16 v[158:159], v235 offset:13824
    s_waitcnt lgkmcnt(8)
    v_mfma_f32_32x32x16_bf16 v[80:95], v[164:167], v[192:195], v[80:95]
    ds_read_b64_tr_b16 v[160:161], v235 offset:9280
    ds_read_b64_tr_b16 v[162:163], v235 offset:13888
    s_waitcnt lgkmcnt(8)
    v_mfma_f32_32x32x16_bf16 v[96:111], v[144:147], v[192:195], v[96:111]
    ds_read_b64_tr_b16 v[164:165], v235 offset:9344
    ds_read_b64_tr_b16 v[166:167], v235 offset:13952
    s_waitcnt lgkmcnt(8)
    v_mfma_f32_32x32x16_bf16 v[112:127], v[148:151], v[192:195], v[112:127]
    ds_read_b64_tr_b16 v[144:145], v235 offset:9408
    ds_read_b64_tr_b16 v[146:147], v235 offset:14016
    s_waitcnt lgkmcnt(8)
    v_mfma_f32_32x32x16_bf16 v[128:143], v[152:155], v[192:195], v[128:143]
    ds_read_b64_tr_b16 v[148:149], v235 offset:9472
    ds_read_b64_tr_b16 v[150:151], v235 offset:14080
    s_waitcnt lgkmcnt(8)
    v_mfma_f32_32x32x16_bf16 v[0:15], v[156:159], v[196:199], v[0:15]
    ds_read_b64_tr_b16 v[152:153], v235 offset:9536
    ds_read_b64_tr_b16 v[154:155], v235 offset:14144
    s_waitcnt lgkmcnt(8)
    v_mfma_f32_32x32x16_bf16 v[16:31], v[160:163], v[196:199], v[16:31]
    ds_read_b64_tr_b16 v[156:157], v235 offset:9600
    ds_read_b64_tr_b16 v[158:159], v235 offset:14208
    s_waitcnt lgkmcnt(8)
    v_mfma_f32_32x32x16_bf16 v[32:47], v[164:167], v[196:199], v[32:47]
    ds_read_b64_tr_b16 v[160:161], v235 offset:9664
    ds_read_b64_tr_b16 v[162:163], v235 offset:14272
    s_waitcnt lgkmcnt(8)
    v_mfma_f32_32x32x16_bf16 v[48:63], v[144:147], v[196:199], v[48:63]
    ds_read_b64_tr_b16 v[164:165], v235 offset:9728
    ds_read_b64_tr_b16 v[166:167], v235 offset:14336
    s_waitcnt lgkmcnt(8)
    v_mfma_f32_32x32x16_bf16 v[64:79], v[148:151], v[196:199], v[64:79]
    s_waitcnt vmcnt(7)
    s_barrier
    s_add_u32 s48, s46, 516096
    s_add_u32 m0, s40, 36864
    s_nop 0
    buffer_load_dwordx4 v236, s[20:23], s48 offen lds
    s_add_u32 m0, s41, 36864
    s_nop 0
    buffer_load_dwordx4 v237, s[24:27], s48 offen lds
    s_add_u32 m0, s42, 36864
    s_nop 0
    buffer_load_dwordx4 v238, s[28:31], s48 offen lds
    s_add_u32 m0, s43, 36864
    s_nop 0
    buffer_load_dwordx4 v239, s[32:35], s48 offen lds
    s_add_u32 m0, s44, 36864
    s_nop 0
    buffer_load_dwordx4 v240, s[36:39], s48 offen lds
    ds_read_b64_tr_b16 v[144:145], v232 offset:0
    ds_read_b64_tr_b16 v[146:147], v232 offset:4608
    s_waitcnt lgkmcnt(8)
    v_mfma_f32_32x32x16_bf16 v[80:95], v[152:155], v[196:199], v[80:95]
    ds_read_b64_tr_b16 v[148:149], v232 offset:64
    ds_read_b64_tr_b16 v[150:151], v232 offset:4672
    s_waitcnt lgkmcnt(8)
    v_mfma_f32_32x32x16_bf16 v[96:111], v[156:159], v[196:199], v[96:111]
    ds_read_b64_tr_b16 v[152:153], v232 offset:128
    ds_read_b64_tr_b16 v[154:155], v232 offset:4736
    s_waitcnt lgkmcnt(8)
    v_mfma_f32_32x32x16_bf16 v[112:127], v[160:163], v[196:199], v[112:127]
    ds_read_b64_tr_b16 v[156:157], v232 offset:192
    ds_read_b64_tr_b16 v[158:159], v232 offset:4800
    s_waitcnt lgkmcnt(8)
    v_mfma_f32_32x32x16_bf16 v[128:143], v[164:167], v[196:199], v[128:143]
    ds_read_b64_tr_b16 v[160:161], v232 offset:256
    ds_read_b64_tr_b16 v[162:163], v232 offset:4864
    s_waitcnt lgkmcnt(8)
    v_mfma_f32_32x32x16_bf16 v[0:15], v[144:147], v[200:203], v[0:15]
    ds_read_b64_tr_b16 v[164:165], v232 offset:320
    ds_read_b64_tr_b16 v[166:167], v232 offset:4928
    s_waitcnt lgkmcnt(8)
    v_mfma_f32_32x32x16_bf16 v[16:31], v[148:151], v[200:203], v[16:31]
    ds_read_b64_tr_b16 v[144:145], v232 offset:384
    ds_read_b64_tr_b16 v[146:147], v232 offset:4992
    s_waitcnt lgkmcnt(8)
    v_mfma_f32_32x32x16_bf16 v[32:47], v[152:155], v[200:203], v[32:47]
    ds_read_b64_tr_b16 v[148:149], v232 offset:448
    ds_read_b64_tr_b16 v[150:151], v232 offset:5056
    s_waitcnt lgkmcnt(8)
    v_mfma_f32_32x32x16_bf16 v[48:63], v[156:159], v[200:203], v[48:63]
    ds_read_b64_tr_b16 v[152:153], v232 offset:512
    ds_read_b64_tr_b16 v[154:155], v232 offset:5120
    s_waitcnt lgkmcnt(8)
    v_mfma_f32_32x32x16_bf16 v[64:79], v[160:163], v[200:203], v[64:79]
    ds_read_b64_tr_b16 v[156:157], v232 offset:9216
    ds_read_b64_tr_b16 v[158:159], v232 offset:13824
    s_waitcnt lgkmcnt(8)
    v_mfma_f32_32x32x16_bf16 v[80:95], v[164:167], v[200:203], v[80:95]
    ds_read_b64_tr_b16 v[160:161], v232 offset:9280
    ds_read_b64_tr_b16 v[162:163], v232 offset:13888
    s_waitcnt lgkmcnt(8)
    v_mfma_f32_32x32x16_bf16 v[96:111], v[144:147], v[200:203], v[96:111]
    ds_read_b64_tr_b16 v[164:165], v232 offset:9344
    ds_read_b64_tr_b16 v[166:167], v232 offset:13952
    s_waitcnt lgkmcnt(8)
    v_mfma_f32_32x32x16_bf16 v[112:127], v[148:151], v[200:203], v[112:127]
    ds_read_b64_tr_b16 v[144:145], v232 offset:9408
    ds_read_b64_tr_b16 v[146:147], v232 offset:14016
    s_waitcnt lgkmcnt(8)
    v_mfma_f32_32x32x16_bf16 v[128:143], v[152:155], v[200:203], v[128:143]
    ds_read_b64_tr_b16 v[148:149], v232 offset:9472
    ds_read_b64_tr_b16 v[150:151], v232 offset:14080
    s_waitcnt lgkmcnt(8)
    v_mfma_f32_32x32x16_bf16 v[0:15], v[156:159], v[204:207], v[0:15]
    ds_read_b64_tr_b16 v[152:153], v232 offset:9536
    ds_read_b64_tr_b16 v[154:155], v232 offset:14144
    s_waitcnt lgkmcnt(8)
    v_mfma_f32_32x32x16_bf16 v[16:31], v[160:163], v[204:207], v[16:31]
    ds_read_b64_tr_b16 v[156:157], v232 offset:9600
    ds_read_b64_tr_b16 v[158:159], v232 offset:14208
    s_waitcnt lgkmcnt(8)
    v_mfma_f32_32x32x16_bf16 v[32:47], v[164:167], v[204:207], v[32:47]
    ds_read_b64_tr_b16 v[160:161], v232 offset:9664
    ds_read_b64_tr_b16 v[162:163], v232 offset:14272
    s_waitcnt lgkmcnt(8)
    v_mfma_f32_32x32x16_bf16 v[48:63], v[144:147], v[204:207], v[48:63]
    ds_read_b64_tr_b16 v[164:165], v232 offset:9728
    ds_read_b64_tr_b16 v[166:167], v232 offset:14336
    s_waitcnt lgkmcnt(8)
    v_mfma_f32_32x32x16_bf16 v[64:79], v[148:151], v[204:207], v[64:79]
    s_waitcnt vmcnt(5)
    s_barrier
    s_add_u32 s48, s46, 552960
    s_add_u32 m0, s40, 55296
    s_nop 0
    buffer_load_dwordx4 v236, s[20:23], s48 offen lds
    s_add_u32 m0, s41, 55296
    s_nop 0
    buffer_load_dwordx4 v237, s[24:27], s48 offen lds
    s_add_u32 m0, s42, 55296
    s_nop 0
    buffer_load_dwordx4 v238, s[28:31], s48 offen lds
    s_add_u32 m0, s43, 55296
    s_nop 0
    buffer_load_dwordx4 v239, s[32:35], s48 offen lds
    s_add_u32 m0, s44, 55296
    s_nop 0
    buffer_load_dwordx4 v240, s[36:39], s48 offen lds
    ds_read_b64_tr_b16 v[144:145], v233 offset:0
    ds_read_b64_tr_b16 v[146:147], v233 offset:4608
    s_waitcnt lgkmcnt(8)
    v_mfma_f32_32x32x16_bf16 v[80:95], v[152:155], v[204:207], v[80:95]
    ds_read_b64_tr_b16 v[148:149], v233 offset:64
    ds_read_b64_tr_b16 v[150:151], v233 offset:4672
    s_waitcnt lgkmcnt(8)
    v_mfma_f32_32x32x16_bf16 v[96:111], v[156:159], v[204:207], v[96:111]
    ds_read_b64_tr_b16 v[152:153], v233 offset:128
    ds_read_b64_tr_b16 v[154:155], v233 offset:4736
    s_waitcnt lgkmcnt(8)
    v_mfma_f32_32x32x16_bf16 v[112:127], v[160:163], v[204:207], v[112:127]
    ds_read_b64_tr_b16 v[156:157], v233 offset:192
    ds_read_b64_tr_b16 v[158:159], v233 offset:4800
    s_waitcnt lgkmcnt(8)
    v_mfma_f32_32x32x16_bf16 v[128:143], v[164:167], v[204:207], v[128:143]
    ds_read_b64_tr_b16 v[160:161], v233 offset:256
    ds_read_b64_tr_b16 v[162:163], v233 offset:4864
    s_waitcnt lgkmcnt(8)
    v_mfma_f32_32x32x16_bf16 v[0:15], v[144:147], v[208:211], v[0:15]
    ds_read_b64_tr_b16 v[164:165], v233 offset:320
    ds_read_b64_tr_b16 v[166:167], v233 offset:4928
    s_waitcnt lgkmcnt(8)
    v_mfma_f32_32x32x16_bf16 v[16:31], v[148:151], v[208:211], v[16:31]
    ds_read_b64_tr_b16 v[144:145], v233 offset:384
    ds_read_b64_tr_b16 v[146:147], v233 offset:4992
    s_waitcnt lgkmcnt(8)
    v_mfma_f32_32x32x16_bf16 v[32:47], v[152:155], v[208:211], v[32:47]
    ds_read_b64_tr_b16 v[148:149], v233 offset:448
    ds_read_b64_tr_b16 v[150:151], v233 offset:5056
    s_waitcnt lgkmcnt(8)
    v_mfma_f32_32x32x16_bf16 v[48:63], v[156:159], v[208:211], v[48:63]
    ds_read_b64_tr_b16 v[152:153], v233 offset:512
    ds_read_b64_tr_b16 v[154:155], v233 offset:5120
    s_waitcnt lgkmcnt(8)
    v_mfma_f32_32x32x16_bf16 v[64:79], v[160:163], v[208:211], v[64:79]
    ds_read_b64_tr_b16 v[156:157], v233 offset:9216
    ds_read_b64_tr_b16 v[158:159], v233 offset:13824
    s_waitcnt lgkmcnt(8)
    v_mfma_f32_32x32x16_bf16 v[80:95], v[164:167], v[208:211], v[80:95]
    ds_read_b64_tr_b16 v[160:161], v233 offset:9280
    ds_read_b64_tr_b16 v[162:163], v233 offset:13888
    s_waitcnt lgkmcnt(8)
    v_mfma_f32_32x32x16_bf16 v[96:111], v[144:147], v[208:211], v[96:111]
    ds_read_b64_tr_b16 v[164:165], v233 offset:9344
    ds_read_b64_tr_b16 v[166:167], v233 offset:13952
    s_waitcnt lgkmcnt(8)
    v_mfma_f32_32x32x16_bf16 v[112:127], v[148:151], v[208:211], v[112:127]
    ds_read_b64_tr_b16 v[144:145], v233 offset:9408
    ds_read_b64_tr_b16 v[146:147], v233 offset:14016
    s_waitcnt lgkmcnt(8)
    v_mfma_f32_32x32x16_bf16 v[128:143], v[152:155], v[208:211], v[128:143]
    ds_read_b64_tr_b16 v[148:149], v233 offset:9472
    ds_read_b64_tr_b16 v[150:151], v233 offset:14080
    s_waitcnt lgkmcnt(8)
    v_mfma_f32_32x32x16_bf16 v[0:15], v[156:159], v[212:215], v[0:15]
    ds_read_b64_tr_b16 v[152:153], v233 offset:9536
    ds_read_b64_tr_b16 v[154:155], v233 offset:14144
    s_waitcnt lgkmcnt(8)
    v_mfma_f32_32x32x16_bf16 v[16:31], v[160:163], v[212:215], v[16:31]
    ds_read_b64_tr_b16 v[156:157], v233 offset:9600
    ds_read_b64_tr_b16 v[158:159], v233 offset:14208
    s_waitcnt lgkmcnt(8)
    v_mfma_f32_32x32x16_bf16 v[32:47], v[164:167], v[212:215], v[32:47]
    ds_read_b64_tr_b16 v[160:161], v233 offset:9664
    ds_read_b64_tr_b16 v[162:163], v233 offset:14272
    s_waitcnt lgkmcnt(8)
    v_mfma_f32_32x32x16_bf16 v[48:63], v[144:147], v[212:215], v[48:63]
    ds_read_b64_tr_b16 v[164:165], v233 offset:9728
    ds_read_b64_tr_b16 v[166:167], v233 offset:14336
    s_waitcnt lgkmcnt(8)
    v_mfma_f32_32x32x16_bf16 v[64:79], v[148:151], v[212:215], v[64:79]
    s_waitcnt vmcnt(5)
    s_barrier
    s_add_u32 s48, s46, 589824
    s_add_u32 m0, s40, 0
    s_nop 0
    buffer_load_dwordx4 v236, s[20:23], s48 offen lds
    s_add_u32 m0, s41, 0
    s_nop 0
    buffer_load_dwordx4 v237, s[24:27], s48 offen lds
    s_add_u32 m0, s42, 0
    s_nop 0
    buffer_load_dwordx4 v238, s[28:31], s48 offen lds
    s_add_u32 m0, s43, 0
    s_nop 0
    buffer_load_dwordx4 v239, s[32:35], s48 offen lds
    s_add_u32 m0, s44, 0
    s_nop 0
    buffer_load_dwordx4 v240, s[36:39], s48 offen lds
    ds_read_b64_tr_b16 v[144:145], v234 offset:0
    ds_read_b64_tr_b16 v[146:147], v234 offset:4608
    s_waitcnt lgkmcnt(8)
    v_mfma_f32_32x32x16_bf16 v[80:95], v[152:155], v[212:215], v[80:95]
    ds_read_b64_tr_b16 v[148:149], v234 offset:64
    ds_read_b64_tr_b16 v[150:151], v234 offset:4672
    s_waitcnt lgkmcnt(8)
    v_mfma_f32_32x32x16_bf16 v[96:111], v[156:159], v[212:215], v[96:111]
    ds_read_b64_tr_b16 v[152:153], v234 offset:128
    ds_read_b64_tr_b16 v[154:155], v234 offset:4736
    s_waitcnt lgkmcnt(8)
    v_mfma_f32_32x32x16_bf16 v[112:127], v[160:163], v[212:215], v[112:127]
    ds_read_b64_tr_b16 v[156:157], v234 offset:192
    ds_read_b64_tr_b16 v[158:159], v234 offset:4800
    s_waitcnt lgkmcnt(8)
    v_mfma_f32_32x32x16_bf16 v[128:143], v[164:167], v[212:215], v[128:143]
    ds_read_b64_tr_b16 v[160:161], v234 offset:256
    ds_read_b64_tr_b16 v[162:163], v234 offset:4864
    s_waitcnt lgkmcnt(8)
    v_mfma_f32_32x32x16_bf16 v[0:15], v[144:147], v[216:219], v[0:15]
    ds_read_b64_tr_b16 v[164:165], v234 offset:320
    ds_read_b64_tr_b16 v[166:167], v234 offset:4928
    s_waitcnt lgkmcnt(8)
    v_mfma_f32_32x32x16_bf16 v[16:31], v[148:151], v[216:219], v[16:31]
    ds_read_b64_tr_b16 v[144:145], v234 offset:384
    ds_read_b64_tr_b16 v[146:147], v234 offset:4992
    s_waitcnt lgkmcnt(8)
    v_mfma_f32_32x32x16_bf16 v[32:47], v[152:155], v[216:219], v[32:47]
    ds_read_b64_tr_b16 v[148:149], v234 offset:448
    ds_read_b64_tr_b16 v[150:151], v234 offset:5056
    s_waitcnt lgkmcnt(8)
    v_mfma_f32_32x32x16_bf16 v[48:63], v[156:159], v[216:219], v[48:63]
    ds_read_b64_tr_b16 v[152:153], v234 offset:512
    ds_read_b64_tr_b16 v[154:155], v234 offset:5120
    s_waitcnt lgkmcnt(8)
    v_mfma_f32_32x32x16_bf16 v[64:79], v[160:163], v[216:219], v[64:79]
    ds_read_b64_tr_b16 v[156:157], v234 offset:9216
    ds_read_b64_tr_b16 v[158:159], v234 offset:13824
    s_waitcnt lgkmcnt(8)
    v_mfma_f32_32x32x16_bf16 v[80:95], v[164:167], v[216:219], v[80:95]
    ds_read_b64_tr_b16 v[160:161], v234 offset:9280
    ds_read_b64_tr_b16 v[162:163], v234 offset:13888
    s_waitcnt lgkmcnt(8)
    v_mfma_f32_32x32x16_bf16 v[96:111], v[144:147], v[216:219], v[96:111]
    ds_read_b64_tr_b16 v[164:165], v234 offset:9344
    ds_read_b64_tr_b16 v[166:167], v234 offset:13952
    s_waitcnt lgkmcnt(8)
    v_mfma_f32_32x32x16_bf16 v[112:127], v[148:151], v[216:219], v[112:127]
    ds_read_b64_tr_b16 v[144:145], v234 offset:9408
    ds_read_b64_tr_b16 v[146:147], v234 offset:14016
    s_waitcnt lgkmcnt(8)
    v_mfma_f32_32x32x16_bf16 v[128:143], v[152:155], v[216:219], v[128:143]
    ds_read_b64_tr_b16 v[148:149], v234 offset:9472
    ds_read_b64_tr_b16 v[150:151], v234 offset:14080
    s_waitcnt lgkmcnt(8)
    v_mfma_f32_32x32x16_bf16 v[0:15], v[156:159], v[220:223], v[0:15]
    ds_read_b64_tr_b16 v[152:153], v234 offset:9536
    ds_read_b64_tr_b16 v[154:155], v234 offset:14144
    s_waitcnt lgkmcnt(8)
    v_mfma_f32_32x32x16_bf16 v[16:31], v[160:163], v[220:223], v[16:31]
    ds_read_b64_tr_b16 v[156:157], v234 offset:9600
    ds_read_b64_tr_b16 v[158:159], v234 offset:14208
    s_waitcnt lgkmcnt(8)
    v_mfma_f32_32x32x16_bf16 v[32:47], v[164:167], v[220:223], v[32:47]
    ds_read_b64_tr_b16 v[160:161], v234 offset:9664
    ds_read_b64_tr_b16 v[162:163], v234 offset:14272
    s_waitcnt lgkmcnt(8)
    v_mfma_f32_32x32x16_bf16 v[48:63], v[144:147], v[220:223], v[48:63]
    ds_read_b64_tr_b16 v[164:165], v234 offset:9728
    ds_read_b64_tr_b16 v[166:167], v234 offset:14336
    s_waitcnt lgkmcnt(8)
    v_mfma_f32_32x32x16_bf16 v[64:79], v[148:151], v[220:223], v[64:79]
    s_waitcnt vmcnt(5)
    s_barrier
    s_add_u32 s48, s46, 626688
    s_add_u32 m0, s40, 18432
    s_nop 0
    buffer_load_dwordx4 v236, s[20:23], s48 offen lds
    s_add_u32 m0, s41, 18432
    s_nop 0
    buffer_load_dwordx4 v237, s[24:27], s48 offen lds
    s_add_u32 m0, s42, 18432
    s_nop 0
    buffer_load_dwordx4 v238, s[28:31], s48 offen lds
    s_add_u32 m0, s43, 18432
    s_nop 0
    buffer_load_dwordx4 v239, s[32:35], s48 offen lds
    s_add_u32 m0, s44, 18432
    s_nop 0
    buffer_load_dwordx4 v240, s[36:39], s48 offen lds
    ds_read_b64_tr_b16 v[144:145], v235 offset:0
    ds_read_b64_tr_b16 v[146:147], v235 offset:4608
    s_waitcnt lgkmcnt(8)
    v_mfma_f32_32x32x16_bf16 v[80:95], v[152:155], v[220:223], v[80:95]
    ds_read_b64_tr_b16 v[148:149], v235 offset:64
    ds_read_b64_tr_b16 v[150:151], v235 offset:4672
    s_waitcnt lgkmcnt(8)
    v_mfma_f32_32x32x16_bf16 v[96:111], v[156:159], v[220:223], v[96:111]
    ds_read_b64_tr_b16 v[152:153], v235 offset:128
    ds_read_b64_tr_b16 v[154:155], v235 offset:4736
    s_waitcnt lgkmcnt(8)
    v_mfma_f32_32x32x16_bf16 v[112:127], v[160:163], v[220:223], v[112:127]
    ds_read_b64_tr_b16 v[156:157], v235 offset:192
    ds_read_b64_tr_b16 v[158:159], v235 offset:4800
    s_waitcnt lgkmcnt(8)
    v_mfma_f32_32x32x16_bf16 v[128:143], v[164:167], v[220:223], v[128:143]
    ds_read_b64_tr_b16 v[160:161], v235 offset:256
    ds_read_b64_tr_b16 v[162:163], v235 offset:4864
    s_waitcnt lgkmcnt(8)
    v_mfma_f32_32x32x16_bf16 v[0:15], v[144:147], v[224:227], v[0:15]
    ds_read_b64_tr_b16 v[164:165], v235 offset:320
    ds_read_b64_tr_b16 v[166:167], v235 offset:4928
    s_waitcnt lgkmcnt(8)
    v_mfma_f32_32x32x16_bf16 v[16:31], v[148:151], v[224:227], v[16:31]
    ds_read_b64_tr_b16 v[144:145], v235 offset:384
    ds_read_b64_tr_b16 v[146:147], v235 offset:4992
    s_waitcnt lgkmcnt(8)
    v_mfma_f32_32x32x16_bf16 v[32:47], v[152:155], v[224:227], v[32:47]
    ds_read_b64_tr_b16 v[148:149], v235 offset:448
    ds_read_b64_tr_b16 v[150:151], v235 offset:5056
    s_waitcnt lgkmcnt(8)
    v_mfma_f32_32x32x16_bf16 v[48:63], v[156:159], v[224:227], v[48:63]
    ds_read_b64_tr_b16 v[152:153], v235 offset:512
    ds_read_b64_tr_b16 v[154:155], v235 offset:5120
    s_waitcnt lgkmcnt(8)
    v_mfma_f32_32x32x16_bf16 v[64:79], v[160:163], v[224:227], v[64:79]
    ds_read_b64_tr_b16 v[156:157], v235 offset:9216
    ds_read_b64_tr_b16 v[158:159], v235 offset:13824
    s_waitcnt lgkmcnt(8)
    v_mfma_f32_32x32x16_bf16 v[80:95], v[164:167], v[224:227], v[80:95]
    ds_read_b64_tr_b16 v[160:161], v235 offset:9280
    ds_read_b64_tr_b16 v[162:163], v235 offset:13888
    s_waitcnt lgkmcnt(8)
    v_mfma_f32_32x32x16_bf16 v[96:111], v[144:147], v[224:227], v[96:111]
    ds_read_b64_tr_b16 v[164:165], v235 offset:9344
    ds_read_b64_tr_b16 v[166:167], v235 offset:13952
    s_waitcnt lgkmcnt(8)
    v_mfma_f32_32x32x16_bf16 v[112:127], v[148:151], v[224:227], v[112:127]
    ds_read_b64_tr_b16 v[144:145], v235 offset:9408
    ds_read_b64_tr_b16 v[146:147], v235 offset:14016
    s_waitcnt lgkmcnt(8)
    v_mfma_f32_32x32x16_bf16 v[128:143], v[152:155], v[224:227], v[128:143]
    ds_read_b64_tr_b16 v[148:149], v235 offset:9472
    ds_read_b64_tr_b16 v[150:151], v235 offset:14080
    s_waitcnt lgkmcnt(8)
    v_mfma_f32_32x32x16_bf16 v[0:15], v[156:159], v[228:231], v[0:15]
    ds_read_b64_tr_b16 v[152:153], v235 offset:9536
    ds_read_b64_tr_b16 v[154:155], v235 offset:14144
    s_waitcnt lgkmcnt(8)
    v_mfma_f32_32x32x16_bf16 v[16:31], v[160:163], v[228:231], v[16:31]
    ds_read_b64_tr_b16 v[156:157], v235 offset:9600
    ds_read_b64_tr_b16 v[158:159], v235 offset:14208
    s_waitcnt lgkmcnt(8)
    v_mfma_f32_32x32x16_bf16 v[32:47], v[164:167], v[228:231], v[32:47]
    ds_read_b64_tr_b16 v[160:161], v235 offset:9664
    ds_read_b64_tr_b16 v[162:163], v235 offset:14272
    s_waitcnt lgkmcnt(8)
    v_mfma_f32_32x32x16_bf16 v[48:63], v[144:147], v[228:231], v[48:63]
    ds_read_b64_tr_b16 v[164:165], v235 offset:9728
    ds_read_b64_tr_b16 v[166:167], v235 offset:14336
    s_waitcnt lgkmcnt(8)
    v_mfma_f32_32x32x16_bf16 v[64:79], v[148:151], v[228:231], v[64:79]
    s_waitcnt vmcnt(5)
    s_barrier
    ds_read_b64_tr_b16 v[144:145], v232 offset:0
    ds_read_b64_tr_b16 v[146:147], v232 offset:4608
    s_waitcnt lgkmcnt(8)
    v_mfma_f32_32x32x16_bf16 v[80:95], v[152:155], v[228:231], v[80:95]
    ds_read_b64_tr_b16 v[148:149], v232 offset:64
    ds_read_b64_tr_b16 v[150:151], v232 offset:4672
    s_waitcnt lgkmcnt(8)
    v_mfma_f32_32x32x16_bf16 v[96:111], v[156:159], v[228:231], v[96:111]
    ds_read_b64_tr_b16 v[152:153], v232 offset:128
    ds_read_b64_tr_b16 v[154:155], v232 offset:4736
    s_waitcnt lgkmcnt(8)
    v_mfma_f32_32x32x16_bf16 v[112:127], v[160:163], v[228:231], v[112:127]
    ds_read_b64_tr_b16 v[156:157], v232 offset:192
    ds_read_b64_tr_b16 v[158:159], v232 offset:4800
    s_waitcnt lgkmcnt(8)
    v_mfma_f32_32x32x16_bf16 v[128:143], v[164:167], v[228:231], v[128:143]
    ds_read_b64_tr_b16 v[160:161], v232 offset:256
    ds_read_b64_tr_b16 v[162:163], v232 offset:4864
    s_waitcnt lgkmcnt(8)
    v_mfma_f32_32x32x16_bf16 v[0:15], v[144:147], v[168:171], v[0:15]
    ds_read_b64_tr_b16 v[164:165], v232 offset:320
    ds_read_b64_tr_b16 v[166:167], v232 offset:4928
    s_waitcnt lgkmcnt(8)
    v_mfma_f32_32x32x16_bf16 v[16:31], v[148:151], v[168:171], v[16:31]
    ds_read_b64_tr_b16 v[144:145], v232 offset:384
    ds_read_b64_tr_b16 v[146:147], v232 offset:4992
    s_waitcnt lgkmcnt(8)
    v_mfma_f32_32x32x16_bf16 v[32:47], v[152:155], v[168:171], v[32:47]
    ds_read_b64_tr_b16 v[148:149], v232 offset:448
    ds_read_b64_tr_b16 v[150:151], v232 offset:5056
    s_waitcnt lgkmcnt(8)
    v_mfma_f32_32x32x16_bf16 v[48:63], v[156:159], v[168:171], v[48:63]
    ds_read_b64_tr_b16 v[152:153], v232 offset:512
    ds_read_b64_tr_b16 v[154:155], v232 offset:5120
    s_waitcnt lgkmcnt(8)
    v_mfma_f32_32x32x16_bf16 v[64:79], v[160:163], v[168:171], v[64:79]
    ds_read_b64_tr_b16 v[156:157], v232 offset:9216
    ds_read_b64_tr_b16 v[158:159], v232 offset:13824
    s_waitcnt lgkmcnt(8)
    v_mfma_f32_32x32x16_bf16 v[80:95], v[164:167], v[168:171], v[80:95]
    ds_read_b64_tr_b16 v[160:161], v232 offset:9280
    ds_read_b64_tr_b16 v[162:163], v232 offset:13888
    s_waitcnt lgkmcnt(8)
    v_mfma_f32_32x32x16_bf16 v[96:111], v[144:147], v[168:171], v[96:111]
    ds_read_b64_tr_b16 v[164:165], v232 offset:9344
    ds_read_b64_tr_b16 v[166:167], v232 offset:13952
    s_waitcnt lgkmcnt(8)
    v_mfma_f32_32x32x16_bf16 v[112:127], v[148:151], v[168:171], v[112:127]
    ds_read_b64_tr_b16 v[144:145], v232 offset:9408
    ds_read_b64_tr_b16 v[146:147], v232 offset:14016
    s_waitcnt lgkmcnt(8)
    v_mfma_f32_32x32x16_bf16 v[128:143], v[152:155], v[168:171], v[128:143]
    ds_read_b64_tr_b16 v[148:149], v232 offset:9472
    ds_read_b64_tr_b16 v[150:151], v232 offset:14080
    s_waitcnt lgkmcnt(8)
    v_mfma_f32_32x32x16_bf16 v[0:15], v[156:159], v[172:175], v[0:15]
    ds_read_b64_tr_b16 v[152:153], v232 offset:9536
    ds_read_b64_tr_b16 v[154:155], v232 offset:14144
    s_waitcnt lgkmcnt(8)
    v_mfma_f32_32x32x16_bf16 v[16:31], v[160:163], v[172:175], v[16:31]
    ds_read_b64_tr_b16 v[156:157], v232 offset:9600
    ds_read_b64_tr_b16 v[158:159], v232 offset:14208
    s_waitcnt lgkmcnt(8)
    v_mfma_f32_32x32x16_bf16 v[32:47], v[164:167], v[172:175], v[32:47]
    ds_read_b64_tr_b16 v[160:161], v232 offset:9664
    ds_read_b64_tr_b16 v[162:163], v232 offset:14272
    s_waitcnt lgkmcnt(8)
    v_mfma_f32_32x32x16_bf16 v[48:63], v[144:147], v[172:175], v[48:63]
    ds_read_b64_tr_b16 v[164:165], v232 offset:9728
    ds_read_b64_tr_b16 v[166:167], v232 offset:14336
    s_waitcnt lgkmcnt(8)
    v_mfma_f32_32x32x16_bf16 v[64:79], v[148:151], v[172:175], v[64:79]
    s_waitcnt vmcnt(0)
    s_barrier
    ds_read_b64_tr_b16 v[144:145], v233 offset:0
    ds_read_b64_tr_b16 v[146:147], v233 offset:4608
    s_waitcnt lgkmcnt(8)
    v_mfma_f32_32x32x16_bf16 v[80:95], v[152:155], v[172:175], v[80:95]
    ds_read_b64_tr_b16 v[148:149], v233 offset:64
    ds_read_b64_tr_b16 v[150:151], v233 offset:4672
    s_waitcnt lgkmcnt(8)
    v_mfma_f32_32x32x16_bf16 v[96:111], v[156:159], v[172:175], v[96:111]
    ds_read_b64_tr_b16 v[152:153], v233 offset:128
    ds_read_b64_tr_b16 v[154:155], v233 offset:4736
    s_waitcnt lgkmcnt(8)
    v_mfma_f32_32x32x16_bf16 v[112:127], v[160:163], v[172:175], v[112:127]
    ds_read_b64_tr_b16 v[156:157], v233 offset:192
    ds_read_b64_tr_b16 v[158:159], v233 offset:4800
    s_waitcnt lgkmcnt(8)
    v_mfma_f32_32x32x16_bf16 v[128:143], v[164:167], v[172:175], v[128:143]
    ds_read_b64_tr_b16 v[160:161], v233 offset:256
    ds_read_b64_tr_b16 v[162:163], v233 offset:4864
    s_waitcnt lgkmcnt(8)
    v_mfma_f32_32x32x16_bf16 v[0:15], v[144:147], v[176:179], v[0:15]
    ds_read_b64_tr_b16 v[164:165], v233 offset:320
    ds_read_b64_tr_b16 v[166:167], v233 offset:4928
    s_waitcnt lgkmcnt(8)
    v_mfma_f32_32x32x16_bf16 v[16:31], v[148:151], v[176:179], v[16:31]
    ds_read_b64_tr_b16 v[144:145], v233 offset:384
    ds_read_b64_tr_b16 v[146:147], v233 offset:4992
    s_waitcnt lgkmcnt(8)
    v_mfma_f32_32x32x16_bf16 v[32:47], v[152:155], v[176:179], v[32:47]
    ds_read_b64_tr_b16 v[148:149], v233 offset:448
    ds_read_b64_tr_b16 v[150:151], v233 offset:5056
    s_waitcnt lgkmcnt(8)
    v_mfma_f32_32x32x16_bf16 v[48:63], v[156:159], v[176:179], v[48:63]
    ds_read_b64_tr_b16 v[152:153], v233 offset:512
    ds_read_b64_tr_b16 v[154:155], v233 offset:5120
    s_waitcnt lgkmcnt(8)
    v_mfma_f32_32x32x16_bf16 v[64:79], v[160:163], v[176:179], v[64:79]
    ds_read_b64_tr_b16 v[156:157], v233 offset:9216
    ds_read_b64_tr_b16 v[158:159], v233 offset:13824
    s_waitcnt lgkmcnt(8)
    v_mfma_f32_32x32x16_bf16 v[80:95], v[164:167], v[176:179], v[80:95]
    ds_read_b64_tr_b16 v[160:161], v233 offset:9280
    ds_read_b64_tr_b16 v[162:163], v233 offset:13888
    s_waitcnt lgkmcnt(8)
    v_mfma_f32_32x32x16_bf16 v[96:111], v[144:147], v[176:179], v[96:111]
    ds_read_b64_tr_b16 v[164:165], v233 offset:9344
    ds_read_b64_tr_b16 v[166:167], v233 offset:13952
    s_waitcnt lgkmcnt(8)
    v_mfma_f32_32x32x16_bf16 v[112:127], v[148:151], v[176:179], v[112:127]
    ds_read_b64_tr_b16 v[144:145], v233 offset:9408
    ds_read_b64_tr_b16 v[146:147], v233 offset:14016
    s_waitcnt lgkmcnt(8)
    v_mfma_f32_32x32x16_bf16 v[128:143], v[152:155], v[176:179], v[128:143]
    ds_read_b64_tr_b16 v[148:149], v233 offset:9472
    ds_read_b64_tr_b16 v[150:151], v233 offset:14080
    s_waitcnt lgkmcnt(8)
    v_mfma_f32_32x32x16_bf16 v[0:15], v[156:159], v[180:183], v[0:15]
    ds_read_b64_tr_b16 v[152:153], v233 offset:9536
    ds_read_b64_tr_b16 v[154:155], v233 offset:14144
    s_waitcnt lgkmcnt(8)
    v_mfma_f32_32x32x16_bf16 v[16:31], v[160:163], v[180:183], v[16:31]
    ds_read_b64_tr_b16 v[156:157], v233 offset:9600
    ds_read_b64_tr_b16 v[158:159], v233 offset:14208
    s_waitcnt lgkmcnt(8)
    v_mfma_f32_32x32x16_bf16 v[32:47], v[164:167], v[180:183], v[32:47]
    ds_read_b64_tr_b16 v[160:161], v233 offset:9664
    ds_read_b64_tr_b16 v[162:163], v233 offset:14272
    s_waitcnt lgkmcnt(8)
    v_mfma_f32_32x32x16_bf16 v[48:63], v[144:147], v[180:183], v[48:63]
    ds_read_b64_tr_b16 v[164:165], v233 offset:9728
    ds_read_b64_tr_b16 v[166:167], v233 offset:14336
    s_waitcnt lgkmcnt(8)
    v_mfma_f32_32x32x16_bf16 v[64:79], v[148:151], v[180:183], v[64:79]
    s_waitcnt lgkmcnt(6)
    v_mfma_f32_32x32x16_bf16 v[80:95], v[152:155], v[180:183], v[80:95]
    s_waitcnt lgkmcnt(4)
    v_mfma_f32_32x32x16_bf16 v[96:111], v[156:159], v[180:183], v[96:111]
    s_waitcnt lgkmcnt(2)
    v_mfma_f32_32x32x16_bf16 v[112:127], v[160:163], v[180:183], v[112:127]
    s_waitcnt lgkmcnt(0)
    v_mfma_f32_32x32x16_bf16 v[128:143], v[164:167], v[180:183], v[128:143]
    s_nop 7
    s_nop 7
    v_cvt_pk_bf16_f32 v144, v0, v1
    v_cvt_pk_bf16_f32 v145, v2, v3
    v_cvt_pk_bf16_f32 v146, v4, v5
    v_cvt_pk_bf16_f32 v147, v6, v7
    v_cvt_pk_bf16_f32 v148, v8, v9
    v_cvt_pk_bf16_f32 v149, v10, v11
    v_cvt_pk_bf16_f32 v150, v12, v13
    v_cvt_pk_bf16_f32 v151, v14, v15
    s_add_u32 s50, s3, 0
    buffer_store_dwordx4 v[144:147], v241, s[16:19], s50 offen nt
    buffer_store_dwordx4 v[148:151], v241, s[16:19], s50 offen offset:1024 nt
    v_cvt_pk_bf16_f32 v152, v16, v17
    v_cvt_pk_bf16_f32 v153, v18, v19
    v_cvt_pk_bf16_f32 v154, v20, v21
    v_cvt_pk_bf16_f32 v155, v22, v23
    v_cvt_pk_bf16_f32 v156, v24, v25
    v_cvt_pk_bf16_f32 v157, v26, v27
    v_cvt_pk_bf16_f32 v158, v28, v29
    v_cvt_pk_bf16_f32 v159, v30, v31
    s_add_u32 s50, s3, 2048
    buffer_store_dwordx4 v[152:155], v241, s[16:19], s50 offen nt
    buffer_store_dwordx4 v[156:159], v241, s[16:19], s50 offen offset:1024 nt
    v_cvt_pk_bf16_f32 v160, v32, v33
    v_cvt_pk_bf16_f32 v161, v34, v35
    v_cvt_pk_bf16_f32 v162, v36, v37
    v_cvt_pk_bf16_f32 v163, v38, v39
    v_cvt_pk_bf16_f32 v164, v40, v41
    v_cvt_pk_bf16_f32 v165, v42, v43
    v_cvt_pk_bf16_f32 v166, v44, v45
    v_cvt_pk_bf16_f32 v167, v46, v47
    s_add_u32 s50, s3, 4096
    buffer_store_dwordx4 v[160:163], v241, s[16:19], s50 offen nt
    buffer_store_dwordx4 v[164:167], v241, s[16:19], s50 offen offset:1024 nt
    v_cvt_pk_bf16_f32 v144, v48, v49
    v_cvt_pk_bf16_f32 v145, v50, v51
    v_cvt_pk_bf16_f32 v146, v52, v53
    v_cvt_pk_bf16_f32 v147, v54, v55
    v_cvt_pk_bf16_f32 v148, v56, v57
    v_cvt_pk_bf16_f32 v149, v58, v59
    v_cvt_pk_bf16_f32 v150, v60, v61
    v_cvt_pk_bf16_f32 v151, v62, v63
    s_add_u32 s50, s3, 6144
    buffer_store_dwordx4 v[144:147], v241, s[16:19], s50 offen nt
    buffer_store_dwordx4 v[148:151], v241, s[16:19], s50 offen offset:1024 nt
    v_cvt_pk_bf16_f32 v152, v64, v65
    v_cvt_pk_bf16_f32 v153, v66, v67
    v_cvt_pk_bf16_f32 v154, v68, v69
    v_cvt_pk_bf16_f32 v155, v70, v71
    v_cvt_pk_bf16_f32 v156, v72, v73
    v_cvt_pk_bf16_f32 v157, v74, v75
    v_cvt_pk_bf16_f32 v158, v76, v77
    v_cvt_pk_bf16_f32 v159, v78, v79
    s_add_u32 s50, s3, 8192
    buffer_store_dwordx4 v[152:155], v241, s[16:19], s50 offen nt
    buffer_store_dwordx4 v[156:159], v241, s[16:19], s50 offen offset:1024 nt
    v_cvt_pk_bf16_f32 v160, v80, v81
    v_cvt_pk_bf16_f32 v161, v82, v83
    v_cvt_pk_bf16_f32 v162, v84, v85
    v_cvt_pk_bf16_f32 v163, v86, v87
    v_cvt_pk_bf16_f32 v164, v88, v89
    v_cvt_pk_bf16_f32 v165, v90, v91
    v_cvt_pk_bf16_f32 v166, v92, v93
    v_cvt_pk_bf16_f32 v167, v94, v95
    s_add_u32 s50, s3, 10240
    buffer_store_dwordx4 v[160:163], v241, s[16:19], s50 offen nt
    buffer_store_dwordx4 v[164:167], v241, s[16:19], s50 offen offset:1024 nt
    v_cvt_pk_bf16_f32 v144, v96, v97
    v_cvt_pk_bf16_f32 v145, v98, v99
    v_cvt_pk_bf16_f32 v146, v100, v101
    v_cvt_pk_bf16_f32 v147, v102, v103
    v_cvt_pk_bf16_f32 v148, v104, v105
    v_cvt_pk_bf16_f32 v149, v106, v107
    v_cvt_pk_bf16_f32 v150, v108, v109
    v_cvt_pk_bf16_f32 v151, v110, v111
    s_add_u32 s50, s3, 12288
    buffer_store_dwordx4 v[144:147], v241, s[16:19], s50 offen nt
    buffer_store_dwordx4 v[148:151], v241, s[16:19], s50 offen offset:1024 nt
    v_cvt_pk_bf16_f32 v152, v112, v113
    v_cvt_pk_bf16_f32 v153, v114, v115
    v_cvt_pk_bf16_f32 v154, v116, v117
    v_cvt_pk_bf16_f32 v155, v118, v119
    v_cvt_pk_bf16_f32 v156, v120, v121
    v_cvt_pk_bf16_f32 v157, v122, v123
    v_cvt_pk_bf16_f32 v158, v124, v125
    v_cvt_pk_bf16_f32 v159, v126, v127
    s_add_u32 s50, s3, 14336
    buffer_store_dwordx4 v[152:155], v241, s[16:19], s50 offen nt
    buffer_store_dwordx4 v[156:159], v241, s[16:19], s50 offen offset:1024 nt
    v_cvt_pk_bf16_f32 v160, v128, v129
    v_cvt_pk_bf16_f32 v161, v130, v131
    v_cvt_pk_bf16_f32 v162, v132, v133
    v_cvt_pk_bf16_f32 v163, v134, v135
    v_cvt_pk_bf16_f32 v164, v136, v137
    v_cvt_pk_bf16_f32 v165, v138, v139
    v_cvt_pk_bf16_f32 v166, v140, v141
    v_cvt_pk_bf16_f32 v167, v142, v143
    s_add_u32 s50, s3, 16384
    buffer_store_dwordx4 v[160:163], v241, s[16:19], s50 offen nt
    buffer_store_dwordx4 v[164:167], v241, s[16:19], s50 offen offset:1024 nt
    s_waitcnt vmcnt(0)
    s_waitcnt vmcnt(0)
    s_endpgm
Lg2_a2:
    s_load_dwordx2 s[6:7], s[0:1], 72
    v_lshrrev_b32 v1, 6, v0
    v_and_b32 v0, 63, v0
    s_sub_u32 s21, s2, 256
    v_readfirstlane_b32 s20, v1
    v_lshrrev_b32 v2, 5, v0
    v_and_b32 v3, 31, v0
    s_lshl_b32 s21, s21, 2
    s_add_u32 s21, s21, s20
    s_lshl_b32 s24, s21, 13
    s_add_u32 s25, s24, 4096
    s_cmp_eq_u32 s21, 288
    s_cselect_b32 s24, 4096, s24
    s_cselect_b32 s25, 0, s25
    s_cselect_b32 s26, 0x40000000, 0
    s_cmp_eq_u32 s21, 0
    s_cselect_b32 s26, 0x40000000, s26
    v_lshlrev_b32 v4, 6, v3
    v_lshl_add_u32 v4, v2, 4, v4
    v_lshlrev_b32 v5, 4, v0
    v_add_u32 v6, s26, v4
    s_waitcnt lgkmcnt(0)
    s_add_u32 s8, s6, 2359296
    s_addc_u32 s9, s7, 0
    s_mov_b32 s10, 2359296
    s_mov_b32 s11, 0x00020000
    s_add_u32 s12, s6, 10108928
    s_addc_u32 s13, s7, 0
    s_mov_b32 s14, 45056
    s_mov_b32 s15, 0x00020000
    s_add_u32 s16, s6, 7741440
    s_addc_u32 s17, s7, 0
    s_mov_b32 s18, 2367488
    s_mov_b32 s19, 0x00020000
    s_add_u32 s28, s6, 4718592
    s_addc_u32 s29, s7, 0
    s_mov_b32 s30, 2359296
    s_mov_b32 s31, 0x00020000
    s_mul_i32 s23, s20, 11264
    s_add_u32 m0, s23, 0
    s_add_u32 s22, s23, 0
    buffer_load_dwordx4 v5, s[12:15], s22 offen lds
    s_add_u32 m0, s23, 1024
    s_add_u32 s22, s23, 1024
    buffer_load_dwordx4 v5, s[12:15], s22 offen lds
    s_add_u32 m0, s23, 2048
    s_add_u32 s22, s23, 2048
    buffer_load_dwordx4 v5, s[12:15], s22 offen lds
    s_add_u32 m0, s23, 3072
    s_add_u32 s22, s23, 3072
    buffer_load_dwordx4 v5, s[12:15], s22 offen lds
    s_add_u32 m0, s23, 4096
    s_add_u32 s22, s23, 4096
    buffer_load_dwordx4 v5, s[12:15], s22 offen lds
    s_add_u32 m0, s23, 5120
    s_add_u32 s22, s23, 5120
    buffer_load_dwordx4 v5, s[12:15], s22 offen lds
    s_add_u32 m0, s23, 6144
    s_add_u32 s22, s23, 6144
    buffer_load_dwordx4 v5, s[12:15], s22 offen lds
    s_add_u32 m0, s23, 7168
    s_add_u32 s22, s23, 7168
    buffer_load_dwordx4 v5, s[12:15], s22 offen lds
    s_add_u32 m0, s23, 8192
    s_add_u32 s22, s23, 8192
    buffer_load_dwordx4 v5, s[12:15], s22 offen lds
    s_add_u32 m0, s23, 9216
    s_add_u32 s22, s23, 9216
    buffer_load_dwordx4 v5, s[12:15], s22 offen lds
    s_add_u32 m0, s23, 10240
    s_add_u32 s22, s23, 10240
    buffer_load_dwordx4 v5, s[12:15], s22 offen lds
    s_cmp_ge_u32 s21, 289
    s_cbranch_scc1 La2_skip
    buffer_load_dwordx4 v[8:11], v4, s[8:11], s24 offen offset:0
    buffer_load_dwordx4 v[12:15], v4, s[8:11], s24 offen offset:32
    buffer_load_dwordx4 v[16:19], v4, s[8:11], s24 offen offset:2048
    buffer_load_dwordx4 v[20:23], v4, s[8:11], s24 offen offset:2080
    buffer_load_dwordx4 v[24:27], v6, s[8:11], s25 offen offset:0
    buffer_load_dwordx4 v[28:31], v6, s[8:11], s25 offen offset:32
    buffer_load_dwordx4 v[32:35], v6, s[8:11], s25 offen offset:2048
    buffer_load_dwordx4 v[36:39], v6, s[8:11], s25 offen offset:2080
    s_lshl_b32 s23, s21, 13
    s_add_u32 s22, s23, 0
    buffer_load_dwordx4 v[40:43], v5, s[16:19], s22 offen offset:0
    buffer_load_dwordx4 v[44:47], v5, s[16:19], s22 offen offset:1024
    buffer_load_dwordx4 v[48:51], v5, s[16:19], s22 offen offset:2048
    buffer_load_dwordx4 v[52:55], v5, s[16:19], s22 offen offset:3072
    s_add_u32 s22, s23, 4096
    buffer_load_dwordx4 v[56:59], v5, s[16:19], s22 offen offset:0
    buffer_load_dwordx4 v[60:63], v5, s[16:19], s22 offen offset:1024
    buffer_load_dwordx4 v[64:67], v5, s[16:19], s22 offen offset:2048
    buffer_load_dwordx4 v[68:71], v5, s[16:19], s22 offen offset:3072
    s_waitcnt vmcnt(16)
    s_barrier
    s_branch La2_go
La2_skip:
    s_waitcnt vmcnt(0)
    s_barrier
    s_endpgm
La2_go:
    ds_read_b128 v[184:187], v5 offset:0
    ds_read_b128 v[188:191], v5 offset:1024
    ds_read_b128 v[192:195], v5 offset:2048
    ds_read_b128 v[196:199], v5 offset:3072
    ds_read_b128 v[200:203], v5 offset:4096
    ds_read_b128 v[204:207], v5 offset:5120
    ds_read_b128 v[208:211], v5 offset:28672
    ds_read_b128 v[212:215], v5 offset:29696
    ds_read_b128 v[216:219], v5 offset:30720
    ds_read_b128 v[220:223], v5 offset:31744
    ds_read_b128 v[224:227], v5 offset:32768
    ds_read_b128 v[228:231], v5 offset:33792
    ds_read_b128 v[232:235], v5 offset:34816
    ds_read_b128 v[236:239], v5 offset:35840
    s_waitcnt vmcnt(8) lgkmcnt(8)
    v_mfma_f32_32x32x16_bf16 v[72:87], v[8:11], v[184:187], 0
    v_mfma_f32_32x32x16_bf16 v[72:87], v[12:15], v[188:191], v[72:87]
    v_mfma_f32_32x32x16_bf16 v[72:87], v[24:27], v[192:195], v[72:87]
    v_mfma_f32_32x32x16_bf16 v[72:87], v[28:31], v[196:199], v[72:87]
    v_mfma_f32_32x32x16_bf16 v[104:119], v[8:11], v[200:203], 0
    v_mfma_f32_32x32x16_bf16 v[104:119], v[12:15], v[204:207], v[104:119]
    v_mfma_f32_32x32x16_bf16 v[104:119], v[24:27], v[184:187], v[104:119]
    v_mfma_f32_32x32x16_bf16 v[104:119], v[28:31], v[188:191], v[104:119]
    v_mfma_f32_32x32x16_bf16 v[88:103], v[16:19], v[184:187], 0
    v_mfma_f32_32x32x16_bf16 v[88:103], v[20:23], v[188:191], v[88:103]
    v_mfma_f32_32x32x16_bf16 v[88:103], v[32:35], v[192:195], v[88:103]
    v_mfma_f32_32x32x16_bf16 v[88:103], v[36:39], v[196:199], v[88:103]
    v_mfma_f32_32x32x16_bf16 v[120:135], v[16:19], v[200:203], 0
    v_mfma_f32_32x32x16_bf16 v[120:135], v[20:23], v[204:207], v[120:135]
    v_mfma_f32_32x32x16_bf16 v[120:135], v[32:35], v[184:187], v[120:135]
    v_mfma_f32_32x32x16_bf16 v[120:135], v[36:39], v[188:191], v[120:135]
    ds_read_b128 v[8:11], v5 offset:36864
    ds_read_b128 v[12:15], v5 offset:37888
    ds_read_b128 v[16:19], v5 offset:38912
    ds_read_b128 v[20:23], v5 offset:39936
    ds_read_b128 v[24:27], v5 offset:40960
    ds_read_b128 v[28:31], v5 offset:41984
    ds_read_b128 v[32:35], v5 offset:43008
    ds_read_b128 v[36:39], v5 offset:44032
    s_nop 7
    s_waitcnt lgkmcnt(8)
    v_lshlrev_b32 v248, 16, v208
    v_lshlrev_b32 v249, 16, v209
    v_and_b32 v250, 0xffff0000, v208
    v_and_b32 v251, 0xffff0000, v209
    v_pk_mul_f32 v[252:253], v[72:73], v[248:249]
    v_pk_mul_f32 v[254:255], v[104:105], v[248:249]
    v_pk_fma_f32 v[252:253], v[104:105], v[250:251], v[252:253]
    v_pk_fma_f32 v[254:255], v[72:73], v[250:251], v[254:255] neg_lo:[1,0,0] neg_hi:[1,0,0]
    v_cvt_pk_bf16_f32 v136, v252, v253
    v_cvt_pk_bf16_f32 v152, v254, v255
    v_lshlrev_b32 v248, 16, v210
    v_lshlrev_b32 v249, 16, v211
    v_and_b32 v250, 0xffff0000, v210
    v_and_b32 v251, 0xffff0000, v211
    v_pk_mul_f32 v[252:253], v[74:75], v[248:249]
    v_pk_mul_f32 v[254:255], v[106:107], v[248:249]
    v_pk_fma_f32 v[252:253], v[106:107], v[250:251], v[252:253]
    v_pk_fma_f32 v[254:255], v[74:75], v[250:251], v[254:255] neg_lo:[1,0,0] neg_hi:[1,0,0]
    v_cvt_pk_bf16_f32 v137, v252, v253
    v_cvt_pk_bf16_f32 v153, v254, v255
    v_lshlrev_b32 v248, 16, v212
    v_lshlrev_b32 v249, 16, v213
    v_and_b32 v250, 0xffff0000, v212
    v_and_b32 v251, 0xffff0000, v213
    v_pk_mul_f32 v[252:253], v[76:77], v[248:249]
    v_pk_mul_f32 v[254:255], v[108:109], v[248:249]
    v_pk_fma_f32 v[252:253], v[108:109], v[250:251], v[252:253]
    v_pk_fma_f32 v[254:255], v[76:77], v[250:251], v[254:255] neg_lo:[1,0,0] neg_hi:[1,0,0]
    v_cvt_pk_bf16_f32 v138, v252, v253
    v_cvt_pk_bf16_f32 v154, v254, v255
    v_lshlrev_b32 v248, 16, v214
    v_lshlrev_b32 v249, 16, v215
    v_and_b32 v250, 0xffff0000, v214
    v_and_b32 v251, 0xffff0000, v215
    v_pk_mul_f32 v[252:253], v[78:79], v[248:249]
    v_pk_mul_f32 v[254:255], v[110:111], v[248:249]
    v_pk_fma_f32 v[252:253], v[110:111], v[250:251], v[252:253]
    v_pk_fma_f32 v[254:255], v[78:79], v[250:251], v[254:255] neg_lo:[1,0,0] neg_hi:[1,0,0]
    v_cvt_pk_bf16_f32 v139, v252, v253
    v_cvt_pk_bf16_f32 v155, v254, v255
    v_lshlrev_b32 v248, 16, v216
    v_lshlrev_b32 v249, 16, v217
    v_and_b32 v250, 0xffff0000, v216
    v_and_b32 v251, 0xffff0000, v217
    v_pk_mul_f32 v[252:253], v[80:81], v[248:249]
    v_pk_mul_f32 v[254:255], v[112:113], v[248:249]
    v_pk_fma_f32 v[252:253], v[112:113], v[250:251], v[252:253]
    v_pk_fma_f32 v[254:255], v[80:81], v[250:251], v[254:255] neg_lo:[1,0,0] neg_hi:[1,0,0]
    v_cvt_pk_bf16_f32 v140, v252, v253
    v_cvt_pk_bf16_f32 v156, v254, v255
    v_lshlrev_b32 v248, 16, v218
    v_lshlrev_b32 v249, 16, v219
    v_and_b32 v250, 0xffff0000, v218
    v_and_b32 v251, 0xffff0000, v219
    v_pk_mul_f32 v[252:253], v[82:83], v[248:249]
    v_pk_mul_f32 v[254:255], v[114:115], v[248:249]
    v_pk_fma_f32 v[252:253], v[114:115], v[250:251], v[252:253]
    v_pk_fma_f32 v[254:255], v[82:83], v[250:251], v[254:255] neg_lo:[1,0,0] neg_hi:[1,0,0]
    v_cvt_pk_bf16_f32 v141, v252, v253
    v_cvt_pk_bf16_f32 v157, v254, v255
    v_lshlrev_b32 v248, 16, v220
    v_lshlrev_b32 v249, 16, v221
    v_and_b32 v250, 0xffff0000, v220
    v_and_b32 v251, 0xffff0000, v221
    v_pk_mul_f32 v[252:253], v[84:85], v[248:249]
    v_pk_mul_f32 v[254:255], v[116:117], v[248:249]
    v_pk_fma_f32 v[252:253], v[116:117], v[250:251], v[252:253]
    v_pk_fma_f32 v[254:255], v[84:85], v[250:251], v[254:255] neg_lo:[1,0,0] neg_hi:[1,0,0]
    v_cvt_pk_bf16_f32 v142, v252, v253
    v_cvt_pk_bf16_f32 v158, v254, v255
    v_lshlrev_b32 v248, 16, v222
    v_lshlrev_b32 v249, 16, v223
    v_and_b32 v250, 0xffff0000, v222
    v_and_b32 v251, 0xffff0000, v223
    v_pk_mul_f32 v[252:253], v[86:87], v[248:249]
    v_pk_mul_f32 v[254:255], v[118:119], v[248:249]
    v_pk_fma_f32 v[252:253], v[118:119], v[250:251], v[252:253]
    v_pk_fma_f32 v[254:255], v[86:87], v[250:251], v[254:255] neg_lo:[1,0,0] neg_hi:[1,0,0]
    v_cvt_pk_bf16_f32 v143, v252, v253
    v_cvt_pk_bf16_f32 v159, v254, v255
    v_lshlrev_b32 v248, 16, v224
    v_lshlrev_b32 v249, 16, v225
    v_and_b32 v250, 0xffff0000, v224
    v_and_b32 v251, 0xffff0000, v225
    v_pk_mul_f32 v[252:253], v[88:89], v[248:249]
    v_pk_mul_f32 v[254:255], v[120:121], v[248:249]
    v_pk_fma_f32 v[252:253], v[120:121], v[250:251], v[252:253]
    v_pk_fma_f32 v[254:255], v[88:89], v[250:251], v[254:255] neg_lo:[1,0,0] neg_hi:[1,0,0]
    v_cvt_pk_bf16_f32 v144, v252, v253
    v_cvt_pk_bf16_f32 v160, v254, v255
    v_lshlrev_b32 v248, 16, v226
    v_lshlrev_b32 v249, 16, v227
    v_and_b32 v250, 0xffff0000, v226
    v_and_b32 v251, 0xffff0000, v227
    v_pk_mul_f32 v[252:253], v[90:91], v[248:249]
    v_pk_mul_f32 v[254:255], v[122:123], v[248:249]
    v_pk_fma_f32 v[252:253], v[122:123], v[250:251], v[252:253]
    v_pk_fma_f32 v[254:255], v[90:91], v[250:251], v[254:255] neg_lo:[1,0,0] neg_hi:[1,0,0]
    v_cvt_pk_bf16_f32 v145, v252, v253
    v_cvt_pk_bf16_f32 v161, v254, v255
    v_lshlrev_b32 v248, 16, v228
    v_lshlrev_b32 v249, 16, v229
    v_and_b32 v250, 0xffff0000, v228
    v_and_b32 v251, 0xffff0000, v229
    v_pk_mul_f32 v[252:253], v[92:93], v[248:249]
    v_pk_mul_f32 v[254:255], v[124:125], v[248:249]
    v_pk_fma_f32 v[252:253], v[124:125], v[250:251], v[252:253]
    v_pk_fma_f32 v[254:255], v[92:93], v[250:251], v[254:255] neg_lo:[1,0,0] neg_hi:[1,0,0]
    v_cvt_pk_bf16_f32 v146, v252, v253
    v_cvt_pk_bf16_f32 v162, v254, v255
    v_lshlrev_b32 v248, 16, v230
    v_lshlrev_b32 v249, 16, v231
    v_and_b32 v250, 0xffff0000, v230
    v_and_b32 v251, 0xffff0000, v231
    v_pk_mul_f32 v[252:253], v[94:95], v[248:249]
    v_pk_mul_f32 v[254:255], v[126:127], v[248:249]
    v_pk_fma_f32 v[252:253], v[126:127], v[250:251], v[252:253]
    v_pk_fma_f32 v[254:255], v[94:95], v[250:251], v[254:255] neg_lo:[1,0,0] neg_hi:[1,0,0]
    v_cvt_pk_bf16_f32 v147, v252, v253
    v_cvt_pk_bf16_f32 v163, v254, v255
    v_lshlrev_b32 v248, 16, v232
    v_lshlrev_b32 v249, 16, v233
    v_and_b32 v250, 0xffff0000, v232
    v_and_b32 v251, 0xffff0000, v233
    v_pk_mul_f32 v[252:253], v[96:97], v[248:249]
    v_pk_mul_f32 v[254:255], v[128:129], v[248:249]
    v_pk_fma_f32 v[252:253], v[128:129], v[250:251], v[252:253]
    v_pk_fma_f32 v[254:255], v[96:97], v[250:251], v[254:255] neg_lo:[1,0,0] neg_hi:[1,0,0]
    v_cvt_pk_bf16_f32 v148, v252, v253
    v_cvt_pk_bf16_f32 v164, v254, v255
    v_lshlrev_b32 v248, 16, v234
    v_lshlrev_b32 v249, 16, v235
    v_and_b32 v250, 0xffff0000, v234
    v_and_b32 v251, 0xffff0000, v235
    v_pk_mul_f32 v[252:253], v[98:99], v[248:249]
    v_pk_mul_f32 v[254:255], v[130:131], v[248:249]
    v_pk_fma_f32 v[252:253], v[130:131], v[250:251], v[252:253]
    v_pk_fma_f32 v[254:255], v[98:99], v[250:251], v[254:255] neg_lo:[1,0,0] neg_hi:[1,0,0]
    v_cvt_pk_bf16_f32 v149, v252, v253
    v_cvt_pk_bf16_f32 v165, v254, v255
    v_lshlrev_b32 v248, 16, v236
    v_lshlrev_b32 v249, 16, v237
    v_and_b32 v250, 0xffff0000, v236
    v_and_b32 v251, 0xffff0000, v237
    v_pk_mul_f32 v[252:253], v[100:101], v[248:249]
    v_pk_mul_f32 v[254:255], v[132:133], v[248:249]
    v_pk_fma_f32 v[252:253], v[132:133], v[250:251], v[252:253]
    v_pk_fma_f32 v[254:255], v[100:101], v[250:251], v[254:255] neg_lo:[1,0,0] neg_hi:[1,0,0]
    v_cvt_pk_bf16_f32 v150, v252, v253
    v_cvt_pk_bf16_f32 v166, v254, v255
    v_lshlrev_b32 v248, 16, v238
    v_lshlrev_b32 v249, 16, v239
    v_and_b32 v250, 0xffff0000, v238
    v_and_b32 v251, 0xffff0000, v239
    v_pk_mul_f32 v[252:253], v[102:103], v[248:249]
    v_pk_mul_f32 v[254:255], v[134:135], v[248:249]
    v_pk_fma_f32 v[252:253], v[134:135], v[250:251], v[252:253]
    v_pk_fma_f32 v[254:255], v[102:103], v[250:251], v[254:255] neg_lo:[1,0,0] neg_hi:[1,0,0]
    v_cvt_pk_bf16_f32 v151, v252, v253
    v_cvt_pk_bf16_f32 v167, v254, v255
    v_xor_b32 v168, 0x80008000, v136
    v_xor_b32 v169, 0x80008000, v137
    v_xor_b32 v170, 0x80008000, v138
    v_xor_b32 v171, 0x80008000, v139
    v_xor_b32 v172, 0x80008000, v140
    v_xor_b32 v173, 0x80008000, v141
    v_xor_b32 v174, 0x80008000, v142
    v_xor_b32 v175, 0x80008000, v143
    v_xor_b32 v176, 0x80008000, v144
    v_xor_b32 v177, 0x80008000, v145
    v_xor_b32 v178, 0x80008000, v146
    v_xor_b32 v179, 0x80008000, v147
    v_xor_b32 v180, 0x80008000, v148
    v_xor_b32 v181, 0x80008000, v149
    v_xor_b32 v182, 0x80008000, v150
    v_xor_b32 v183, 0x80008000, v151
    ds_read_b128 v[184:187], v5 offset:12288
    ds_read_b128 v[188:191], v5 offset:13312
    ds_read_b128 v[192:195], v5 offset:14336
    ds_read_b128 v[196:199], v5 offset:15360
    ds_read_b128 v[200:203], v5 offset:16384
    ds_read_b128 v[204:207], v5 offset:17408
    ds_read_b128 v[208:211], v5 offset:18432
    ds_read_b128 v[212:215], v5 offset:19456
    ds_read_b128 v[216:219], v5 offset:20480
    ds_read_b128 v[220:223], v5 offset:21504
    ds_read_b128 v[224:227], v5 offset:22528
    ds_read_b128 v[228:231], v5 offset:23552
    ds_read_b128 v[232:235], v5 offset:24576
    ds_read_b128 v[236:239], v5 offset:25600
    ds_read_b128 v[240:243], v5 offset:26624
    ds_read_b128 v[244:247], v5 offset:27648
    s_waitcnt lgkmcnt(0)
    v_mfma_f32_32x32x16_bf16 v[72:87], v[184:187], v[136:139], 0
    v_mfma_f32_32x32x16_bf16 v[72:87], v[188:191], v[140:143], v[72:87]
    v_mfma_f32_32x32x16_bf16 v[72:87], v[192:195], v[144:147], v[72:87]
    v_mfma_f32_32x32x16_bf16 v[72:87], v[196:199], v[148:151], v[72:87]
    v_mfma_f32_32x32x16_bf16 v[72:87], v[216:219], v[152:155], v[72:87]
    v_mfma_f32_32x32x16_bf16 v[72:87], v[220:223], v[156:159], v[72:87]
    v_mfma_f32_32x32x16_bf16 v[72:87], v[224:227], v[160:163], v[72:87]
    v_mfma_f32_32x32x16_bf16 v[72:87], v[228:231], v[164:167], v[72:87]
    v_mfma_f32_32x32x16_bf16 v[104:119], v[184:187], v[152:155], 0
    v_mfma_f32_32x32x16_bf16 v[104:119], v[188:191], v[156:159], v[104:119]
    v_mfma_f32_32x32x16_bf16 v[104:119], v[192:195], v[160:163], v[104:119]
    v_mfma_f32_32x32x16_bf16 v[104:119], v[196:199], v[164:167], v[104:119]
    v_mfma_f32_32x32x16_bf16 v[104:119], v[216:219], v[168:171], v[104:119]
    v_mfma_f32_32x32x16_bf16 v[104:119], v[220:223], v[172:175], v[104:119]
    v_mfma_f32_32x32x16_bf16 v[104:119], v[224:227], v[176:179], v[104:119]
    v_mfma_f32_32x32x16_bf16 v[104:119], v[228:231], v[180:183], v[104:119]
    v_mfma_f32_32x32x16_bf16 v[88:103], v[200:203], v[136:139], 0
    v_mfma_f32_32x32x16_bf16 v[88:103], v[204:207], v[140:143], v[88:103]
    v_mfma_f32_32x32x16_bf16 v[88:103], v[208:211], v[144:147], v[88:103]
    v_mfma_f32_32x32x16_bf16 v[88:103], v[212:215], v[148:151], v[88:103]
    v_mfma_f32_32x32x16_bf16 v[88:103], v[232:235], v[152:155], v[88:103]
    v_mfma_f32_32x32x16_bf16 v[88:103], v[236:239], v[156:159], v[88:103]
    v_mfma_f32_32x32x16_bf16 v[88:103], v[240:243], v[160:163], v[88:103]
    v_mfma_f32_32x32x16_bf16 v[88:103], v[244:247], v[164:167], v[88:103]
    v_mfma_f32_32x32x16_bf16 v[120:135], v[200:203], v[152:155], 0
    v_mfma_f32_32x32x16_bf16 v[120:135], v[204:207], v[156:159], v[120:135]
    v_mfma_f32_32x32x16_bf16 v[120:135], v[208:211], v[160:163], v[120:135]
    v_mfma_f32_32x32x16_bf16 v[120:135], v[212:215], v[164:167], v[120:135]
    v_mfma_f32_32x32x16_bf16 v[120:135], v[232:235], v[168:171], v[120:135]
    v_mfma_f32_32x32x16_bf16 v[120:135], v[236:239], v[172:175], v[120:135]
    v_mfma_f32_32x32x16_bf16 v[120:135], v[240:243], v[176:179], v[120:135]
    v_mfma_f32_32x32x16_bf16 v[120:135], v[244:247], v[180:183], v[120:135]
    s_nop 7
    s_nop 7
    s_waitcnt vmcnt(0)
    v_lshlrev_b32 v248, 16, v40
    v_lshlrev_b32 v249, 16, v41
    v_and_b32 v250, 0xffff0000, v40
    v_and_b32 v251, 0xffff0000, v41
    v_pk_mul_f32 v[252:253], v[72:73], v[248:249]
    v_pk_mul_f32 v[254:255], v[104:105], v[248:249]
    v_pk_fma_f32 v[252:253], v[104:105], v[250:251], v[252:253] neg_lo:[1,0,0] neg_hi:[1,0,0]
    v_pk_fma_f32 v[254:255], v[72:73], v[250:251], v[254:255]
    v_cvt_pk_bf16_f32 v136, v252, v253
    v_cvt_pk_bf16_f32 v152, v254, v255
    v_lshlrev_b32 v248, 16, v42
    v_lshlrev_b32 v249, 16, v43
    v_and_b32 v250, 0xffff0000, v42
    v_and_b32 v251, 0xffff0000, v43
    v_pk_mul_f32 v[252:253], v[74:75], v[248:249]
    v_pk_mul_f32 v[254:255], v[106:107], v[248:249]
    v_pk_fma_f32 v[252:253], v[106:107], v[250:251], v[252:253] neg_lo:[1,0,0] neg_hi:[1,0,0]
    v_pk_fma_f32 v[254:255], v[74:75], v[250:251], v[254:255]
    v_cvt_pk_bf16_f32 v137, v252, v253
    v_cvt_pk_bf16_f32 v153, v254, v255
    v_lshlrev_b32 v248, 16, v44
    v_lshlrev_b32 v249, 16, v45
    v_and_b32 v250, 0xffff0000, v44
    v_and_b32 v251, 0xffff0000, v45
    v_pk_mul_f32 v[252:253], v[76:77], v[248:249]
    v_pk_mul_f32 v[254:255], v[108:109], v[248:249]
    v_pk_fma_f32 v[252:253], v[108:109], v[250:251], v[252:253] neg_lo:[1,0,0] neg_hi:[1,0,0]
    v_pk_fma_f32 v[254:255], v[76:77], v[250:251], v[254:255]
    v_cvt_pk_bf16_f32 v138, v252, v253
    v_cvt_pk_bf16_f32 v154, v254, v255
    v_lshlrev_b32 v248, 16, v46
    v_lshlrev_b32 v249, 16, v47
    v_and_b32 v250, 0xffff0000, v46
    v_and_b32 v251, 0xffff0000, v47
    v_pk_mul_f32 v[252:253], v[78:79], v[248:249]
    v_pk_mul_f32 v[254:255], v[110:111], v[248:249]
    v_pk_fma_f32 v[252:253], v[110:111], v[250:251], v[252:253] neg_lo:[1,0,0] neg_hi:[1,0,0]
    v_pk_fma_f32 v[254:255], v[78:79], v[250:251], v[254:255]
    v_cvt_pk_bf16_f32 v139, v252, v253
    v_cvt_pk_bf16_f32 v155, v254, v255
    v_lshlrev_b32 v248, 16, v48
    v_lshlrev_b32 v249, 16, v49
    v_and_b32 v250, 0xffff0000, v48
    v_and_b32 v251, 0xffff0000, v49
    v_pk_mul_f32 v[252:253], v[80:81], v[248:249]
    v_pk_mul_f32 v[254:255], v[112:113], v[248:249]
    v_pk_fma_f32 v[252:253], v[112:113], v[250:251], v[252:253] neg_lo:[1,0,0] neg_hi:[1,0,0]
    v_pk_fma_f32 v[254:255], v[80:81], v[250:251], v[254:255]
    v_cvt_pk_bf16_f32 v140, v252, v253
    v_cvt_pk_bf16_f32 v156, v254, v255
    v_lshlrev_b32 v248, 16, v50
    v_lshlrev_b32 v249, 16, v51
    v_and_b32 v250, 0xffff0000, v50
    v_and_b32 v251, 0xffff0000, v51
    v_pk_mul_f32 v[252:253], v[82:83], v[248:249]
    v_pk_mul_f32 v[254:255], v[114:115], v[248:249]
    v_pk_fma_f32 v[252:253], v[114:115], v[250:251], v[252:253] neg_lo:[1,0,0] neg_hi:[1,0,0]
    v_pk_fma_f32 v[254:255], v[82:83], v[250:251], v[254:255]
    v_cvt_pk_bf16_f32 v141, v252, v253
    v_cvt_pk_bf16_f32 v157, v254, v255
    v_lshlrev_b32 v248, 16, v52
    v_lshlrev_b32 v249, 16, v53
    v_and_b32 v250, 0xffff0000, v52
    v_and_b32 v251, 0xffff0000, v53
    v_pk_mul_f32 v[252:253], v[84:85], v[248:249]
    v_pk_mul_f32 v[254:255], v[116:117], v[248:249]
    v_pk_fma_f32 v[252:253], v[116:117], v[250:251], v[252:253] neg_lo:[1,0,0] neg_hi:[1,0,0]
    v_pk_fma_f32 v[254:255], v[84:85], v[250:251], v[254:255]
    v_cvt_pk_bf16_f32 v142, v252, v253
    v_cvt_pk_bf16_f32 v158, v254, v255
    v_lshlrev_b32 v248, 16, v54
    v_lshlrev_b32 v249, 16, v55
    v_and_b32 v250, 0xffff0000, v54
    v_and_b32 v251, 0xffff0000, v55
    v_pk_mul_f32 v[252:253], v[86:87], v[248:249]
    v_pk_mul_f32 v[254:255], v[118:119], v[248:249]
    v_pk_fma_f32 v[252:253], v[118:119], v[250:251], v[252:253] neg_lo:[1,0,0] neg_hi:[1,0,0]
    v_pk_fma_f32 v[254:255], v[86:87], v[250:251], v[254:255]
    v_cvt_pk_bf16_f32 v143, v252, v253
    v_cvt_pk_bf16_f32 v159, v254, v255
    v_lshlrev_b32 v248, 16, v56
    v_lshlrev_b32 v249, 16, v57
    v_and_b32 v250, 0xffff0000, v56
    v_and_b32 v251, 0xffff0000, v57
    v_pk_mul_f32 v[252:253], v[88:89], v[248:249]
    v_pk_mul_f32 v[254:255], v[120:121], v[248:249]
    v_pk_fma_f32 v[252:253], v[120:121], v[250:251], v[252:253] neg_lo:[1,0,0] neg_hi:[1,0,0]
    v_pk_fma_f32 v[254:255], v[88:89], v[250:251], v[254:255]
    v_cvt_pk_bf16_f32 v144, v252, v253
    v_cvt_pk_bf16_f32 v160, v254, v255
    v_lshlrev_b32 v248, 16, v58
    v_lshlrev_b32 v249, 16, v59
    v_and_b32 v250, 0xffff0000, v58
    v_and_b32 v251, 0xffff0000, v59
    v_pk_mul_f32 v[252:253], v[90:91], v[248:249]
    v_pk_mul_f32 v[254:255], v[122:123], v[248:249]
    v_pk_fma_f32 v[252:253], v[122:123], v[250:251], v[252:253] neg_lo:[1,0,0] neg_hi:[1,0,0]
    v_pk_fma_f32 v[254:255], v[90:91], v[250:251], v[254:255]
    v_cvt_pk_bf16_f32 v145, v252, v253
    v_cvt_pk_bf16_f32 v161, v254, v255
    v_lshlrev_b32 v248, 16, v60
    v_lshlrev_b32 v249, 16, v61
    v_and_b32 v250, 0xffff0000, v60
    v_and_b32 v251, 0xffff0000, v61
    v_pk_mul_f32 v[252:253], v[92:93], v[248:249]
    v_pk_mul_f32 v[254:255], v[124:125], v[248:249]
    v_pk_fma_f32 v[252:253], v[124:125], v[250:251], v[252:253] neg_lo:[1,0,0] neg_hi:[1,0,0]
    v_pk_fma_f32 v[254:255], v[92:93], v[250:251], v[254:255]
    v_cvt_pk_bf16_f32 v146, v252, v253
    v_cvt_pk_bf16_f32 v162, v254, v255
    v_lshlrev_b32 v248, 16, v62
    v_lshlrev_b32 v249, 16, v63
    v_and_b32 v250, 0xffff0000, v62
    v_and_b32 v251, 0xffff0000, v63
    v_pk_mul_f32 v[252:253], v[94:95], v[248:249]
    v_pk_mul_f32 v[254:255], v[126:127], v[248:249]
    v_pk_fma_f32 v[252:253], v[126:127], v[250:251], v[252:253] neg_lo:[1,0,0] neg_hi:[1,0,0]
    v_pk_fma_f32 v[254:255], v[94:95], v[250:251], v[254:255]
    v_cvt_pk_bf16_f32 v147, v252, v253
    v_cvt_pk_bf16_f32 v163, v254, v255
    v_lshlrev_b32 v248, 16, v64
    v_lshlrev_b32 v249, 16, v65
    v_and_b32 v250, 0xffff0000, v64
    v_and_b32 v251, 0xffff0000, v65
    v_pk_mul_f32 v[252:253], v[96:97], v[248:249]
    v_pk_mul_f32 v[254:255], v[128:129], v[248:249]
    v_pk_fma_f32 v[252:253], v[128:129], v[250:251], v[252:253] neg_lo:[1,0,0] neg_hi:[1,0,0]
    v_pk_fma_f32 v[254:255], v[96:97], v[250:251], v[254:255]
    v_cvt_pk_bf16_f32 v148, v252, v253
    v_cvt_pk_bf16_f32 v164, v254, v255
    v_lshlrev_b32 v248, 16, v66
    v_lshlrev_b32 v249, 16, v67
    v_and_b32 v250, 0xffff0000, v66
    v_and_b32 v251, 0xffff0000, v67
    v_pk_mul_f32 v[252:253], v[98:99], v[248:249]
    v_pk_mul_f32 v[254:255], v[130:131], v[248:249]
    v_pk_fma_f32 v[252:253], v[130:131], v[250:251], v[252:253] neg_lo:[1,0,0] neg_hi:[1,0,0]
    v_pk_fma_f32 v[254:255], v[98:99], v[250:251], v[254:255]
    v_cvt_pk_bf16_f32 v149, v252, v253
    v_cvt_pk_bf16_f32 v165, v254, v255
    v_lshlrev_b32 v248, 16, v68
    v_lshlrev_b32 v249, 16, v69
    v_and_b32 v250, 0xffff0000, v68
    v_and_b32 v251, 0xffff0000, v69
    v_pk_mul_f32 v[252:253], v[100:101], v[248:249]
    v_pk_mul_f32 v[254:255], v[132:133], v[248:249]
    v_pk_fma_f32 v[252:253], v[132:133], v[250:251], v[252:253] neg_lo:[1,0,0] neg_hi:[1,0,0]
    v_pk_fma_f32 v[254:255], v[100:101], v[250:251], v[254:255]
    v_cvt_pk_bf16_f32 v150, v252, v253
    v_cvt_pk_bf16_f32 v166, v254, v255
    v_lshlrev_b32 v248, 16, v70
    v_lshlrev_b32 v249, 16, v71
    v_and_b32 v250, 0xffff0000, v70
    v_and_b32 v251, 0xffff0000, v71
    v_pk_mul_f32 v[252:253], v[102:103], v[248:249]
    v_pk_mul_f32 v[254:255], v[134:135], v[248:249]
    v_pk_fma_f32 v[252:253], v[134:135], v[250:251], v[252:253] neg_lo:[1,0,0] neg_hi:[1,0,0]
    v_pk_fma_f32 v[254:255], v[102:103], v[250:251], v[254:255]
    v_cvt_pk_bf16_f32 v151, v252, v253
    v_cvt_pk_bf16_f32 v167, v254, v255
    v_xor_b32 v168, 0x80008000, v152
    v_xor_b32 v169, 0x80008000, v153
    v_xor_b32 v170, 0x80008000, v154
    v_xor_b32 v171, 0x80008000, v155
    v_xor_b32 v172, 0x80008000, v156
    v_xor_b32 v173, 0x80008000, v157
    v_xor_b32 v174, 0x80008000, v158
    v_xor_b32 v175, 0x80008000, v159
    v_xor_b32 v176, 0x80008000, v160
    v_xor_b32 v177, 0x80008000, v161
    v_xor_b32 v178, 0x80008000, v162
    v_xor_b32 v179, 0x80008000, v163
    v_xor_b32 v180, 0x80008000, v164
    v_xor_b32 v181, 0x80008000, v165
    v_xor_b32 v182, 0x80008000, v166
    v_xor_b32 v183, 0x80008000, v167
    ds_read_b128 v[40:43], v5 offset:6144
    ds_read_b128 v[44:47], v5 offset:7168
    ds_read_b128 v[48:51], v5 offset:8192
    ds_read_b128 v[52:55], v5 offset:9216
    v_mfma_f32_32x32x16_bf16 v[72:87], v[136:139], v[184:187], 0
    v_mfma_f32_32x32x16_bf16 v[72:87], v[140:143], v[188:191], v[72:87]
    v_mfma_f32_32x32x16_bf16 v[72:87], v[144:147], v[192:195], v[72:87]
    v_mfma_f32_32x32x16_bf16 v[72:87], v[148:151], v[196:199], v[72:87]
    v_mfma_f32_32x32x16_bf16 v[72:87], v[168:171], v[216:219], v[72:87]
    v_mfma_f32_32x32x16_bf16 v[72:87], v[172:175], v[220:223], v[72:87]
    v_mfma_f32_32x32x16_bf16 v[72:87], v[176:179], v[224:227], v[72:87]
    v_mfma_f32_32x32x16_bf16 v[72:87], v[180:183], v[228:231], v[72:87]
    v_mfma_f32_32x32x16_bf16 v[104:119], v[136:139], v[216:219], 0
    v_mfma_f32_32x32x16_bf16 v[104:119], v[140:143], v[220:223], v[104:119]
    v_mfma_f32_32x32x16_bf16 v[104:119], v[144:147], v[224:227], v[104:119]
    v_mfma_f32_32x32x16_bf16 v[104:119], v[148:151], v[228:231], v[104:119]
    v_mfma_f32_32x32x16_bf16 v[104:119], v[152:155], v[184:187], v[104:119]
    v_mfma_f32_32x32x16_bf16 v[104:119], v[156:159], v[188:191], v[104:119]
    v_mfma_f32_32x32x16_bf16 v[104:119], v[160:163], v[192:195], v[104:119]
    v_mfma_f32_32x32x16_bf16 v[104:119], v[164:167], v[196:199], v[104:119]
    v_mfma_f32_32x32x16_bf16 v[88:103], v[136:139], v[200:203], 0
    v_mfma_f32_32x32x16_bf16 v[88:103], v[140:143], v[204:207], v[88:103]
    v_mfma_f32_32x32x16_bf16 v[88:103], v[144:147], v[208:211], v[88:103]
    v_mfma_f32_32x32x16_bf16 v[88:103], v[148:151], v[212:215], v[88:103]
    v_mfma_f32_32x32x16_bf16 v[88:103], v[168:171], v[232:235], v[88:103]
    v_mfma_f32_32x32x16_bf16 v[88:103], v[172:175], v[236:239], v[88:103]
    v_mfma_f32_32x32x16_bf16 v[88:103], v[176:179], v[240:243], v[88:103]
    v_mfma_f32_32x32x16_bf16 v[88:103], v[180:183], v[244:247], v[88:103]
    v_mfma_f32_32x32x16_bf16 v[120:135], v[136:139], v[232:235], 0
    v_mfma_f32_32x32x16_bf16 v[120:135], v[140:143], v[236:239], v[120:135]
    v_mfma_f32_32x32x16_bf16 v[120:135], v[144:147], v[240:243], v[120:135]
    v_mfma_f32_32x32x16_bf16 v[120:135], v[148:151], v[244:247], v[120:135]
    v_mfma_f32_32x32x16_bf16 v[120:135], v[152:155], v[200:203], v[120:135]
    v_mfma_f32_32x32x16_bf16 v[120:135], v[156:159], v[204:207], v[120:135]
    v_mfma_f32_32x32x16_bf16 v[120:135], v[160:163], v[208:211], v[120:135]
    v_mfma_f32_32x32x16_bf16 v[120:135], v[164:167], v[212:215], v[120:135]
    s_nop 7
    s_nop 7
    v_lshlrev_b32 v248, 16, v8
    v_lshlrev_b32 v249, 16, v9
    v_and_b32 v250, 0xffff0000, v8
    v_and_b32 v251, 0xffff0000, v9
    v_pk_mul_f32 v[252:253], v[72:73], v[248:249]
    v_pk_mul_f32 v[254:255], v[104:105], v[248:249]
    v_pk_fma_f32 v[252:253], v[104:105], v[250:251], v[252:253] neg_lo:[1,0,0] neg_hi:[1,0,0]
    v_pk_fma_f32 v[254:255], v[72:73], v[250:251], v[254:255]
    v_cvt_pk_bf16_f32 v136, v252, v253
    v_cvt_pk_bf16_f32 v152, v254, v255
    v_lshlrev_b32 v248, 16, v10
    v_lshlrev_b32 v249, 16, v11
    v_and_b32 v250, 0xffff0000, v10
    v_and_b32 v251, 0xffff0000, v11
    v_pk_mul_f32 v[252:253], v[74:75], v[248:249]
    v_pk_mul_f32 v[254:255], v[106:107], v[248:249]
    v_pk_fma_f32 v[252:253], v[106:107], v[250:251], v[252:253] neg_lo:[1,0,0] neg_hi:[1,0,0]
    v_pk_fma_f32 v[254:255], v[74:75], v[250:251], v[254:255]
    v_cvt_pk_bf16_f32 v137, v252, v253
    v_cvt_pk_bf16_f32 v153, v254, v255
    v_lshlrev_b32 v248, 16, v12
    v_lshlrev_b32 v249, 16, v13
    v_and_b32 v250, 0xffff0000, v12
    v_and_b32 v251, 0xffff0000, v13
    v_pk_mul_f32 v[252:253], v[76:77], v[248:249]
    v_pk_mul_f32 v[254:255], v[108:109], v[248:249]
    v_pk_fma_f32 v[252:253], v[108:109], v[250:251], v[252:253] neg_lo:[1,0,0] neg_hi:[1,0,0]
    v_pk_fma_f32 v[254:255], v[76:77], v[250:251], v[254:255]
    v_cvt_pk_bf16_f32 v138, v252, v253
    v_cvt_pk_bf16_f32 v154, v254, v255
    v_lshlrev_b32 v248, 16, v14
    v_lshlrev_b32 v249, 16, v15
    v_and_b32 v250, 0xffff0000, v14
    v_and_b32 v251, 0xffff0000, v15
    v_pk_mul_f32 v[252:253], v[78:79], v[248:249]
    v_pk_mul_f32 v[254:255], v[110:111], v[248:249]
    v_pk_fma_f32 v[252:253], v[110:111], v[250:251], v[252:253] neg_lo:[1,0,0] neg_hi:[1,0,0]
    v_pk_fma_f32 v[254:255], v[78:79], v[250:251], v[254:255]
    v_cvt_pk_bf16_f32 v139, v252, v253
    v_cvt_pk_bf16_f32 v155, v254, v255
    v_lshlrev_b32 v248, 16, v16
    v_lshlrev_b32 v249, 16, v17
    v_and_b32 v250, 0xffff0000, v16
    v_and_b32 v251, 0xffff0000, v17
    v_pk_mul_f32 v[252:253], v[80:81], v[248:249]
    v_pk_mul_f32 v[254:255], v[112:113], v[248:249]
    v_pk_fma_f32 v[252:253], v[112:113], v[250:251], v[252:253] neg_lo:[1,0,0] neg_hi:[1,0,0]
    v_pk_fma_f32 v[254:255], v[80:81], v[250:251], v[254:255]
    v_cvt_pk_bf16_f32 v140, v252, v253
    v_cvt_pk_bf16_f32 v156, v254, v255
    v_lshlrev_b32 v248, 16, v18
    v_lshlrev_b32 v249, 16, v19
    v_and_b32 v250, 0xffff0000, v18
    v_and_b32 v251, 0xffff0000, v19
    v_pk_mul_f32 v[252:253], v[82:83], v[248:249]
    v_pk_mul_f32 v[254:255], v[114:115], v[248:249]
    v_pk_fma_f32 v[252:253], v[114:115], v[250:251], v[252:253] neg_lo:[1,0,0] neg_hi:[1,0,0]
    v_pk_fma_f32 v[254:255], v[82:83], v[250:251], v[254:255]
    v_cvt_pk_bf16_f32 v141, v252, v253
    v_cvt_pk_bf16_f32 v157, v254, v255
    v_lshlrev_b32 v248, 16, v20
    v_lshlrev_b32 v249, 16, v21
    v_and_b32 v250, 0xffff0000, v20
    v_and_b32 v251, 0xffff0000, v21
    v_pk_mul_f32 v[252:253], v[84:85], v[248:249]
    v_pk_mul_f32 v[254:255], v[116:117], v[248:249]
    v_pk_fma_f32 v[252:253], v[116:117], v[250:251], v[252:253] neg_lo:[1,0,0] neg_hi:[1,0,0]
    v_pk_fma_f32 v[254:255], v[84:85], v[250:251], v[254:255]
    v_cvt_pk_bf16_f32 v142, v252, v253
    v_cvt_pk_bf16_f32 v158, v254, v255
    v_lshlrev_b32 v248, 16, v22
    v_lshlrev_b32 v249, 16, v23
    v_and_b32 v250, 0xffff0000, v22
    v_and_b32 v251, 0xffff0000, v23
    v_pk_mul_f32 v[252:253], v[86:87], v[248:249]
    v_pk_mul_f32 v[254:255], v[118:119], v[248:249]
    v_pk_fma_f32 v[252:253], v[118:119], v[250:251], v[252:253] neg_lo:[1,0,0] neg_hi:[1,0,0]
    v_pk_fma_f32 v[254:255], v[86:87], v[250:251], v[254:255]
    v_cvt_pk_bf16_f32 v143, v252, v253
    v_cvt_pk_bf16_f32 v159, v254, v255
    v_lshlrev_b32 v248, 16, v24
    v_lshlrev_b32 v249, 16, v25
    v_and_b32 v250, 0xffff0000, v24
    v_and_b32 v251, 0xffff0000, v25
    v_pk_mul_f32 v[252:253], v[88:89], v[248:249]
    v_pk_mul_f32 v[254:255], v[120:121], v[248:249]
    v_pk_fma_f32 v[252:253], v[120:121], v[250:251], v[252:253] neg_lo:[1,0,0] neg_hi:[1,0,0]
    v_pk_fma_f32 v[254:255], v[88:89], v[250:251], v[254:255]
    v_cvt_pk_bf16_f32 v144, v252, v253
    v_cvt_pk_bf16_f32 v160, v254, v255
    v_lshlrev_b32 v248, 16, v26
    v_lshlrev_b32 v249, 16, v27
    v_and_b32 v250, 0xffff0000, v26
    v_and_b32 v251, 0xffff0000, v27
    v_pk_mul_f32 v[252:253], v[90:91], v[248:249]
    v_pk_mul_f32 v[254:255], v[122:123], v[248:249]
    v_pk_fma_f32 v[252:253], v[122:123], v[250:251], v[252:253] neg_lo:[1,0,0] neg_hi:[1,0,0]
    v_pk_fma_f32 v[254:255], v[90:91], v[250:251], v[254:255]
    v_cvt_pk_bf16_f32 v145, v252, v253
    v_cvt_pk_bf16_f32 v161, v254, v255
    v_lshlrev_b32 v248, 16, v28
    v_lshlrev_b32 v249, 16, v29
    v_and_b32 v250, 0xffff0000, v28
    v_and_b32 v251, 0xffff0000, v29
    v_pk_mul_f32 v[252:253], v[92:93], v[248:249]
    v_pk_mul_f32 v[254:255], v[124:125], v[248:249]
    v_pk_fma_f32 v[252:253], v[124:125], v[250:251], v[252:253] neg_lo:[1,0,0] neg_hi:[1,0,0]
    v_pk_fma_f32 v[254:255], v[92:93], v[250:251], v[254:255]
    v_cvt_pk_bf16_f32 v146, v252, v253
    v_cvt_pk_bf16_f32 v162, v254, v255
    v_lshlrev_b32 v248, 16, v30
    v_lshlrev_b32 v249, 16, v31
    v_and_b32 v250, 0xffff0000, v30
    v_and_b32 v251, 0xffff0000, v31
    v_pk_mul_f32 v[252:253], v[94:95], v[248:249]
    v_pk_mul_f32 v[254:255], v[126:127], v[248:249]
    v_pk_fma_f32 v[252:253], v[126:127], v[250:251], v[252:253] neg_lo:[1,0,0] neg_hi:[1,0,0]
    v_pk_fma_f32 v[254:255], v[94:95], v[250:251], v[254:255]
    v_cvt_pk_bf16_f32 v147, v252, v253
    v_cvt_pk_bf16_f32 v163, v254, v255
    v_lshlrev_b32 v248, 16, v32
    v_lshlrev_b32 v249, 16, v33
    v_and_b32 v250, 0xffff0000, v32
    v_and_b32 v251, 0xffff0000, v33
    v_pk_mul_f32 v[252:253], v[96:97], v[248:249]
    v_pk_mul_f32 v[254:255], v[128:129], v[248:249]
    v_pk_fma_f32 v[252:253], v[128:129], v[250:251], v[252:253] neg_lo:[1,0,0] neg_hi:[1,0,0]
    v_pk_fma_f32 v[254:255], v[96:97], v[250:251], v[254:255]
    v_cvt_pk_bf16_f32 v148, v252, v253
    v_cvt_pk_bf16_f32 v164, v254, v255
    v_lshlrev_b32 v248, 16, v34
    v_lshlrev_b32 v249, 16, v35
    v_and_b32 v250, 0xffff0000, v34
    v_and_b32 v251, 0xffff0000, v35
    v_pk_mul_f32 v[252:253], v[98:99], v[248:249]
    v_pk_mul_f32 v[254:255], v[130:131], v[248:249]
    v_pk_fma_f32 v[252:253], v[130:131], v[250:251], v[252:253] neg_lo:[1,0,0] neg_hi:[1,0,0]
    v_pk_fma_f32 v[254:255], v[98:99], v[250:251], v[254:255]
    v_cvt_pk_bf16_f32 v149, v252, v253
    v_cvt_pk_bf16_f32 v165, v254, v255
    v_lshlrev_b32 v248, 16, v36
    v_lshlrev_b32 v249, 16, v37
    v_and_b32 v250, 0xffff0000, v36
    v_and_b32 v251, 0xffff0000, v37
    v_pk_mul_f32 v[252:253], v[100:101], v[248:249]
    v_pk_mul_f32 v[254:255], v[132:133], v[248:249]
    v_pk_fma_f32 v[252:253], v[132:133], v[250:251], v[252:253] neg_lo:[1,0,0] neg_hi:[1,0,0]
    v_pk_fma_f32 v[254:255], v[100:101], v[250:251], v[254:255]
    v_cvt_pk_bf16_f32 v150, v252, v253
    v_cvt_pk_bf16_f32 v166, v254, v255
    v_lshlrev_b32 v248, 16, v38
    v_lshlrev_b32 v249, 16, v39
    v_and_b32 v250, 0xffff0000, v38
    v_and_b32 v251, 0xffff0000, v39
    v_pk_mul_f32 v[252:253], v[102:103], v[248:249]
    v_pk_mul_f32 v[254:255], v[134:135], v[248:249]
    v_pk_fma_f32 v[252:253], v[134:135], v[250:251], v[252:253] neg_lo:[1,0,0] neg_hi:[1,0,0]
    v_pk_fma_f32 v[254:255], v[102:103], v[250:251], v[254:255]
    v_cvt_pk_bf16_f32 v151, v252, v253
    v_cvt_pk_bf16_f32 v167, v254, v255
    v_xor_b32 v168, 0x80008000, v152
    v_xor_b32 v169, 0x80008000, v153
    v_xor_b32 v170, 0x80008000, v154
    v_xor_b32 v171, 0x80008000, v155
    v_xor_b32 v172, 0x80008000, v156
    v_xor_b32 v173, 0x80008000, v157
    v_xor_b32 v174, 0x80008000, v158
    v_xor_b32 v175, 0x80008000, v159
    v_xor_b32 v176, 0x80008000, v160
    v_xor_b32 v177, 0x80008000, v161
    v_xor_b32 v178, 0x80008000, v162
    v_xor_b32 v179, 0x80008000, v163
    v_xor_b32 v180, 0x80008000, v164
    v_xor_b32 v181, 0x80008000, v165
    v_xor_b32 v182, 0x80008000, v166
    v_xor_b32 v183, 0x80008000, v167
    s_waitcnt lgkmcnt(0)
    v_mfma_f32_32x32x16_bf16 v[72:87], v[40:43], v[136:139], 0
    v_mfma_f32_32x32x16_bf16 v[72:87], v[44:47], v[140:143], v[72:87]
    v_mfma_f32_32x32x16_bf16 v[72:87], v[48:51], v[168:171], v[72:87]
    v_mfma_f32_32x32x16_bf16 v[72:87], v[52:55], v[172:175], v[72:87]
    v_mfma_f32_32x32x16_bf16 v[104:119], v[48:51], v[136:139], 0
    v_mfma_f32_32x32x16_bf16 v[104:119], v[52:55], v[140:143], v[104:119]
    v_mfma_f32_32x32x16_bf16 v[104:119], v[40:43], v[152:155], v[104:119]
    v_mfma_f32_32x32x16_bf16 v[104:119], v[44:47], v[156:159], v[104:119]
    v_mfma_f32_32x32x16_bf16 v[88:103], v[40:43], v[144:147], 0
    v_mfma_f32_32x32x16_bf16 v[88:103], v[44:47], v[148:151], v[88:103]
    v_mfma_f32_32x32x16_bf16 v[88:103], v[48:51], v[176:179], v[88:103]
    v_mfma_f32_32x32x16_bf16 v[88:103], v[52:55], v[180:183], v[88:103]
    v_mfma_f32_32x32x16_bf16 v[120:135], v[48:51], v[144:147], 0
    v_mfma_f32_32x32x16_bf16 v[120:135], v[52:55], v[148:151], v[120:135]
    v_mfma_f32_32x32x16_bf16 v[120:135], v[40:43], v[160:163], v[120:135]
    v_mfma_f32_32x32x16_bf16 v[120:135], v[44:47], v[164:167], v[120:135]
    v_lshlrev_b32 v4, 6, v3
    v_lshl_add_u32 v4, v2, 5, v4
    v_add_u32 v6, s26, v4
    s_nop 7
    s_nop 5
    v_cvt_pk_bf16_f32 v136, v72, v73
    v_cvt_pk_bf16_f32 v137, v74, v75
    v_cvt_pk_bf16_f32 v140, v76, v77
    v_cvt_pk_bf16_f32 v141, v78, v79
    v_cvt_pk_bf16_f32 v138, v80, v81
    v_cvt_pk_bf16_f32 v139, v82, v83
    v_cvt_pk_bf16_f32 v142, v84, v85
    v_cvt_pk_bf16_f32 v143, v86, v87
    s_nop 1
    v_permlane32_swap_b32 v136, v138
    v_permlane32_swap_b32 v137, v139
    v_permlane32_swap_b32 v140, v142
    v_permlane32_swap_b32 v141, v143
    buffer_store_dwordx4 v[136:139], v4, s[28:31], s24 offen offset:0
    buffer_store_dwordx4 v[140:143], v4, s[28:31], s24 offen offset:16
    v_cvt_pk_bf16_f32 v144, v88, v89
    v_cvt_pk_bf16_f32 v145, v90, v91
    v_cvt_pk_bf16_f32 v148, v92, v93
    v_cvt_pk_bf16_f32 v149, v94, v95
    v_cvt_pk_bf16_f32 v146, v96, v97
    v_cvt_pk_bf16_f32 v147, v98, v99
    v_cvt_pk_bf16_f32 v150, v100, v101
    v_cvt_pk_bf16_f32 v151, v102, v103
    s_nop 1
    v_permlane32_swap_b32 v144, v146
    v_permlane32_swap_b32 v145, v147
    v_permlane32_swap_b32 v148, v150
    v_permlane32_swap_b32 v149, v151
    buffer_store_dwordx4 v[144:147], v4, s[28:31], s24 offen offset:2048
    buffer_store_dwordx4 v[148:151], v4, s[28:31], s24 offen offset:2064
    v_cvt_pk_bf16_f32 v152, v104, v105
    v_cvt_pk_bf16_f32 v153, v106, v107
    v_cvt_pk_bf16_f32 v156, v108, v109
    v_cvt_pk_bf16_f32 v157, v110, v111
    v_cvt_pk_bf16_f32 v154, v112, v113
    v_cvt_pk_bf16_f32 v155, v114, v115
    v_cvt_pk_bf16_f32 v158, v116, v117
    v_cvt_pk_bf16_f32 v159, v118, v119
    s_nop 1
    v_permlane32_swap_b32 v152, v154
    v_permlane32_swap_b32 v153, v155
    v_permlane32_swap_b32 v156, v158
    v_permlane32_swap_b32 v157, v159
    buffer_store_dwordx4 v[152:155], v6, s[28:31], s25 offen offset:0
    buffer_store_dwordx4 v[156:159], v6, s[28:31], s25 offen offset:16
    v_cvt_pk_bf16_f32 v160, v120, v121
    v_cvt_pk_bf16_f32 v161, v122, v123
    v_cvt_pk_bf16_f32 v164, v124, v125
    v_cvt_pk_bf16_f32 v165, v126, v127
    v_cvt_pk_bf16_f32 v162, v128, v129
    v_cvt_pk_bf16_f32 v163, v130, v131
    v_cvt_pk_bf16_f32 v166, v132, v133
    v_cvt_pk_bf16_f32 v167, v134, v135
    s_nop 1
    v_permlane32_swap_b32 v160, v162
    v_permlane32_swap_b32 v161, v163
    v_permlane32_swap_b32 v164, v166
    v_permlane32_swap_b32 v165, v167
    buffer_store_dwordx4 v[160:163], v6, s[28:31], s25 offen offset:2048
    buffer_store_dwordx4 v[164:167], v6, s[28:31], s25 offen offset:2064
    s_waitcnt vmcnt(0)
    s_waitcnt vmcnt(0)
La2_end:
    s_endpgm
.globl fin_kernel
.p2align 8
.type fin_kernel,@function
fin_kernel:
    s_cmp_ge_u32 s2, 192
    s_cbranch_scc1 Lfin_end
    s_load_dwordx2 s[4:5], s[0:1], 0
    s_load_dwordx2 s[6:7], s[0:1], 72
    s_load_dwordx2 s[8:9], s[0:1], 56
    v_lshrrev_b32 v1, 6, v0
    v_and_b32 v0, 63, v0
    s_nop 0
    v_readfirstlane_b32 s20, v1
    v_lshrrev_b32 v2, 5, v0
    v_and_b32 v3, 31, v0
    s_and_b32 s21, s2, 31
    s_lshr_b32 s22, s2, 5
    s_lshl_b32 s24, s21, 1
    s_and_b32 s23, s20, 1
    s_add_u32 s24, s24, s23
    s_mul_i32 s25, s22, 3
    s_lshr_b32 s23, s20, 1
    s_add_u32 s25, s25, s23
    s_waitcnt lgkmcnt(0)
    s_add_u32 s12, s6, 4718592
    s_addc_u32 s13, s7, 0
    s_mov_b32 s14, 2359296
    s_mov_b32 s15, 0x00020000
    s_add_u32 s16, s6, 7077888
    s_addc_u32 s17, s7, 0
    s_mov_b32 s18, 663552
    s_mov_b32 s19, 0x00020000
    s_add_u32 s28, s6, 29028352
    s_addc_u32 s29, s7, 0
    s_mov_b32 s30, 18874368
    s_mov_b32 s31, 0x00020000
    s_mov_b32 s32, s4
    s_mov_b32 s33, s5
    s_mov_b32 s34, 2359296
    s_mov_b32 s35, 0x00020000
    s_mov_b32 s36, s8
    s_mov_b32 s37, s9
    s_mov_b32 s38, 2359296
    s_mov_b32 s39, 0x00020000
    v_lshlrev_b32 v5, 4, v0
    s_mul_i32 s23, s24, 18
    s_add_u32 s23, s23, s25
    s_lshl_b32 s23, s23, 11
    buffer_load_dwordx4 v[8:11], v5, s[28:31], s23 offen nt
    buffer_load_dwordx4 v[12:15], v5, s[28:31], s23 offen offset:1024 nt
    s_add_u32 s23, s23, 2359296
    buffer_load_dwordx4 v[16:19], v5, s[28:31], s23 offen nt
    buffer_load_dwordx4 v[20:23], v5, s[28:31], s23 offen offset:1024 nt
    s_add_u32 s23, s23, 2359296
    buffer_load_dwordx4 v[24:27], v5, s[28:31], s23 offen nt
    buffer_load_dwordx4 v[28:31], v5, s[28:31], s23 offen offset:1024 nt
    s_add_u32 s23, s23, 2359296
    buffer_load_dwordx4 v[32:35], v5, s[28:31], s23 offen nt
    buffer_load_dwordx4 v[36:39], v5, s[28:31], s23 offen offset:1024 nt
    s_add_u32 s23, s23, 2359296
    buffer_load_dwordx4 v[40:43], v5, s[28:31], s23 offen nt
    buffer_load_dwordx4 v[44:47], v5, s[28:31], s23 offen offset:1024 nt
    s_add_u32 s23, s23, 2359296
    buffer_load_dwordx4 v[48:51], v5, s[28:31], s23 offen nt
    buffer_load_dwordx4 v[52:55], v5, s[28:31], s23 offen offset:1024 nt
    s_add_u32 s23, s23, 2359296
    buffer_load_dwordx4 v[56:59], v5, s[28:31], s23 offen nt
    buffer_load_dwordx4 v[60:63], v5, s[28:31], s23 offen offset:1024 nt
    s_add_u32 s23, s23, 2359296
    buffer_load_dwordx4 v[64:67], v5, s[28:31], s23 offen nt
    buffer_load_dwordx4 v[68:71], v5, s[28:31], s23 offen offset:1024 nt
    v_lshlrev_b32 v6, 6, v3
    v_add_u32 v6, s24, v6
    v_mul_u32_u24 v6, 1152, v6
    v_lshl_add_u32 v6, v2, 5, v6
    s_lshl_b32 s26, s25, 6
    buffer_load_dwordx4 v[72:75], v6, s[32:35], s26 offen offset:0
    buffer_load_dwordx4 v[76:79], v6, s[32:35], s26 offen offset:16
    v_lshrrev_b32 v4, 3, v0
    v_lshlrev_b32 v4, 12, v4
    v_and_b32 v1, 7, v0
    v_lshl_add_u32 v4, v1, 4, v4
    s_lshl_b32 s21, s21, 7
    s_mul_i32 s22, s20, 393216
    s_add_u32 s21, s21, s22
    s_mul_i32 s22, s20, 12288
    s_add_u32 m0, s22, 0
    s_add_u32 s23, s21, 0
    buffer_load_dwordx4 v4, s[12:15], s23 offen lds
    s_add_u32 m0, s22, 1024
    s_add_u32 s23, s21, 32768
    buffer_load_dwordx4 v4, s[12:15], s23 offen lds
    s_add_u32 m0, s22, 2048
    s_add_u32 s23, s21, 65536
    buffer_load_dwordx4 v4, s[12:15], s23 offen lds
    s_add_u32 m0, s22, 3072
    s_add_u32 s23, s21, 98304
    buffer_load_dwordx4 v4, s[12:15], s23 offen lds
    s_add_u32 m0, s22, 4096
    s_add_u32 s23, s21, 131072
    buffer_load_dwordx4 v4, s[12:15], s23 offen lds
    s_add_u32 m0, s22, 5120
    s_add_u32 s23, s21, 163840
    buffer_load_dwordx4 v4, s[12:15], s23 offen lds
    s_add_u32 m0, s22, 6144
    s_add_u32 s23, s21, 196608
    buffer_load_dwordx4 v4, s[12:15], s23 offen lds
    s_add_u32 m0, s22, 7168
    s_add_u32 s23, s21, 229376
    buffer_load_dwordx4 v4, s[12:15], s23 offen lds
    s_add_u32 m0, s22, 8192
    s_add_u32 s23, s21, 262144
    buffer_load_dwordx4 v4, s[12:15], s23 offen lds
    s_add_u32 m0, s22, 9216
    s_add_u32 s23, s21, 294912
    buffer_load_dwordx4 v4, s[12:15], s23 offen lds
    s_add_u32 m0, s22, 10240
    s_add_u32 s23, s21, 327680
    buffer_load_dwordx4 v4, s[12:15], s23 offen lds
    s_add_u32 m0, s22, 11264
    s_add_u32 s23, s21, 360448
    buffer_load_dwordx4 v4, s[12:15], s23 offen lds
    s_and_b32 s27, s20, 1
    s_lshl_b32 s21, s25, 1
    s_add_u32 s21, s21, s27
    s_mul_i32 s21, s21, 18432
    buffer_load_dwordx4 v[80:83], v5, s[16:19], s21 offen offset:0
    buffer_load_dwordx4 v[84:87], v5, s[16:19], s21 offen offset:1024
    buffer_load_dwordx4 v[88:91], v5, s[16:19], s21 offen offset:2048
    buffer_load_dwordx4 v[92:95], v5, s[16:19], s21 offen offset:3072
    s_add_u32 s21, s21, 4096
    buffer_load_dwordx4 v[96:99], v5, s[16:19], s21 offen offset:0
    buffer_load_dwordx4 v[100:103], v5, s[16:19], s21 offen offset:1024
    buffer_load_dwordx4 v[104:107], v5, s[16:19], s21 offen offset:2048
    buffer_load_dwordx4 v[108:111], v5, s[16:19], s21 offen offset:3072
    s_add_u32 s21, s21, 4096
    buffer_load_dwordx4 v[112:115], v5, s[16:19], s21 offen offset:0
    buffer_load_dwordx4 v[116:119], v5, s[16:19], s21 offen offset:1024
    buffer_load_dwordx4 v[120:123], v5, s[16:19], s21 offen offset:2048
    buffer_load_dwordx4 v[124:127], v5, s[16:19], s21 offen offset:3072
    s_add_u32 s21, s21, 4096
    buffer_load_dwordx4 v[128:131], v5, s[16:19], s21 offen offset:0
    buffer_load_dwordx4 v[132:135], v5, s[16:19], s21 offen offset:1024
    buffer_load_dwordx4 v[136:139], v5, s[16:19], s21 offen offset:2048
    buffer_load_dwordx4 v[140:143], v5, s[16:19], s21 offen offset:3072
    s_add_u32 s21, s21, 4096
    buffer_load_dwordx4 v[144:147], v5, s[16:19], s21 offen offset:0
    buffer_load_dwordx4 v[148:151], v5, s[16:19], s21 offen offset:1024
    v_bfe_u32 v7, v0, 2, 2
    v_lshl_add_u32 v7, v2, 3, v7
    v_lshlrev_b32 v7, 7, v7
    v_bfe_u32 v1, v0, 4, 1
    v_lshl_add_u32 v7, v1, 5, v7
    v_and_b32 v1, 3, v0
    v_lshl_add_u32 v7, v1, 3, v7
    s_mul_i32 s23, s27, 36864
    v_add_u32 v7, s23, v7
    s_lshl_b32 s23, s27, 6
    v_add_u32 v1, s23, v7
    s_xor_b32 s23, s23, 64
    v_add_u32 v7, s23, v7
    v_mov_b32 v2, 0x3f80
    v_mov_b32 v3, 0x3f800000
    s_mul_i32 s21, s20, 4096
    s_add_u32 s22, s21, 73728
    v_add_u32 v4, s22, v5
    s_xor_b32 s21, s20, 1
    s_mul_i32 s21, s21, 4096
    s_add_u32 s22, s21, 73728
    v_add_u32 v5, s22, v5
    s_waitcnt vmcnt(18)
    s_barrier
    ds_read_b64_tr_b16 v[184:185], v7 offset:0
    ds_read_b64_tr_b16 v[186:187], v7 offset:512
    ds_read_b64_tr_b16 v[188:189], v1 offset:0
    ds_read_b64_tr_b16 v[190:191], v1 offset:512
    ds_read_b64_tr_b16 v[192:193], v7 offset:2048
    ds_read_b64_tr_b16 v[194:195], v7 offset:2560
    ds_read_b64_tr_b16 v[196:197], v1 offset:2048
    ds_read_b64_tr_b16 v[198:199], v1 offset:2560
    ds_read_b64_tr_b16 v[200:201], v7 offset:4096
    ds_read_b64_tr_b16 v[202:203], v7 offset:4608
    ds_read_b64_tr_b16 v[204:205], v1 offset:4096
    ds_read_b64_tr_b16 v[206:207], v1 offset:4608
    s_waitcnt vmcnt(17) lgkmcnt(8)
    v_mfma_f32_32x32x16_bf16 v[168:183], v[80:83], v[184:187], 0
    v_mfma_f32_32x32x16_bf16 v[152:167], v[80:83], v[188:191], 0
    ds_read_b64_tr_b16 v[208:209], v7 offset:6144
    ds_read_b64_tr_b16 v[210:211], v7 offset:6656
    ds_read_b64_tr_b16 v[212:213], v1 offset:6144
    ds_read_b64_tr_b16 v[214:215], v1 offset:6656
    s_waitcnt vmcnt(16) lgkmcnt(8)
    v_mfma_f32_32x32x16_bf16 v[168:183], v[84:87], v[192:195], v[168:183]
    v_mfma_f32_32x32x16_bf16 v[152:167], v[84:87], v[196:199], v[152:167]
    ds_read_b64_tr_b16 v[184:185], v7 offset:8192
    ds_read_b64_tr_b16 v[186:187], v7 offset:8704
    ds_read_b64_tr_b16 v[188:189], v1 offset:8192
    ds_read_b64_tr_b16 v[190:191], v1 offset:8704
    s_waitcnt vmcnt(15) lgkmcnt(8)
    v_mfma_f32_32x32x16_bf16 v[168:183], v[88:91], v[200:203], v[168:183]
    v_mfma_f32_32x32x16_bf16 v[152:167], v[88:91], v[204:207], v[152:167]
    ds_read_b64_tr_b16 v[192:193], v7 offset:10240
    ds_read_b64_tr_b16 v[194:195], v7 offset:10752
    ds_read_b64_tr_b16 v[196:197], v1 offset:10240
    ds_read_b64_tr_b16 v[198:199], v1 offset:10752
    s_waitcnt vmcnt(14) lgkmcnt(8)
    v_mfma_f32_32x32x16_bf16 v[168:183], v[92:95], v[208:211], v[168:183]
    v_mfma_f32_32x32x16_bf16 v[152:167], v[92:95], v[212:215], v[152:167]
    ds_read_b64_tr_b16 v[200:201], v7 offset:12288
    ds_read_b64_tr_b16 v[202:203], v7 offset:12800
    ds_read_b64_tr_b16 v[204:205], v1 offset:12288
    ds_read_b64_tr_b16 v[206:207], v1 offset:12800
    s_waitcnt vmcnt(13) lgkmcnt(8)
    v_mfma_f32_32x32x16_bf16 v[168:183], v[96:99], v[184:187], v[168:183]
    v_mfma_f32_32x32x16_bf16 v[152:167], v[96:99], v[188:191], v[152:167]
    ds_read_b64_tr_b16 v[208:209], v7 offset:14336
    ds_read_b64_tr_b16 v[210:211], v7 offset:14848
    ds_read_b64_tr_b16 v[212:213], v1 offset:14336
    ds_read_b64_tr_b16 v[214:215], v1 offset:14848
    s_waitcnt vmcnt(12) lgkmcnt(8)
    v_mfma_f32_32x32x16_bf16 v[168:183], v[100:103], v[192:195], v[168:183]
    v_mfma_f32_32x32x16_bf16 v[152:167], v[100:103], v[196:199], v[152:167]
    ds_read_b64_tr_b16 v[184:185], v7 offset:16384
    ds_read_b64_tr_b16 v[186:187], v7 offset:16896
    ds_read_b64_tr_b16 v[188:189], v1 offset:16384
    ds_read_b64_tr_b16 v[190:191], v1 offset:16896
    s_waitcnt vmcnt(11) lgkmcnt(8)
    v_mfma_f32_32x32x16_bf16 v[168:183], v[104:107], v[200:203], v[168:183]
    v_mfma_f32_32x32x16_bf16 v[152:167], v[104:107], v[204:207], v[152:167]
    ds_read_b64_tr_b16 v[192:193], v7 offset:18432
    ds_read_b64_tr_b16 v[194:195], v7 offset:18944
    ds_read_b64_tr_b16 v[196:197], v1 offset:18432
    ds_read_b64_tr_b16 v[198:199], v1 offset:18944
    s_waitcnt vmcnt(10) lgkmcnt(8)
    v_mfma_f32_32x32x16_bf16 v[168:183], v[108:111], v[208:211], v[168:183]
    v_mfma_f32_32x32x16_bf16 v[152:167], v[108:111], v[212:215], v[152:167]
    ds_read_b64_tr_b16 v[200:201], v7 offset:20480
    ds_read_b64_tr_b16 v[202:203], v7 offset:20992
    ds_read_b64_tr_b16 v[204:205], v1 offset:20480
    ds_read_b64_tr_b16 v[206:207], v1 offset:20992
    s_waitcnt vmcnt(9) lgkmcnt(8)
    v_mfma_f32_32x32x16_bf16 v[168:183], v[112:115], v[184:187], v[168:183]
    v_mfma_f32_32x32x16_bf16 v[152:167], v[112:115], v[188:191], v[152:167]
    ds_read_b64_tr_b16 v[208:209], v7 offset:22528
    ds_read_b64_tr_b16 v[210:211], v7 offset:23040
    ds_read_b64_tr_b16 v[212:213], v1 offset:22528
    ds_read_b64_tr_b16 v[214:215], v1 offset:23040
    s_waitcnt vmcnt(8) lgkmcnt(8)
    v_mfma_f32_32x32x16_bf16 v[168:183], v[116:119], v[192:195], v[168:183]
    v_mfma_f32_32x32x16_bf16 v[152:167], v[116:119], v[196:199], v[152:167]
    ds_read_b64_tr_b16 v[184:185], v7 offset:24576
    ds_read_b64_tr_b16 v[186:187], v7 offset:25088
    ds_read_b64_tr_b16 v[188:189], v1 offset:24576
    ds_read_b64_tr_b16 v[190:191], v1 offset:25088
    s_waitcnt vmcnt(7) lgkmcnt(8)
    v_mfma_f32_32x32x16_bf16 v[168:183], v[120:123], v[200:203], v[168:183]
    v_mfma_f32_32x32x16_bf16 v[152:167], v[120:123], v[204:207], v[152:167]
    ds_read_b64_tr_b16 v[192:193], v7 offset:26624
    ds_read_b64_tr_b16 v[194:195], v7 offset:27136
    ds_read_b64_tr_b16 v[196:197], v1 offset:26624
    ds_read_b64_tr_b16 v[198:199], v1 offset:27136
    s_waitcnt vmcnt(6) lgkmcnt(8)
    v_mfma_f32_32x32x16_bf16 v[168:183], v[124:127], v[208:211], v[168:183]
    v_mfma_f32_32x32x16_bf16 v[152:167], v[124:127], v[212:215], v[152:167]
    ds_read_b64_tr_b16 v[200:201], v7 offset:28672
    ds_read_b64_tr_b16 v[202:203], v7 offset:29184
    ds_read_b64_tr_b16 v[204:205], v1 offset:28672
    ds_read_b64_tr_b16 v[206:207], v1 offset:29184
    s_waitcnt vmcnt(5) lgkmcnt(8)
    v_mfma_f32_32x32x16_bf16 v[168:183], v[128:131], v[184:187], v[168:183]
    v_mfma_f32_32x32x16_bf16 v[152:167], v[128:131], v[188:191], v[152:167]
    ds_read_b64_tr_b16 v[208:209], v7 offset:30720
    ds_read_b64_tr_b16 v[210:211], v7 offset:31232
    ds_read_b64_tr_b16 v[212:213], v1 offset:30720
    ds_read_b64_tr_b16 v[214:215], v1 offset:31232
    s_waitcnt vmcnt(4) lgkmcnt(8)
    v_mfma_f32_32x32x16_bf16 v[168:183], v[132:135], v[192:195], v[168:183]
    v_mfma_f32_32x32x16_bf16 v[152:167], v[132:135], v[196:199], v[152:167]
    ds_read_b64_tr_b16 v[184:185], v7 offset:32768
    ds_read_b64_tr_b16 v[186:187], v7 offset:33280
    ds_read_b64_tr_b16 v[188:189], v1 offset:32768
    ds_read_b64_tr_b16 v[190:191], v1 offset:33280
    s_waitcnt vmcnt(3) lgkmcnt(8)
    v_mfma_f32_32x32x16_bf16 v[168:183], v[136:139], v[200:203], v[168:183]
    v_mfma_f32_32x32x16_bf16 v[152:167], v[136:139], v[204:207], v[152:167]
    ds_read_b64_tr_b16 v[192:193], v7 offset:34816
    ds_read_b64_tr_b16 v[194:195], v7 offset:35328
    ds_read_b64_tr_b16 v[196:197], v1 offset:34816
    ds_read_b64_tr_b16 v[198:199], v1 offset:35328
    s_waitcnt vmcnt(2) lgkmcnt(8)
    v_mfma_f32_32x32x16_bf16 v[168:183], v[140:143], v[208:211], v[168:183]
    v_mfma_f32_32x32x16_bf16 v[152:167], v[140:143], v[212:215], v[152:167]
    s_waitcnt vmcnt(1) lgkmcnt(4)
    v_mfma_f32_32x32x16_bf16 v[168:183], v[144:147], v[184:187], v[168:183]
    v_mfma_f32_32x32x16_bf16 v[152:167], v[144:147], v[188:191], v[152:167]
    s_waitcnt vmcnt(0) lgkmcnt(0)
    v_mfma_f32_32x32x16_bf16 v[168:183], v[148:151], v[192:195], v[168:183]
    v_mfma_f32_32x32x16_bf16 v[152:167], v[148:151], v[196:199], v[152:167]
    s_nop 15
    s_nop 7
    ds_write_b128 v4, v[168:171] offset:0
    ds_write_b128 v4, v[172:175] offset:1024
    ds_write_b128 v4, v[176:179] offset:2048
    ds_write_b128 v4, v[180:183] offset:3072
    s_nop 7
    v_permlane32_swap_b32 v72, v74
    v_permlane32_swap_b32 v73, v75
    v_permlane32_swap_b32 v76, v78
    v_permlane32_swap_b32 v77, v79
    v_dot2_f32_bf16 v152, v8, v2, v152
    v_dot2_f32_bf16 v153, v8, v3, v153
    v_dot2_f32_bf16 v154, v9, v2, v154
    v_dot2_f32_bf16 v155, v9, v3, v155
    v_dot2_f32_bf16 v156, v10, v2, v156
    v_dot2_f32_bf16 v157, v10, v3, v157
    v_dot2_f32_bf16 v158, v11, v2, v158
    v_dot2_f32_bf16 v159, v11, v3, v159
    v_dot2_f32_bf16 v160, v12, v2, v160
    v_dot2_f32_bf16 v161, v12, v3, v161
    v_dot2_f32_bf16 v162, v13, v2, v162
    v_dot2_f32_bf16 v163, v13, v3, v163
    v_dot2_f32_bf16 v164, v14, v2, v164
    v_dot2_f32_bf16 v165, v14, v3, v165
    v_dot2_f32_bf16 v166, v15, v2, v166
    v_dot2_f32_bf16 v167, v15, v3, v167
    v_dot2_f32_bf16 v152, v16, v2, v152
    v_dot2_f32_bf16 v153, v16, v3, v153
    v_dot2_f32_bf16 v154, v17, v2, v154
    v_dot2_f32_bf16 v155, v17, v3, v155
    v_dot2_f32_bf16 v156, v18, v2, v156
    v_dot2_f32_bf16 v157, v18, v3, v157
    v_dot2_f32_bf16 v158, v19, v2, v158
    v_dot2_f32_bf16 v159, v19, v3, v159
    v_dot2_f32_bf16 v160, v20, v2, v160
    v_dot2_f32_bf16 v161, v20, v3, v161
    v_dot2_f32_bf16 v162, v21, v2, v162
    v_dot2_f32_bf16 v163, v21, v3, v163
    v_dot2_f32_bf16 v164, v22, v2, v164
    v_dot2_f32_bf16 v165, v22, v3, v165
    v_dot2_f32_bf16 v166, v23, v2, v166
    v_dot2_f32_bf16 v167, v23, v3, v167
    v_dot2_f32_bf16 v152, v24, v2, v152
    v_dot2_f32_bf16 v153, v24, v3, v153
    v_dot2_f32_bf16 v154, v25, v2, v154
    v_dot2_f32_bf16 v155, v25, v3, v155
    v_dot2_f32_bf16 v156, v26, v2, v156
    v_dot2_f32_bf16 v157, v26, v3, v157
    v_dot2_f32_bf16 v158, v27, v2, v158
    v_dot2_f32_bf16 v159, v27, v3, v159
    v_dot2_f32_bf16 v160, v28, v2, v160
    v_dot2_f32_bf16 v161, v28, v3, v161
    v_dot2_f32_bf16 v162, v29, v2, v162
    v_dot2_f32_bf16 v163, v29, v3, v163
    v_dot2_f32_bf16 v164, v30, v2, v164
    v_dot2_f32_bf16 v165, v30, v3, v165
    v_dot2_f32_bf16 v166, v31, v2, v166
    v_dot2_f32_bf16 v167, v31, v3, v167
    v_dot2_f32_bf16 v152, v32, v2, v152
    v_dot2_f32_bf16 v153, v32, v3, v153
    v_dot2_f32_bf16 v154, v33, v2, v154
    v_dot2_f32_bf16 v155, v33, v3, v155
    v_dot2_f32_bf16 v156, v34, v2, v156
    v_dot2_f32_bf16 v157, v34, v3, v157
    v_dot2_f32_bf16 v158, v35, v2, v158
    v_dot2_f32_bf16 v159, v35, v3, v159
    v_dot2_f32_bf16 v160, v36, v2, v160
    v_dot2_f32_bf16 v161, v36, v3, v161
    v_dot2_f32_bf16 v162, v37, v2, v162
    v_dot2_f32_bf16 v163, v37, v3, v163
    v_dot2_f32_bf16 v164, v38, v2, v164
    v_dot2_f32_bf16 v165, v38, v3, v165
    v_dot2_f32_bf16 v166, v39, v2, v166
    v_dot2_f32_bf16 v167, v39, v3, v167
    v_dot2_f32_bf16 v152, v40, v2, v152
    v_dot2_f32_bf16 v153, v40, v3, v153
    v_dot2_f32_bf16 v154, v41, v2, v154
    v_dot2_f32_bf16 v155, v41, v3, v155
    v_dot2_f32_bf16 v156, v42, v2, v156
    v_dot2_f32_bf16 v157, v42, v3, v157
    v_dot2_f32_bf16 v158, v43, v2, v158
    v_dot2_f32_bf16 v159, v43, v3, v159
    v_dot2_f32_bf16 v160, v44, v2, v160
    v_dot2_f32_bf16 v161, v44, v3, v161
    v_dot2_f32_bf16 v162, v45, v2, v162
    v_dot2_f32_bf16 v163, v45, v3, v163
    v_dot2_f32_bf16 v164, v46, v2, v164
    v_dot2_f32_bf16 v165, v46, v3, v165
    v_dot2_f32_bf16 v166, v47, v2, v166
    v_dot2_f32_bf16 v167, v47, v3, v167
    v_dot2_f32_bf16 v152, v48, v2, v152
    v_dot2_f32_bf16 v153, v48, v3, v153
    v_dot2_f32_bf16 v154, v49, v2, v154
    v_dot2_f32_bf16 v155, v49, v3, v155
    v_dot2_f32_bf16 v156, v50, v2, v156
    v_dot2_f32_bf16 v157, v50, v3, v157
    v_dot2_f32_bf16 v158, v51, v2, v158
    v_dot2_f32_bf16 v159, v51, v3, v159
    v_dot2_f32_bf16 v160, v52, v2, v160
    v_dot2_f32_bf16 v161, v52, v3, v161
    v_dot2_f32_bf16 v162, v53, v2, v162
    v_dot2_f32_bf16 v163, v53, v3, v163
    v_dot2_f32_bf16 v164, v54, v2, v164
    v_dot2_f32_bf16 v165, v54, v3, v165
    v_dot2_f32_bf16 v166, v55, v2, v166
    v_dot2_f32_bf16 v167, v55, v3, v167
    v_dot2_f32_bf16 v152, v56, v2, v152
    v_dot2_f32_bf16 v153, v56, v3, v153
    v_dot2_f32_bf16 v154, v57, v2, v154
    v_dot2_f32_bf16 v155, v57, v3, v155
    v_dot2_f32_bf16 v156, v58, v2, v156
    v_dot2_f32_bf16 v157, v58, v3, v157
    v_dot2_f32_bf16 v158, v59, v2, v158
    v_dot2_f32_bf16 v159, v59, v3, v159
    v_dot2_f32_bf16 v160, v60, v2, v160
    v_dot2_f32_bf16 v161, v60, v3, v161
    v_dot2_f32_bf16 v162, v61, v2, v162
    v_dot2_f32_bf16 v163, v61, v3, v163
    v_dot2_f32_bf16 v164, v62, v2, v164
    v_dot2_f32_bf16 v165, v62, v3, v165
    v_dot2_f32_bf16 v166, v63, v2, v166
    v_dot2_f32_bf16 v167, v63, v3, v167
    v_dot2_f32_bf16 v152, v64, v2, v152
    v_dot2_f32_bf16 v153, v64, v3, v153
    v_dot2_f32_bf16 v154, v65, v2, v154
    v_dot2_f32_bf16 v155, v65, v3, v155
    v_dot2_f32_bf16 v156, v66, v2, v156
    v_dot2_f32_bf16 v157, v66, v3, v157
    v_dot2_f32_bf16 v158, v67, v2, v158
    v_dot2_f32_bf16 v159, v67, v3, v159
    v_dot2_f32_bf16 v160, v68, v2, v160
    v_dot2_f32_bf16 v161, v68, v3, v161
    v_dot2_f32_bf16 v162, v69, v2, v162
    v_dot2_f32_bf16 v163, v69, v3, v163
    v_dot2_f32_bf16 v164, v70, v2, v164
    v_dot2_f32_bf16 v165, v70, v3, v165
    v_dot2_f32_bf16 v166, v71, v2, v166
    v_dot2_f32_bf16 v167, v71, v3, v167
    v_dot2_f32_bf16 v152, v72, v2, v152
    v_dot2_f32_bf16 v153, v72, v3, v153
    v_dot2_f32_bf16 v154, v73, v2, v154
    v_dot2_f32_bf16 v155, v73, v3, v155
    v_dot2_f32_bf16 v156, v76, v2, v156
    v_dot2_f32_bf16 v157, v76, v3, v157
    v_dot2_f32_bf16 v158, v77, v2, v158
    v_dot2_f32_bf16 v159, v77, v3, v159
    v_dot2_f32_bf16 v160, v74, v2, v160
    v_dot2_f32_bf16 v161, v74, v3, v161
    v_dot2_f32_bf16 v162, v75, v2, v162
    v_dot2_f32_bf16 v163, v75, v3, v163
    v_dot2_f32_bf16 v164, v78, v2, v164
    v_dot2_f32_bf16 v165, v78, v3, v165
    v_dot2_f32_bf16 v166, v79, v2, v166
    v_dot2_f32_bf16 v167, v79, v3, v167
    s_waitcnt lgkmcnt(0)
    s_barrier
    ds_read_b128 v[168:171], v5 offset:0
    ds_read_b128 v[172:175], v5 offset:1024
    ds_read_b128 v[176:179], v5 offset:2048
    ds_read_b128 v[180:183], v5 offset:3072
    s_waitcnt lgkmcnt(3)
    v_add_f32 v152, v152, v168
    v_add_f32 v153, v153, v169
    v_add_f32 v154, v154, v170
    v_add_f32 v155, v155, v171
    v_cvt_pk_bf16_f32 v72, v152, v153
    v_cvt_pk_bf16_f32 v73, v154, v155
    s_waitcnt lgkmcnt(2)
    v_add_f32 v156, v156, v172
    v_add_f32 v157, v157, v173
    v_add_f32 v158, v158, v174
    v_add_f32 v159, v159, v175
    v_cvt_pk_bf16_f32 v76, v156, v157
    v_cvt_pk_bf16_f32 v77, v158, v159
    s_waitcnt lgkmcnt(1)
    v_add_f32 v160, v160, v176
    v_add_f32 v161, v161, v177
    v_add_f32 v162, v162, v178
    v_add_f32 v163, v163, v179
    v_cvt_pk_bf16_f32 v74, v160, v161
    v_cvt_pk_bf16_f32 v75, v162, v163
    s_waitcnt lgkmcnt(0)
    v_add_f32 v164, v164, v180
    v_add_f32 v165, v165, v181
    v_add_f32 v166, v166, v182
    v_add_f32 v167, v167, v183
    v_cvt_pk_bf16_f32 v78, v164, v165
    v_cvt_pk_bf16_f32 v79, v166, v167
    s_nop 1
    v_permlane32_swap_b32 v72, v74
    v_permlane32_swap_b32 v73, v75
    v_permlane32_swap_b32 v76, v78
    v_permlane32_swap_b32 v77, v79
    buffer_store_dwordx4 v[72:75], v6, s[36:39], s26 offen offset:0
    buffer_store_dwordx4 v[76:79], v6, s[36:39], s26 offen offset:16
    s_waitcnt vmcnt(0)
Lfin_end:
    s_endpgm
.section .rodata,"a"
.p2align 6
.amdhsa_kernel prep_kernel
  .amdhsa_next_free_vgpr 256
  .amdhsa_next_free_sgpr 96
  .amdhsa_accum_offset 256
  .amdhsa_group_segment_fixed_size 0
  .amdhsa_kernarg_size 80
  .amdhsa_user_sgpr_count 2
  .amdhsa_user_sgpr_kernarg_segment_ptr 1
  .amdhsa_system_sgpr_workgroup_id_x 1
.end_amdhsa_kernel

.p2align 6
.amdhsa_kernel ffn1_kernel
  .amdhsa_next_free_vgpr 224
  .amdhsa_next_free_sgpr 96
  .amdhsa_accum_offset 224
  .amdhsa_group_segment_fixed_size 0
  .amdhsa_kernarg_size 80
  .amdhsa_user_sgpr_count 2
  .amdhsa_user_sgpr_kernarg_segment_ptr 1
  .amdhsa_system_sgpr_workgroup_id_x 1
.end_amdhsa_kernel

.p2align 6
.amdhsa_kernel g2_kernel
  .amdhsa_next_free_vgpr 256
  .amdhsa_next_free_sgpr 96
  .amdhsa_accum_offset 256
  .amdhsa_group_segment_fixed_size 0
  .amdhsa_kernarg_size 80
  .amdhsa_user_sgpr_count 2
  .amdhsa_user_sgpr_kernarg_segment_ptr 1
  .amdhsa_system_sgpr_workgroup_id_x 1
.end_amdhsa_kernel

.p2align 6
.amdhsa_kernel fin_kernel
  .amdhsa_next_free_vgpr 216
  .amdhsa_next_free_sgpr 96
  .amdhsa_accum_offset 216
  .amdhsa_group_segment_fixed_size 0
  .amdhsa_kernarg_size 80
  .amdhsa_user_sgpr_count 2
  .amdhsa_user_sgpr_kernarg_segment_ptr 1
  .amdhsa_system_sgpr_workgroup_id_x 1
.end_amdhsa_kernel
```
